```python
import torch

def _softmax(x, axis=-1):
    return torch.softmax(x, dim=axis)
def _gelu(x):
    return torch.nn.functional.gelu(x, approximate="tanh")
def _silu(x):
    return torch.nn.functional.silu(x)
def _sigmoid(x):
    return torch.sigmoid(x)
def _layernorm(x, axis=-1, eps=1e-5):
    m = x.mean(dim=axis, keepdim=True)
    v = x.var(dim=axis, keepdim=True, unbiased=False)
    return (x - m) / torch.sqrt(v + eps)
def _scatter_add(tgt, idx, src, axis=0):
    return tgt.clone().index_add_(axis, idx, src)
def _segment_sum(src, seg, n):
    out = torch.zeros((n,) + src.shape[1:], dtype=src.dtype)
    return out.index_add_(0, seg, src)
def _pad(x, pw):
    flat = tuple(v for pair in reversed(pw) for v in pair)
    return torch.nn.functional.pad(x, flat)

kernel_name = 'gated_mix__sliding_local_dilated__softmax_full_mha__prompt'

def setup_inputs():

    _w = (lambda a: (lambda t: t.to(torch.bfloat16) if t.is_floating_point() else t)(torch.as_tensor(a)))
    def _A_setup():
        B, S, D = 1, 2048, 576
        return {
            "x": _w((lambda *s: torch.randn(*s, dtype=torch.bfloat16) * 0.05)(B, S, D)),
            "wqkv": _w((lambda *s: torch.randn(*s, dtype=torch.bfloat16) * 3.2)(D, 3 * D)),
            "wo": _w((lambda *s: torch.randn(*s, dtype=torch.bfloat16) * 0.1)(D, D)),
        }
    _A_in = _A_setup()

    def _B_setup():
        B, S, D = 1, 2048, 576
        return {
            "x": _w((lambda *s: torch.randn(*s, dtype=torch.bfloat16) * 0.05)(B, S, D)),
            "wqkv": _w((lambda *s: torch.randn(*s, dtype=torch.bfloat16) * 1.6)(D, 3 * D)),
            "wo": _w((lambda *s: torch.randn(*s, dtype=torch.bfloat16) * 0.2)(D, D)),
        }
    _B_in = _B_setup()

    return {
        "A_x": _A_in["x"],
        "A_wqkv": _A_in["wqkv"],
        "A_wo": _A_in["wo"],
        "B_x": _B_in["x"],
        "B_wqkv": _B_in["wqkv"],
        "B_wo": _B_in["wo"],
        "gate_w": _w((lambda *s: torch.randn(*s, dtype=torch.bfloat16) * 0.05)(576) * 16.0),
    }

def reference(A_x, A_wqkv, A_wo, B_x, B_wqkv, B_wo, gate_w):
    def _A_ref(x, wqkv, wo):
        B, S, D = x.shape
        H = 32; Dh = D // H
        W, dil = 8, 2
        qkv = (lambda x, *d: x.permute(*d))((x @ wqkv).reshape(B, S, 3, H, Dh), 2, 0, 3, 1, 4)
        q, k, v = qkv[0], qkv[1], qkv[2]
        scale = Dh ** -0.5
        pos = torch.arange(S)
        off = torch.arange(W) * dil
        idx = pos[:, None] - off[None, :]
        mask = idx >= 0
        idx_c = torch.where(mask, idx, 0).reshape(-1)
        kg = k[:, :, idx_c, :].reshape(B, H, S, W, Dh)
        vg = v[:, :, idx_c, :].reshape(B, H, S, W, Dh)
        logits = torch.einsum("bhsd,bhswd->bhsw", q, kg) * scale
        logits = torch.where(mask[None, None, :, :], logits, -1e9)
        attn = _softmax(logits, axis=-1)
        o = torch.einsum("bhsw,bhswd->bhsd", attn, vg)
        return (lambda x, *d: x.permute(*d))(o, 0, 2, 1, 3).reshape(B, S, D) @ wo

    def _B_ref(x, wqkv, wo):
        B, S, D = x.shape
        H = 32; Dh = D // H
        qkv = (lambda x, *d: x.permute(*d))((x @ wqkv).reshape(B, S, 3, H, Dh), 2, 0, 3, 1, 4)
        q, k, v = qkv[0], qkv[1], qkv[2]
        scale = Dh ** -0.5
        scores = torch.einsum("bhqd,bhkd->bhqk", q, k) * scale
        p = _softmax(scores, axis=-1)
        o = torch.einsum("bhqk,bhkd->bhqd", p, v)
        return (lambda x, *d: x.permute(*d))(o, 0, 2, 1, 3).reshape(B, S, D) @ wo

    x = A_x
    g = _sigmoid((x * gate_w).sum(-1, keepdims=True))
    a = _A_ref(x, A_wqkv, A_wo)
    b = _B_ref(x, B_wqkv, B_wo)
    return g * a + (1 - g) * b
```

```asm
; @launch kernel=k1_qkv_kernel grid=(256,1,1) block=(512,1,1) lds=147456
; @launch kernel=k2_attn_kernel grid=(256,1,1) block=(512,1,1) lds=163840
.amdgcn_target "amdgcn-amd-amdhsa--gfx950"
.text
.globl k1_qkv_kernel
.p2align 8
.type k1_qkv_kernel,@function
k1_qkv_kernel:
  s_cmp_ge_u32 s2, 256
  s_cbranch_scc1 k1_qkv_kernel_end
  s_load_dwordx2 s[20:21], s[0:1], 72
  s_load_dwordx2 s[8:9], s[0:1], 0
  v_and_b32 v1, 63, v0
  v_lshrrev_b32 v11, 6, v0
  s_nop 0
  v_readfirstlane_b32 s5, v11
  s_cmp_ge_u32 s2, 224
  s_cbranch_scc1 k1_qkv_kernel_gate0
  s_load_dwordx2 s[12:13], s[0:1], 8
  s_load_dwordx2 s[14:15], s[0:1], 32
  s_mov_b32 s70, s5
  s_and_b32 s6, s2, 7
  s_lshr_b32 s7, s2, 3
  s_and_b32 s3, s6, 1
  s_lshl_b32 s3, s3, 2
  s_and_b32 s30, s7, 3
  s_add_u32 s3, s3, s30
  s_lshr_b32 s6, s6, 1
  s_mul_i32 s6, s6, 7
  s_lshr_b32 s7, s7, 2
  s_add_u32 s4, s6, s7
  s_cmp_ge_u32 s4, 14
  s_cselect_b32 s26, 1, 0
  s_mul_i32 s6, s26, 14
  s_sub_u32 s4, s4, s6
  s_cmp_ge_u32 s4, 9
  s_cselect_b32 s27, 1, 0
  s_cselect_b32 s30, 0, 64
  s_cselect_b32 s31, 64, 0
  s_and_b32 s28, s5, 3
  s_lshr_b32 s29, s5, 2
  v_lshrrev_b32 v11, 3, v1
  v_mul_u32_u24 v11, 1152, v11
  v_and_b32 v12, 7, v1
  v_lshrrev_b32 v13, 4, v1
  v_xor_b32 v12, v12, v13
  v_lshl_add_u32 v8, v12, 4, v11
  v_xor_b32 v9, 64, v8
  v_xor_b32 v48, s30, v8
  v_xor_b32 v49, s31, v8
  v_mul_u32_u24 v11, 3456, v13
  v_and_b32 v12, 15, v1
  v_lshlrev_b32 v13, 2, v13
  v_xor_b32 v12, v12, v13
  s_and_b32 s6, s5, 1
  s_lshl_b32 s6, s6, 1
  v_xor_b32 v12, s6, v12
  v_lshl_add_u32 v10, v12, 4, v11
  s_lshl_b32 s6, s3, 8
  s_lshl_b32 s7, s5, 5
  s_add_u32 s6, s6, s7
  s_mul_i32 s22, s6, 1152
  s_mul_i32 s23, s5, 27648
  s_lshl_b32 s6, s4, 8
  s_add_u32 s23, s23, s6
  s_lshl_b32 s24, s5, 12
  s_lshl_b32 s25, s5, 11
  s_add_u32 s25, s25, 32768
  s_waitcnt lgkmcnt(0)
  s_and_b32 s9, s9, 0xffff
  s_mov_b32 s10, 2359296
  s_mov_b32 s11, 0x20000
  s_cmp_eq_u32 s26, 1
  s_cselect_b32 s12, s14, s12
  s_cselect_b32 s13, s15, s13
  s_and_b32 s13, s13, 0xffff
  s_mov_b32 s14, 1990656
  s_mov_b32 s15, 0x20000
  s_add_u32 s30, s23, 0
  s_add_u32 m0, s25, 0
  s_nop 0
  buffer_load_dwordx4 v10, s[12:15], s30 offen  lds
  s_add_u32 s30, s23, 13824
  s_add_u32 m0, s25, 1024
  s_nop 0
  buffer_load_dwordx4 v10, s[12:15], s30 offen  lds
  s_add_u32 s30, s22, 0
  s_add_u32 m0, s24, 0
  s_nop 0
  buffer_load_dwordx4 v8, s[8:11], s30 offen  lds
  s_add_u32 s30, s22, 9216
  s_add_u32 m0, s24, 1024
  s_nop 0
  buffer_load_dwordx4 v48, s[8:11], s30 offen  lds
  s_add_u32 s30, s22, 18432
  s_add_u32 m0, s24, 2048
  s_nop 0
  buffer_load_dwordx4 v49, s[8:11], s30 offen  lds
  s_add_u32 s30, s22, 27648
  s_add_u32 m0, s24, 3072
  s_nop 0
  buffer_load_dwordx4 v9, s[8:11], s30 offen  lds
  s_add_u32 s30, s23, 221184
  s_add_u32 m0, s25, 49152
  s_nop 0
  buffer_load_dwordx4 v10, s[12:15], s30 offen  lds
  s_add_u32 s30, s23, 235008
  s_add_u32 m0, s25, 50176
  s_nop 0
  buffer_load_dwordx4 v10, s[12:15], s30 offen  lds
  s_add_u32 s30, s22, 128
  s_add_u32 m0, s24, 49152
  s_nop 0
  buffer_load_dwordx4 v8, s[8:11], s30 offen  lds
  s_add_u32 s30, s22, 9344
  s_add_u32 m0, s24, 50176
  s_nop 0
  buffer_load_dwordx4 v48, s[8:11], s30 offen  lds
  s_add_u32 s30, s22, 18560
  s_add_u32 m0, s24, 51200
  s_nop 0
  buffer_load_dwordx4 v49, s[8:11], s30 offen  lds
  s_add_u32 s30, s22, 27776
  s_add_u32 m0, s24, 52224
  s_nop 0
  buffer_load_dwordx4 v9, s[8:11], s30 offen  lds
  s_mov_b32 s16, s20
  s_and_b32 s17, s21, 0xffff
  s_mov_b32 s18, 0x2000000
  s_mov_b32 s19, 0x20000
  v_and_b32 v11, 15, v1
  v_and_b32 v14, 8, v1
  v_mul_u32_u24 v14, s27, v14
  v_add_u32 v11, v11, v14
  v_lshrrev_b32 v12, 4, v1
  v_bfe_u32 v13, v1, 1, 3
  v_xor_b32 v13, v12, v13
  v_lshlrev_b32 v13, 4, v13
  v_lshl_add_u32 v13, v11, 7, v13
  s_lshl_b32 s6, s28, 13
  v_add_u32 v2, s6, v13
  v_xor_b32 v3, 64, v2
  s_mov_b32 s72, 0x76543210
  s_mov_b32 s73, 0xfedcba98
  s_cmp_eq_u32 s27, 1
  s_cbranch_scc1 k1_qkv_kernel_vsetup
  s_lshl_b32 s6, s4, 7
  s_lshl_b32 s7, s29, 6
  s_add_u32 s6, s6, s7
  s_cmp_ge_u32 s6, 576
  s_cselect_b32 s7, 576, 0
  s_sub_u32 s6, s6, s7
  s_lshr_b32 s32, s6, 2
  s_cmp_eq_u32 s7, 576
  s_mov_b32 s33, 13631488
  s_cselect_b32 s33, 8388608, s33
  s_mov_b32 s38, 5242880
  s_cselect_b32 s38, 0, s38
  s_mov_b32 s34, 73728
  s_cselect_b32 s34, 151552, s34
  s_mov_b32 s35, 1152
  s_cselect_b32 s35, 2368, s35
  s_mov_b32 s36, 1024
  s_cselect_b32 s36, 2240, s36
  s_cselect_b32 s37, 1.0, 1051597459
  s_cselect_b32 s78, 1, 0
  s_cmp_eq_u32 s26, 1
  s_cselect_b32 s33, s38, s33
  s_lshl_b32 s6, s3, 3
  s_lshl_b32 s7, s28, 1
  s_add_u32 s6, s6, s7
  s_mul_i32 s38, s6, s35
  s_add_u32 s39, s38, s35
  s_lshr_b32 s79, s32, 4
  s_mov_b32 s74, 0xffff0000
  s_mov_b32 s75, 0
  s_mov_b32 s92, 0
  s_mov_b32 s93, 0xffff
  s_mov_b32 s94, 0
  s_mov_b32 s95, 0xffff0000
  v_and_b32 v11, 15, v1
  v_lshlrev_b32 v12, 4, v11
  v_lshrrev_b32 v13, 5, v1
  v_mul_lo_u32 v13, v13, s35
  v_and_b32 v11, 31, v1
  v_lshl_add_u32 v52, v11, 4, v13
  v_lshl_add_u32 v53, v11, 2, v13
  s_cmp_lg_u32 s79, 0
  s_cbranch_scc1 k1_qkv_kernel_setup1
  s_mov_b32 s72, 0x86317520
  s_mov_b32 s73, 0xdfca4eb9
  s_mul_i32 s80, s34, 0
  s_add_u32 s80, s80, s33
  s_mul_i32 s81, s34, 0
  s_add_u32 s81, s81, s33
  s_add_u32 s81, s81, 512
  s_mul_i32 s82, s34, 1
  s_add_u32 s82, s82, s33
  s_mul_i32 s83, s34, 1
  s_add_u32 s83, s83, s33
  s_add_u32 s83, s83, 512
  v_mov_b32 v14, s80
  v_mov_b32 v15, s81
  v_cndmask_b32 v14, v14, v15, s[74:75]
  v_mov_b32 v15, s82
  v_cndmask_b32 v14, v14, v15, s[92:93]
  v_mov_b32 v15, s83
  v_cndmask_b32 v14, v14, v15, s[94:95]
  v_add_u32 v50, v14, v12
  s_mul_i32 s80, s34, 2
  s_add_u32 s80, s80, s33
  s_mul_i32 s81, s34, 2
  s_add_u32 s81, s81, s33
  s_add_u32 s81, s81, 512
  s_mul_i32 s82, s34, 3
  s_add_u32 s82, s82, s33
  s_mov_b32 s83, 2147418112
  v_mov_b32 v14, s80
  v_mov_b32 v15, s81
  v_cndmask_b32 v14, v14, v15, s[74:75]
  v_mov_b32 v15, s82
  v_cndmask_b32 v14, v14, v15, s[92:93]
  v_mov_b32 v15, s83
  v_cndmask_b32 v14, v14, v15, s[94:95]
  v_add_u32 v51, v14, v12
  s_mul_i32 s84, s34, 0
  s_add_u32 s84, s84, s33
  s_add_u32 s84, s84, s38
  s_add_u32 s84, s84, s36
  s_add_u32 s85, s84, s34
  s_mul_i32 s86, s34, 2
  s_add_u32 s86, s86, s33
  s_add_u32 s86, s86, s38
  s_add_u32 s86, s86, s36
  s_add_u32 s87, s86, s34
  s_branch k1_qkv_kernel_setup_done
k1_qkv_kernel_setup1:
  s_cmp_lg_u32 s79, 1
  s_cbranch_scc1 k1_qkv_kernel_setup2
  s_mov_b32 s72, 0xa8319720
  s_mov_b32 s73, 0xfec56db4
  s_mul_i32 s80, s34, 3
  s_add_u32 s80, s80, s33
  s_add_u32 s80, s80, 512
  s_mul_i32 s81, s34, 4
  s_add_u32 s81, s81, s33
  s_mul_i32 s82, s34, 5
  s_add_u32 s82, s82, s33
  s_mul_i32 s83, s34, 5
  s_add_u32 s83, s83, s33
  s_add_u32 s83, s83, 512
  v_mov_b32 v14, s80
  v_mov_b32 v15, s81
  v_cndmask_b32 v14, v14, v15, s[74:75]
  v_mov_b32 v15, s82
  v_cndmask_b32 v14, v14, v15, s[92:93]
  v_mov_b32 v15, s83
  v_cndmask_b32 v14, v14, v15, s[94:95]
  v_add_u32 v50, v14, v12
  s_mul_i32 s80, s34, 4
  s_add_u32 s80, s80, s33
  s_add_u32 s80, s80, 512
  s_mul_i32 s81, s34, 6
  s_add_u32 s81, s81, s33
  s_mul_i32 s82, s34, 6
  s_add_u32 s82, s82, s33
  s_add_u32 s82, s82, 512
  s_mov_b32 s83, 2147418112
  v_mov_b32 v14, s80
  v_mov_b32 v15, s81
  v_cndmask_b32 v14, v14, v15, s[74:75]
  v_mov_b32 v15, s82
  v_cndmask_b32 v14, v14, v15, s[92:93]
  v_mov_b32 v15, s83
  v_cndmask_b32 v14, v14, v15, s[94:95]
  v_add_u32 v51, v14, v12
  s_mul_i32 s84, s34, 4
  s_add_u32 s84, s84, s33
  s_add_u32 s84, s84, s38
  s_add_u32 s84, s84, s36
  s_add_u32 s85, s84, s34
  s_mul_i32 s86, s34, 6
  s_add_u32 s86, s86, s33
  s_add_u32 s86, s86, s38
  s_add_u32 s86, s86, s36
  s_add_u32 s87, s86, s34
  s_branch k1_qkv_kernel_setup_done
k1_qkv_kernel_setup2:
  s_cmp_lg_u32 s79, 2
  s_cbranch_scc1 k1_qkv_kernel_setup3
  s_mov_b32 s72, 0xca31b920
  s_mov_b32 s73, 0x8e75fd64
  s_mul_i32 s80, s34, 7
  s_add_u32 s80, s80, s33
  s_mul_i32 s81, s34, 7
  s_add_u32 s81, s81, s33
  s_add_u32 s81, s81, 512
  s_mul_i32 s82, s34, 9
  s_add_u32 s82, s82, s33
  s_mul_i32 s83, s34, 9
  s_add_u32 s83, s83, s33
  s_add_u32 s83, s83, 512
  v_mov_b32 v14, s80
  v_mov_b32 v15, s81
  v_cndmask_b32 v14, v14, v15, s[74:75]
  v_mov_b32 v15, s82
  v_cndmask_b32 v14, v14, v15, s[92:93]
  v_mov_b32 v15, s83
  v_cndmask_b32 v14, v14, v15, s[94:95]
  v_add_u32 v50, v14, v12
  s_mul_i32 s80, s34, 8
  s_add_u32 s80, s80, s33
  s_mul_i32 s81, s34, 8
  s_add_u32 s81, s81, s33
  s_add_u32 s81, s81, 512
  s_mul_i32 s82, s34, 10
  s_add_u32 s82, s82, s33
  s_mov_b32 s83, 2147418112
  v_mov_b32 v14, s80
  v_mov_b32 v15, s81
  v_cndmask_b32 v14, v14, v15, s[74:75]
  v_mov_b32 v15, s82
  v_cndmask_b32 v14, v14, v15, s[92:93]
  v_mov_b32 v15, s83
  v_cndmask_b32 v14, v14, v15, s[94:95]
  v_add_u32 v51, v14, v12
  s_mul_i32 s84, s34, 10
  s_add_u32 s84, s84, s33
  s_add_u32 s84, s84, s38
  s_add_u32 s84, s84, 512
  s_mul_i32 s85, s34, 8
  s_add_u32 s85, s85, s33
  s_add_u32 s85, s85, s38
  s_add_u32 s85, s85, s36
  s_add_u32 s86, s85, s34
  s_branch k1_qkv_kernel_setup_done
k1_qkv_kernel_setup3:
  s_cmp_lg_u32 s79, 3
  s_cbranch_scc1 k1_qkv_kernel_setup4
  s_mov_b32 s72, 0xec53db42
  s_mov_b32 s73, 0xa097f186
  s_mul_i32 s80, s34, 11
  s_add_u32 s80, s80, s33
  s_mul_i32 s81, s34, 11
  s_add_u32 s81, s81, s33
  s_add_u32 s81, s81, 512
  s_mul_i32 s82, s34, 13
  s_add_u32 s82, s82, s33
  s_mul_i32 s83, s34, 13
  s_add_u32 s83, s83, s33
  s_add_u32 s83, s83, 512
  v_mov_b32 v14, s80
  v_mov_b32 v15, s81
  v_cndmask_b32 v14, v14, v15, s[74:75]
  v_mov_b32 v15, s82
  v_cndmask_b32 v14, v14, v15, s[92:93]
  v_mov_b32 v15, s83
  v_cndmask_b32 v14, v14, v15, s[94:95]
  v_add_u32 v50, v14, v12
  s_mul_i32 s80, s34, 12
  s_add_u32 s80, s80, s33
  s_mul_i32 s81, s34, 12
  s_add_u32 s81, s81, s33
  s_add_u32 s81, s81, 512
  s_mov_b32 s82, 2147418112
  s_mov_b32 s83, 2147418112
  v_mov_b32 v14, s80
  v_mov_b32 v15, s81
  v_cndmask_b32 v14, v14, v15, s[74:75]
  v_mov_b32 v15, s82
  v_cndmask_b32 v14, v14, v15, s[92:93]
  v_mov_b32 v15, s83
  v_cndmask_b32 v14, v14, v15, s[94:95]
  v_add_u32 v51, v14, v12
  s_mul_i32 s84, s34, 10
  s_add_u32 s84, s84, s33
  s_add_u32 s84, s84, s38
  s_add_u32 s84, s84, s36
  s_add_u32 s85, s84, s34
  s_mul_i32 s86, s34, 10
  s_add_u32 s86, s86, s33
  s_add_u32 s86, s86, s38
  s_add_u32 s86, s86, 520
  s_mul_i32 s87, s34, 14
  s_add_u32 s87, s87, s33
  s_add_u32 s87, s87, s38
  s_mul_i32 s88, s34, 12
  s_add_u32 s88, s88, s33
  s_add_u32 s88, s88, s38
  s_add_u32 s88, s88, s36
  s_add_u32 s89, s88, s34
  s_branch k1_qkv_kernel_setup_done
k1_qkv_kernel_setup4:
  s_cmp_lg_u32 s79, 4
  s_cbranch_scc1 k1_qkv_kernel_setup5
  s_mov_b32 s72, 0x7523641
  s_mov_b32 s73, 0xceb9fda8
  s_mul_i32 s80, s34, 14
  s_add_u32 s80, s80, s33
  s_add_u32 s80, s80, 512
  s_mul_i32 s81, s34, 15
  s_add_u32 s81, s81, s33
  s_mul_i32 s82, s34, 15
  s_add_u32 s82, s82, s33
  s_add_u32 s82, s82, 512
  s_mov_b32 s83, 2147418112
  v_mov_b32 v14, s80
  v_mov_b32 v15, s81
  v_cndmask_b32 v14, v14, v15, s[74:75]
  v_mov_b32 v15, s82
  v_cndmask_b32 v14, v14, v15, s[92:93]
  v_mov_b32 v15, s83
  v_cndmask_b32 v14, v14, v15, s[94:95]
  v_add_u32 v50, v14, v12
  s_mul_i32 s80, s34, 16
  s_add_u32 s80, s80, s33
  s_mul_i32 s81, s34, 16
  s_add_u32 s81, s81, s33
  s_add_u32 s81, s81, 512
  s_mul_i32 s82, s34, 17
  s_add_u32 s82, s82, s33
  s_mov_b32 s83, 2147418112
  v_mov_b32 v14, s80
  v_mov_b32 v15, s81
  v_cndmask_b32 v14, v14, v15, s[74:75]
  v_mov_b32 v15, s82
  v_cndmask_b32 v14, v14, v15, s[92:93]
  v_mov_b32 v15, s83
  v_cndmask_b32 v14, v14, v15, s[94:95]
  v_add_u32 v51, v14, v12
  s_mul_i32 s84, s34, 14
  s_add_u32 s84, s84, s33
  s_add_u32 s84, s84, s38
  s_add_u32 s84, s84, s36
  s_add_u32 s85, s84, s34
  s_mul_i32 s86, s34, 14
  s_add_u32 s86, s86, s33
  s_add_u32 s86, s86, s38
  s_add_u32 s86, s86, 8
  s_mul_i32 s87, s34, 17
  s_add_u32 s87, s87, s33
  s_add_u32 s87, s87, s38
  s_add_u32 s87, s87, 512
  s_mul_i32 s88, s34, 16
  s_add_u32 s88, s88, s33
  s_add_u32 s88, s88, s38
  s_add_u32 s88, s88, s36
  s_add_u32 s89, s88, s34
  s_branch k1_qkv_kernel_setup_done
k1_qkv_kernel_setup5:
  s_cmp_lg_u32 s79, 5
  s_cbranch_scc1 k1_qkv_kernel_setup6
  s_mov_b32 s72, 0x97428631
  s_mov_b32 s73, 0xe0dbf5ca
  s_mul_i32 s80, s34, 18
  s_add_u32 s80, s80, s33
  s_mul_i32 s81, s34, 18
  s_add_u32 s81, s81, s33
  s_add_u32 s81, s81, 512
  s_mul_i32 s82, s34, 19
  s_add_u32 s82, s82, s33
  s_mul_i32 s83, s34, 19
  s_add_u32 s83, s83, s33
  s_add_u32 s83, s83, 512
  v_mov_b32 v14, s80
  v_mov_b32 v15, s81
  v_cndmask_b32 v14, v14, v15, s[74:75]
  v_mov_b32 v15, s82
  v_cndmask_b32 v14, v14, v15, s[92:93]
  v_mov_b32 v15, s83
  v_cndmask_b32 v14, v14, v15, s[94:95]
  v_add_u32 v50, v14, v12
  s_mul_i32 s80, s34, 20
  s_add_u32 s80, s80, s33
  s_mul_i32 s81, s34, 20
  s_add_u32 s81, s81, s33
  s_add_u32 s81, s81, 512
  s_mov_b32 s82, 2147418112
  s_mov_b32 s83, 2147418112
  v_mov_b32 v14, s80
  v_mov_b32 v15, s81
  v_cndmask_b32 v14, v14, v15, s[74:75]
  v_mov_b32 v15, s82
  v_cndmask_b32 v14, v14, v15, s[92:93]
  v_mov_b32 v15, s83
  v_cndmask_b32 v14, v14, v15, s[94:95]
  v_add_u32 v51, v14, v12
  s_mul_i32 s84, s34, 18
  s_add_u32 s84, s84, s33
  s_add_u32 s84, s84, s38
  s_add_u32 s84, s84, s36
  s_add_u32 s85, s84, s34
  s_mul_i32 s86, s34, 17
  s_add_u32 s86, s86, s33
  s_add_u32 s86, s86, s38
  s_add_u32 s86, s86, 520
  s_mul_i32 s87, s34, 21
  s_add_u32 s87, s87, s33
  s_add_u32 s87, s87, s38
  s_mul_i32 s88, s34, 20
  s_add_u32 s88, s88, s33
  s_add_u32 s88, s88, s38
  s_add_u32 s88, s88, s36
  s_add_u32 s89, s88, s34
  s_branch k1_qkv_kernel_setup_done
k1_qkv_kernel_setup6:
  s_cmp_lg_u32 s79, 6
  s_cbranch_scc1 k1_qkv_kernel_setup7
  s_mov_b32 s72, 0xb942a831
  s_mov_b32 s73, 0xfd67ec5
  s_mul_i32 s80, s34, 21
  s_add_u32 s80, s80, s33
  s_add_u32 s80, s80, 512
  s_mul_i32 s81, s34, 22
  s_add_u32 s81, s81, s33
  s_mul_i32 s82, s34, 23
  s_add_u32 s82, s82, s33
  s_mul_i32 s83, s34, 23
  s_add_u32 s83, s83, s33
  s_add_u32 s83, s83, 512
  v_mov_b32 v14, s80
  v_mov_b32 v15, s81
  v_cndmask_b32 v14, v14, v15, s[74:75]
  v_mov_b32 v15, s82
  v_cndmask_b32 v14, v14, v15, s[92:93]
  v_mov_b32 v15, s83
  v_cndmask_b32 v14, v14, v15, s[94:95]
  v_add_u32 v50, v14, v12
  s_mul_i32 s80, s34, 22
  s_add_u32 s80, s80, s33
  s_add_u32 s80, s80, 512
  s_mul_i32 s81, s34, 24
  s_add_u32 s81, s81, s33
  s_mul_i32 s82, s34, 24
  s_add_u32 s82, s82, s33
  s_add_u32 s82, s82, 512
  s_mov_b32 s83, 2147418112
  v_mov_b32 v14, s80
  v_mov_b32 v15, s81
  v_cndmask_b32 v14, v14, v15, s[74:75]
  v_mov_b32 v15, s82
  v_cndmask_b32 v14, v14, v15, s[92:93]
  v_mov_b32 v15, s83
  v_cndmask_b32 v14, v14, v15, s[94:95]
  v_add_u32 v51, v14, v12
  s_mul_i32 s84, s34, 22
  s_add_u32 s84, s84, s33
  s_add_u32 s84, s84, s38
  s_add_u32 s84, s84, s36
  s_add_u32 s85, s84, s34
  s_mul_i32 s86, s34, 21
  s_add_u32 s86, s86, s33
  s_add_u32 s86, s86, s38
  s_add_u32 s86, s86, 8
  s_branch k1_qkv_kernel_setup_done
k1_qkv_kernel_setup7:
  s_cmp_lg_u32 s79, 7
  s_cbranch_scc1 k1_qkv_kernel_setup8
  s_mov_b32 s72, 0xdb42ca31
  s_mov_b32 s73, 0x9f860e75
  s_mul_i32 s80, s34, 25
  s_add_u32 s80, s80, s33
  s_mul_i32 s81, s34, 25
  s_add_u32 s81, s81, s33
  s_add_u32 s81, s81, 512
  s_mul_i32 s82, s34, 27
  s_add_u32 s82, s82, s33
  s_mul_i32 s83, s34, 27
  s_add_u32 s83, s83, s33
  s_add_u32 s83, s83, 512
  v_mov_b32 v14, s80
  v_mov_b32 v15, s81
  v_cndmask_b32 v14, v14, v15, s[74:75]
  v_mov_b32 v15, s82
  v_cndmask_b32 v14, v14, v15, s[92:93]
  v_mov_b32 v15, s83
  v_cndmask_b32 v14, v14, v15, s[94:95]
  v_add_u32 v50, v14, v12
  s_mul_i32 s80, s34, 26
  s_add_u32 s80, s80, s33
  s_mul_i32 s81, s34, 26
  s_add_u32 s81, s81, s33
  s_add_u32 s81, s81, 512
  s_mul_i32 s82, s34, 28
  s_add_u32 s82, s82, s33
  s_mov_b32 s83, 2147418112
  v_mov_b32 v14, s80
  v_mov_b32 v15, s81
  v_cndmask_b32 v14, v14, v15, s[74:75]
  v_mov_b32 v15, s82
  v_cndmask_b32 v14, v14, v15, s[92:93]
  v_mov_b32 v15, s83
  v_cndmask_b32 v14, v14, v15, s[94:95]
  v_add_u32 v51, v14, v12
  s_mul_i32 s84, s34, 24
  s_add_u32 s84, s84, s33
  s_add_u32 s84, s84, s38
  s_add_u32 s84, s84, s36
  s_add_u32 s85, s84, s34
  s_mul_i32 s86, s34, 26
  s_add_u32 s86, s86, s33
  s_add_u32 s86, s86, s38
  s_add_u32 s86, s86, s36
  s_add_u32 s87, s86, s34
  s_branch k1_qkv_kernel_setup_done
k1_qkv_kernel_setup8:
  s_mov_b32 s72, 0xf641e530
  s_mov_b32 s73, 0xbda82c97
  s_mul_i32 s80, s34, 28
  s_add_u32 s80, s80, s33
  s_add_u32 s80, s80, 512
  s_mul_i32 s81, s34, 29
  s_add_u32 s81, s81, s33
  s_mul_i32 s82, s34, 29
  s_add_u32 s82, s82, s33
  s_add_u32 s82, s82, 512
  s_mul_i32 s83, s34, 31
  s_add_u32 s83, s83, s33
  s_add_u32 s83, s83, 512
  v_mov_b32 v14, s80
  v_mov_b32 v15, s81
  v_cndmask_b32 v14, v14, v15, s[74:75]
  v_mov_b32 v15, s82
  v_cndmask_b32 v14, v14, v15, s[92:93]
  v_mov_b32 v15, s83
  v_cndmask_b32 v14, v14, v15, s[94:95]
  v_add_u32 v50, v14, v12
  s_mul_i32 s80, s34, 30
  s_add_u32 s80, s80, s33
  s_mul_i32 s81, s34, 30
  s_add_u32 s81, s81, s33
  s_add_u32 s81, s81, 512
  s_mul_i32 s82, s34, 31
  s_add_u32 s82, s82, s33
  s_mov_b32 s83, 2147418112
  v_mov_b32 v14, s80
  v_mov_b32 v15, s81
  v_cndmask_b32 v14, v14, v15, s[74:75]
  v_mov_b32 v15, s82
  v_cndmask_b32 v14, v14, v15, s[92:93]
  v_mov_b32 v15, s83
  v_cndmask_b32 v14, v14, v15, s[94:95]
  v_add_u32 v51, v14, v12
  s_mul_i32 s84, s34, 28
  s_add_u32 s84, s84, s33
  s_add_u32 s84, s84, s38
  s_add_u32 s84, s84, s36
  s_add_u32 s85, s84, s34
  s_mul_i32 s86, s34, 30
  s_add_u32 s86, s86, s33
  s_add_u32 s86, s86, s38
  s_add_u32 s86, s86, s36
  s_add_u32 s87, s86, s34
  s_branch k1_qkv_kernel_setup_done
k1_qkv_kernel_vsetup:
  s_lshl_b32 s6, s4, 7
  s_lshl_b32 s7, s29, 6
  s_add_u32 s6, s6, s7
  s_sub_u32 s32, s6, 1152
  s_cmp_eq_u32 s26, 1
  s_mov_b32 s33, 8389632
  s_cselect_b32 s33, 1024, s33
  s_lshl_b32 s6, s3, 3
  s_lshl_b32 s7, s28, 1
  s_add_u32 s6, s6, s7
  s_mul_i32 s38, s6, 2368
  s_add_u32 s39, s38, 2368
  s_mov_b32 s34, 151552
  v_lshrrev_b32 v12, 4, v1
  v_and_b32 v11, 15, v1
  v_add_u32 v11, s32, v11
  v_add_u32 v13, 0, v11
  v_mul_u32_u24 v14, 3641, v13
  v_lshrrev_b32 v14, 16, v14
  v_mul_u32_u24 v15, 18, v14
  v_sub_u32 v15, v13, v15
  v_mul_lo_u32 v14, v14, s34
  v_lshl_add_u32 v14, v15, 6, v14
  v_lshrrev_b32 v13, 2, v15
  v_add_u32 v13, v13, v12
  v_and_b32 v13, 3, v13
  v_lshlrev_b32 v13, 4, v13
  v_add3_u32 v50, v13, v14, s33
  v_add_u32 v13, 16, v11
  v_mul_u32_u24 v14, 3641, v13
  v_lshrrev_b32 v14, 16, v14
  v_mul_u32_u24 v15, 18, v14
  v_sub_u32 v15, v13, v15
  v_mul_lo_u32 v14, v14, s34
  v_lshl_add_u32 v14, v15, 6, v14
  v_lshrrev_b32 v13, 2, v15
  v_add_u32 v13, v13, v12
  v_and_b32 v13, 3, v13
  v_lshlrev_b32 v13, 4, v13
  v_add3_u32 v51, v13, v14, s33
  v_add_u32 v13, 32, v11
  v_mul_u32_u24 v14, 3641, v13
  v_lshrrev_b32 v14, 16, v14
  v_mul_u32_u24 v15, 18, v14
  v_sub_u32 v15, v13, v15
  v_mul_lo_u32 v14, v14, s34
  v_lshl_add_u32 v14, v15, 6, v14
  v_lshrrev_b32 v13, 2, v15
  v_add_u32 v13, v13, v12
  v_and_b32 v13, 3, v13
  v_lshlrev_b32 v13, 4, v13
  v_add3_u32 v52, v13, v14, s33
  v_add_u32 v13, 48, v11
  v_mul_u32_u24 v14, 3641, v13
  v_lshrrev_b32 v14, 16, v14
  v_mul_u32_u24 v15, 18, v14
  v_sub_u32 v15, v13, v15
  v_mul_lo_u32 v14, v14, s34
  v_lshl_add_u32 v14, v15, 6, v14
  v_lshrrev_b32 v13, 2, v15
  v_add_u32 v13, v13, v12
  v_and_b32 v13, 3, v13
  v_lshlrev_b32 v13, 4, v13
  v_add3_u32 v53, v13, v14, s33
  s_mul_i32 s6, s32, 3641
  s_lshr_b32 s6, s6, 16
  v_lshrrev_b32 v11, 3, v1
  v_add_u32 v11, s6, v11
  v_mul_u32_u24 v12, 18, v11
  v_add_u32 v12, 17, v12
  v_mul_lo_u32 v11, v11, s34
  v_bfe_u32 v13, v1, 2, 1
  v_mul_u32_u24 v13, 2368, v13
  v_add_u32 v11, v11, v13
  v_and_b32 v13, 3, v1
  v_lshlrev_b32 v13, 4, v13
  v_add3_u32 v11, v11, v13, s33
  v_add_u32 v11, 1152, v11
  s_add_u32 s6, s32, 64
  v_mov_b32 v13, 2147418112
  v_cmp_gt_u32 vcc, s6, v12
  v_mov_b32 v56, 0x3f803f80
  v_mov_b32 v57, 0x3f803f80
  v_mov_b32 v58, 0x3f803f80
  v_mov_b32 v59, 0x3f803f80
  v_cndmask_b32 v54, v13, v11, vcc
k1_qkv_kernel_setup_done:
  v_lshrrev_b32 v12, 4, v1
  v_bfe_u32 v11, v1, 2, 2
  v_lshl_add_u32 v13, v12, 3, v11
  v_lshlrev_b32 v13, 8, v13
  v_add_u32 v13, 32768, v13
  v_and_b32 v12, 1, v12
  v_lshlrev_b32 v12, 2, v12
  v_lshl_or_b32 v11, v11, 3, v12
  s_lshl_b32 s6, s29, 4
  v_xor_b32 v11, s6, v11
  v_and_b32 v12, 3, v1
  v_lshlrev_b32 v12, 2, v12
  v_add_u32 v14, 0, v12
  v_lshrrev_b32 v14, v14, s72
  v_and_b32 v14, 15, v14
  v_xor_b32 v14, v14, v11
  v_lshl_add_u32 v4, v14, 3, v13
  v_add_u32 v14, 16, v12
  v_lshrrev_b32 v14, v14, s72
  v_and_b32 v14, 15, v14
  v_xor_b32 v14, v14, v11
  v_lshl_add_u32 v5, v14, 3, v13
  v_add_u32 v14, 0, v12
  v_lshrrev_b32 v14, v14, s73
  v_and_b32 v14, 15, v14
  v_xor_b32 v14, v14, v11
  v_lshl_add_u32 v6, v14, 3, v13
  v_add_u32 v14, 16, v12
  v_lshrrev_b32 v14, v14, s73
  v_and_b32 v14, 15, v14
  v_xor_b32 v14, v14, v11
  v_lshl_add_u32 v7, v14, 3, v13
  s_waitcnt vmcnt(6)
  s_barrier
  s_cmp_eq_u32 s27, 1
  s_cbranch_scc1 k1_qkv_kernel_vtype
  ds_read_b64_tr_b16 v[128:129], v4 offset:0
  ds_read_b64_tr_b16 v[130:131], v4 offset:1024
  ds_read_b128 v[16:19], v2 offset:0
  ds_read_b64_tr_b16 v[132:133], v5 offset:0
  ds_read_b64_tr_b16 v[134:135], v5 offset:1024
  ds_read_b64_tr_b16 v[136:137], v6 offset:0
  ds_read_b64_tr_b16 v[138:139], v6 offset:1024
  ds_read_b64_tr_b16 v[140:141], v7 offset:0
  ds_read_b64_tr_b16 v[142:143], v7 offset:1024
  ds_read_b128 v[20:23], v2 offset:2048
  ds_read_b128 v[24:27], v2 offset:4096
  ds_read_b128 v[28:31], v2 offset:6144
  s_waitcnt lgkmcnt(0)
  v_mfma_f32_16x16x32_bf16 v[64:67], v[128:131], v[16:19], 0
  ds_read_b64_tr_b16 v[144:145], v4 offset:8192
  v_mfma_f32_16x16x32_bf16 v[68:71], v[132:135], v[16:19], 0
  ds_read_b64_tr_b16 v[146:147], v4 offset:9216
  s_add_u32 s30, s23, 442368
  s_add_u32 m0, s25, 98304
  v_mfma_f32_16x16x32_bf16 v[72:75], v[136:139], v[16:19], 0
  ds_read_b128 v[32:35], v3 offset:0
  buffer_load_dwordx4 v10, s[12:15], s30 offen  lds
  v_mfma_f32_16x16x32_bf16 v[76:79], v[140:143], v[16:19], 0
  ds_read_b64_tr_b16 v[148:149], v5 offset:8192
  s_add_u32 s30, s23, 456192
  s_add_u32 m0, s25, 99328
  v_mfma_f32_16x16x32_bf16 v[92:95], v[140:143], v[20:23], 0
  ds_read_b64_tr_b16 v[150:151], v5 offset:9216
  buffer_load_dwordx4 v10, s[12:15], s30 offen  lds
  v_mfma_f32_16x16x32_bf16 v[88:91], v[136:139], v[20:23], 0
  ds_read_b64_tr_b16 v[152:153], v6 offset:8192
  v_mfma_f32_16x16x32_bf16 v[84:87], v[132:135], v[20:23], 0
  ds_read_b64_tr_b16 v[154:155], v6 offset:9216
  s_add_u32 s30, s22, 256
  s_add_u32 m0, s24, 98304
  v_mfma_f32_16x16x32_bf16 v[80:83], v[128:131], v[20:23], 0
  ds_read_b64_tr_b16 v[156:157], v7 offset:8192
  buffer_load_dwordx4 v8, s[8:11], s30 offen  lds
  v_mfma_f32_16x16x32_bf16 v[96:99], v[128:131], v[24:27], 0
  ds_read_b64_tr_b16 v[158:159], v7 offset:9216
  s_add_u32 s30, s22, 9472
  s_add_u32 m0, s24, 99328
  v_mfma_f32_16x16x32_bf16 v[100:103], v[132:135], v[24:27], 0
  ds_read_b128 v[36:39], v3 offset:2048
  buffer_load_dwordx4 v48, s[8:11], s30 offen  lds
  v_mfma_f32_16x16x32_bf16 v[104:107], v[136:139], v[24:27], 0
  ds_read_b128 v[40:43], v3 offset:4096
  v_mfma_f32_16x16x32_bf16 v[108:111], v[140:143], v[24:27], 0
  ds_read_b128 v[44:47], v3 offset:6144
  s_add_u32 s30, s22, 18688
  s_add_u32 m0, s24, 100352
  v_mfma_f32_16x16x32_bf16 v[124:127], v[140:143], v[28:31], 0
  buffer_load_dwordx4 v49, s[8:11], s30 offen  lds
  v_mfma_f32_16x16x32_bf16 v[120:123], v[136:139], v[28:31], 0
  s_add_u32 s30, s22, 27904
  s_add_u32 m0, s24, 101376
  v_mfma_f32_16x16x32_bf16 v[116:119], v[132:135], v[28:31], 0
  buffer_load_dwordx4 v9, s[8:11], s30 offen  lds
  v_mfma_f32_16x16x32_bf16 v[112:115], v[128:131], v[28:31], 0
  s_waitcnt lgkmcnt(0)
  s_waitcnt vmcnt(6)
  s_barrier
  v_add_u32 v2, 49152, v2
  v_add_u32 v3, 49152, v3
  v_add_u32 v4, 49152, v4
  v_add_u32 v5, 49152, v5
  v_add_u32 v6, 49152, v6
  v_add_u32 v7, 49152, v7
  v_mfma_f32_16x16x32_bf16 v[64:67], v[144:147], v[32:35], v[64:67]
  ds_read_b64_tr_b16 v[128:129], v4 offset:0
  v_mfma_f32_16x16x32_bf16 v[68:71], v[148:151], v[32:35], v[68:71]
  ds_read_b64_tr_b16 v[130:131], v4 offset:1024
  s_add_u32 s30, s23, 663552
  s_add_u32 m0, s25, 0
  v_mfma_f32_16x16x32_bf16 v[72:75], v[152:155], v[32:35], v[72:75]
  ds_read_b128 v[16:19], v2 offset:0
  buffer_load_dwordx4 v10, s[12:15], s30 offen  lds
  v_mfma_f32_16x16x32_bf16 v[76:79], v[156:159], v[32:35], v[76:79]
  ds_read_b64_tr_b16 v[132:133], v5 offset:0
  s_add_u32 s30, s23, 677376
  s_add_u32 m0, s25, 1024
  v_mfma_f32_16x16x32_bf16 v[92:95], v[156:159], v[36:39], v[92:95]
  ds_read_b64_tr_b16 v[134:135], v5 offset:1024
  buffer_load_dwordx4 v10, s[12:15], s30 offen  lds
  v_mfma_f32_16x16x32_bf16 v[88:91], v[152:155], v[36:39], v[88:91]
  ds_read_b64_tr_b16 v[136:137], v6 offset:0
  v_mfma_f32_16x16x32_bf16 v[84:87], v[148:151], v[36:39], v[84:87]
  ds_read_b64_tr_b16 v[138:139], v6 offset:1024
  s_add_u32 s30, s22, 384
  s_add_u32 m0, s24, 0
  v_mfma_f32_16x16x32_bf16 v[80:83], v[144:147], v[36:39], v[80:83]
  ds_read_b64_tr_b16 v[140:141], v7 offset:0
  buffer_load_dwordx4 v8, s[8:11], s30 offen  lds
  v_mfma_f32_16x16x32_bf16 v[96:99], v[144:147], v[40:43], v[96:99]
  ds_read_b64_tr_b16 v[142:143], v7 offset:1024
  s_add_u32 s30, s22, 9600
  s_add_u32 m0, s24, 1024
  v_mfma_f32_16x16x32_bf16 v[100:103], v[148:151], v[40:43], v[100:103]
  ds_read_b128 v[20:23], v2 offset:2048
  buffer_load_dwordx4 v48, s[8:11], s30 offen  lds
  v_mfma_f32_16x16x32_bf16 v[104:107], v[152:155], v[40:43], v[104:107]
  ds_read_b128 v[24:27], v2 offset:4096
  v_mfma_f32_16x16x32_bf16 v[108:111], v[156:159], v[40:43], v[108:111]
  ds_read_b128 v[28:31], v2 offset:6144
  s_add_u32 s30, s22, 18816
  s_add_u32 m0, s24, 2048
  v_mfma_f32_16x16x32_bf16 v[124:127], v[156:159], v[44:47], v[124:127]
  buffer_load_dwordx4 v49, s[8:11], s30 offen  lds
  v_mfma_f32_16x16x32_bf16 v[120:123], v[152:155], v[44:47], v[120:123]
  s_add_u32 s30, s22, 28032
  s_add_u32 m0, s24, 3072
  v_mfma_f32_16x16x32_bf16 v[116:119], v[148:151], v[44:47], v[116:119]
  buffer_load_dwordx4 v9, s[8:11], s30 offen  lds
  v_mfma_f32_16x16x32_bf16 v[112:115], v[144:147], v[44:47], v[112:115]
  s_waitcnt lgkmcnt(0)
  v_mfma_f32_16x16x32_bf16 v[64:67], v[128:131], v[16:19], v[64:67]
  ds_read_b64_tr_b16 v[144:145], v4 offset:8192
  v_mfma_f32_16x16x32_bf16 v[68:71], v[132:135], v[16:19], v[68:71]
  ds_read_b64_tr_b16 v[146:147], v4 offset:9216
  v_mfma_f32_16x16x32_bf16 v[72:75], v[136:139], v[16:19], v[72:75]
  ds_read_b128 v[32:35], v3 offset:0
  v_mfma_f32_16x16x32_bf16 v[76:79], v[140:143], v[16:19], v[76:79]
  ds_read_b64_tr_b16 v[148:149], v5 offset:8192
  v_mfma_f32_16x16x32_bf16 v[92:95], v[140:143], v[20:23], v[92:95]
  ds_read_b64_tr_b16 v[150:151], v5 offset:9216
  v_mfma_f32_16x16x32_bf16 v[88:91], v[136:139], v[20:23], v[88:91]
  ds_read_b64_tr_b16 v[152:153], v6 offset:8192
  v_mfma_f32_16x16x32_bf16 v[84:87], v[132:135], v[20:23], v[84:87]
  ds_read_b64_tr_b16 v[154:155], v6 offset:9216
  v_mfma_f32_16x16x32_bf16 v[80:83], v[128:131], v[20:23], v[80:83]
  ds_read_b64_tr_b16 v[156:157], v7 offset:8192
  v_mfma_f32_16x16x32_bf16 v[96:99], v[128:131], v[24:27], v[96:99]
  ds_read_b64_tr_b16 v[158:159], v7 offset:9216
  v_mfma_f32_16x16x32_bf16 v[100:103], v[132:135], v[24:27], v[100:103]
  ds_read_b128 v[36:39], v3 offset:2048
  v_mfma_f32_16x16x32_bf16 v[104:107], v[136:139], v[24:27], v[104:107]
  ds_read_b128 v[40:43], v3 offset:4096
  v_mfma_f32_16x16x32_bf16 v[108:111], v[140:143], v[24:27], v[108:111]
  ds_read_b128 v[44:47], v3 offset:6144
  v_mfma_f32_16x16x32_bf16 v[124:127], v[140:143], v[28:31], v[124:127]
  v_mfma_f32_16x16x32_bf16 v[120:123], v[136:139], v[28:31], v[120:123]
  v_mfma_f32_16x16x32_bf16 v[116:119], v[132:135], v[28:31], v[116:119]
  v_mfma_f32_16x16x32_bf16 v[112:115], v[128:131], v[28:31], v[112:115]
  s_waitcnt lgkmcnt(0)
  s_waitcnt vmcnt(6)
  s_barrier
  v_add_u32 v2, 49152, v2
  v_add_u32 v3, 49152, v3
  v_add_u32 v4, 49152, v4
  v_add_u32 v5, 49152, v5
  v_add_u32 v6, 49152, v6
  v_add_u32 v7, 49152, v7
  v_mfma_f32_16x16x32_bf16 v[64:67], v[144:147], v[32:35], v[64:67]
  ds_read_b64_tr_b16 v[128:129], v4 offset:0
  v_mfma_f32_16x16x32_bf16 v[68:71], v[148:151], v[32:35], v[68:71]
  ds_read_b64_tr_b16 v[130:131], v4 offset:1024
  v_mfma_f32_16x16x32_bf16 v[72:75], v[152:155], v[32:35], v[72:75]
  ds_read_b128 v[16:19], v2 offset:0
  v_mfma_f32_16x16x32_bf16 v[76:79], v[156:159], v[32:35], v[76:79]
  ds_read_b64_tr_b16 v[132:133], v5 offset:0
  s_add_u32 s30, s23, 884736
  s_add_u32 m0, s25, 49152
  v_mfma_f32_16x16x32_bf16 v[92:95], v[156:159], v[36:39], v[92:95]
  ds_read_b64_tr_b16 v[134:135], v5 offset:1024
  buffer_load_dwordx4 v10, s[12:15], s30 offen  lds
  v_mfma_f32_16x16x32_bf16 v[88:91], v[152:155], v[36:39], v[88:91]
  ds_read_b64_tr_b16 v[136:137], v6 offset:0
  v_mfma_f32_16x16x32_bf16 v[84:87], v[148:151], v[36:39], v[84:87]
  ds_read_b64_tr_b16 v[138:139], v6 offset:1024
  v_mfma_f32_16x16x32_bf16 v[80:83], v[144:147], v[36:39], v[80:83]
  ds_read_b64_tr_b16 v[140:141], v7 offset:0
  v_mfma_f32_16x16x32_bf16 v[96:99], v[144:147], v[40:43], v[96:99]
  ds_read_b64_tr_b16 v[142:143], v7 offset:1024
  s_add_u32 s30, s23, 898560
  s_add_u32 m0, s25, 50176
  v_mfma_f32_16x16x32_bf16 v[100:103], v[148:151], v[40:43], v[100:103]
  ds_read_b128 v[20:23], v2 offset:2048
  buffer_load_dwordx4 v10, s[12:15], s30 offen  lds
  v_mfma_f32_16x16x32_bf16 v[104:107], v[152:155], v[40:43], v[104:107]
  ds_read_b128 v[24:27], v2 offset:4096
  v_mfma_f32_16x16x32_bf16 v[108:111], v[156:159], v[40:43], v[108:111]
  ds_read_b128 v[28:31], v2 offset:6144
  v_mfma_f32_16x16x32_bf16 v[124:127], v[156:159], v[44:47], v[124:127]
  v_mfma_f32_16x16x32_bf16 v[120:123], v[152:155], v[44:47], v[120:123]
  s_add_u32 s30, s22, 512
  s_add_u32 m0, s24, 49152
  v_mfma_f32_16x16x32_bf16 v[116:119], v[148:151], v[44:47], v[116:119]
  buffer_load_dwordx4 v8, s[8:11], s30 offen  lds
  v_mfma_f32_16x16x32_bf16 v[112:115], v[144:147], v[44:47], v[112:115]
  s_waitcnt lgkmcnt(0)
  v_mfma_f32_16x16x32_bf16 v[64:67], v[128:131], v[16:19], v[64:67]
  ds_read_b64_tr_b16 v[144:145], v4 offset:8192
  v_mfma_f32_16x16x32_bf16 v[68:71], v[132:135], v[16:19], v[68:71]
  ds_read_b64_tr_b16 v[146:147], v4 offset:9216
  v_mfma_f32_16x16x32_bf16 v[72:75], v[136:139], v[16:19], v[72:75]
  ds_read_b128 v[32:35], v3 offset:0
  v_mfma_f32_16x16x32_bf16 v[76:79], v[140:143], v[16:19], v[76:79]
  ds_read_b64_tr_b16 v[148:149], v5 offset:8192
  s_add_u32 s30, s22, 9728
  s_add_u32 m0, s24, 50176
  v_mfma_f32_16x16x32_bf16 v[92:95], v[140:143], v[20:23], v[92:95]
  ds_read_b64_tr_b16 v[150:151], v5 offset:9216
  buffer_load_dwordx4 v48, s[8:11], s30 offen  lds
  v_mfma_f32_16x16x32_bf16 v[88:91], v[136:139], v[20:23], v[88:91]
  ds_read_b64_tr_b16 v[152:153], v6 offset:8192
  v_mfma_f32_16x16x32_bf16 v[84:87], v[132:135], v[20:23], v[84:87]
  ds_read_b64_tr_b16 v[154:155], v6 offset:9216
  v_mfma_f32_16x16x32_bf16 v[80:83], v[128:131], v[20:23], v[80:83]
  ds_read_b64_tr_b16 v[156:157], v7 offset:8192
  v_mfma_f32_16x16x32_bf16 v[96:99], v[128:131], v[24:27], v[96:99]
  ds_read_b64_tr_b16 v[158:159], v7 offset:9216
  s_add_u32 s30, s22, 18944
  s_add_u32 m0, s24, 51200
  v_mfma_f32_16x16x32_bf16 v[100:103], v[132:135], v[24:27], v[100:103]
  ds_read_b128 v[36:39], v3 offset:2048
  buffer_load_dwordx4 v49, s[8:11], s30 offen  lds
  v_mfma_f32_16x16x32_bf16 v[104:107], v[136:139], v[24:27], v[104:107]
  ds_read_b128 v[40:43], v3 offset:4096
  v_mfma_f32_16x16x32_bf16 v[108:111], v[140:143], v[24:27], v[108:111]
  ds_read_b128 v[44:47], v3 offset:6144
  v_mfma_f32_16x16x32_bf16 v[124:127], v[140:143], v[28:31], v[124:127]
  v_mfma_f32_16x16x32_bf16 v[120:123], v[136:139], v[28:31], v[120:123]
  s_add_u32 s30, s22, 28160
  s_add_u32 m0, s24, 52224
  v_mfma_f32_16x16x32_bf16 v[116:119], v[132:135], v[28:31], v[116:119]
  buffer_load_dwordx4 v9, s[8:11], s30 offen  lds
  v_mfma_f32_16x16x32_bf16 v[112:115], v[128:131], v[28:31], v[112:115]
  s_waitcnt lgkmcnt(0)
  s_waitcnt vmcnt(6)
  s_barrier
  v_subrev_u32 v2, 98304, v2
  v_subrev_u32 v3, 98304, v3
  v_subrev_u32 v4, 98304, v4
  v_subrev_u32 v5, 98304, v5
  v_subrev_u32 v6, 98304, v6
  v_subrev_u32 v7, 98304, v7
  v_mfma_f32_16x16x32_bf16 v[64:67], v[144:147], v[32:35], v[64:67]
  ds_read_b64_tr_b16 v[128:129], v4 offset:0
  v_mfma_f32_16x16x32_bf16 v[68:71], v[148:151], v[32:35], v[68:71]
  ds_read_b64_tr_b16 v[130:131], v4 offset:1024
  v_mfma_f32_16x16x32_bf16 v[72:75], v[152:155], v[32:35], v[72:75]
  ds_read_b128 v[16:19], v2 offset:0
  v_mfma_f32_16x16x32_bf16 v[76:79], v[156:159], v[32:35], v[76:79]
  ds_read_b64_tr_b16 v[132:133], v5 offset:0
  s_add_u32 s30, s23, 1105920
  s_add_u32 m0, s25, 98304
  v_mfma_f32_16x16x32_bf16 v[92:95], v[156:159], v[36:39], v[92:95]
  ds_read_b64_tr_b16 v[134:135], v5 offset:1024
  buffer_load_dwordx4 v10, s[12:15], s30 offen  lds
  v_mfma_f32_16x16x32_bf16 v[88:91], v[152:155], v[36:39], v[88:91]
  ds_read_b64_tr_b16 v[136:137], v6 offset:0
  v_mfma_f32_16x16x32_bf16 v[84:87], v[148:151], v[36:39], v[84:87]
  ds_read_b64_tr_b16 v[138:139], v6 offset:1024
  v_mfma_f32_16x16x32_bf16 v[80:83], v[144:147], v[36:39], v[80:83]
  ds_read_b64_tr_b16 v[140:141], v7 offset:0
  v_mfma_f32_16x16x32_bf16 v[96:99], v[144:147], v[40:43], v[96:99]
  ds_read_b64_tr_b16 v[142:143], v7 offset:1024
  s_add_u32 s30, s23, 1119744
  s_add_u32 m0, s25, 99328
  v_mfma_f32_16x16x32_bf16 v[100:103], v[148:151], v[40:43], v[100:103]
  ds_read_b128 v[20:23], v2 offset:2048
  buffer_load_dwordx4 v10, s[12:15], s30 offen  lds
  v_mfma_f32_16x16x32_bf16 v[104:107], v[152:155], v[40:43], v[104:107]
  ds_read_b128 v[24:27], v2 offset:4096
  v_mfma_f32_16x16x32_bf16 v[108:111], v[156:159], v[40:43], v[108:111]
  ds_read_b128 v[28:31], v2 offset:6144
  v_mfma_f32_16x16x32_bf16 v[124:127], v[156:159], v[44:47], v[124:127]
  v_mfma_f32_16x16x32_bf16 v[120:123], v[152:155], v[44:47], v[120:123]
  s_add_u32 s30, s22, 640
  s_add_u32 m0, s24, 98304
  v_mfma_f32_16x16x32_bf16 v[116:119], v[148:151], v[44:47], v[116:119]
  buffer_load_dwordx4 v8, s[8:11], s30 offen  lds
  v_mfma_f32_16x16x32_bf16 v[112:115], v[144:147], v[44:47], v[112:115]
  s_waitcnt lgkmcnt(0)
  v_mfma_f32_16x16x32_bf16 v[64:67], v[128:131], v[16:19], v[64:67]
  ds_read_b64_tr_b16 v[144:145], v4 offset:8192
  v_mfma_f32_16x16x32_bf16 v[68:71], v[132:135], v[16:19], v[68:71]
  ds_read_b64_tr_b16 v[146:147], v4 offset:9216
  v_mfma_f32_16x16x32_bf16 v[72:75], v[136:139], v[16:19], v[72:75]
  ds_read_b128 v[32:35], v3 offset:0
  v_mfma_f32_16x16x32_bf16 v[76:79], v[140:143], v[16:19], v[76:79]
  ds_read_b64_tr_b16 v[148:149], v5 offset:8192
  s_add_u32 s30, s22, 9856
  s_add_u32 m0, s24, 99328
  v_mfma_f32_16x16x32_bf16 v[92:95], v[140:143], v[20:23], v[92:95]
  ds_read_b64_tr_b16 v[150:151], v5 offset:9216
  buffer_load_dwordx4 v48, s[8:11], s30 offen  lds
  v_mfma_f32_16x16x32_bf16 v[88:91], v[136:139], v[20:23], v[88:91]
  ds_read_b64_tr_b16 v[152:153], v6 offset:8192
  v_mfma_f32_16x16x32_bf16 v[84:87], v[132:135], v[20:23], v[84:87]
  ds_read_b64_tr_b16 v[154:155], v6 offset:9216
  v_mfma_f32_16x16x32_bf16 v[80:83], v[128:131], v[20:23], v[80:83]
  ds_read_b64_tr_b16 v[156:157], v7 offset:8192
  v_mfma_f32_16x16x32_bf16 v[96:99], v[128:131], v[24:27], v[96:99]
  ds_read_b64_tr_b16 v[158:159], v7 offset:9216
  s_add_u32 s30, s22, 19072
  s_add_u32 m0, s24, 100352
  v_mfma_f32_16x16x32_bf16 v[100:103], v[132:135], v[24:27], v[100:103]
  ds_read_b128 v[36:39], v3 offset:2048
  buffer_load_dwordx4 v49, s[8:11], s30 offen  lds
  v_mfma_f32_16x16x32_bf16 v[104:107], v[136:139], v[24:27], v[104:107]
  ds_read_b128 v[40:43], v3 offset:4096
  v_mfma_f32_16x16x32_bf16 v[108:111], v[140:143], v[24:27], v[108:111]
  ds_read_b128 v[44:47], v3 offset:6144
  v_mfma_f32_16x16x32_bf16 v[124:127], v[140:143], v[28:31], v[124:127]
  v_mfma_f32_16x16x32_bf16 v[120:123], v[136:139], v[28:31], v[120:123]
  s_add_u32 s30, s22, 28288
  s_add_u32 m0, s24, 101376
  v_mfma_f32_16x16x32_bf16 v[116:119], v[132:135], v[28:31], v[116:119]
  buffer_load_dwordx4 v9, s[8:11], s30 offen  lds
  v_mfma_f32_16x16x32_bf16 v[112:115], v[128:131], v[28:31], v[112:115]
  s_waitcnt lgkmcnt(0)
  s_waitcnt vmcnt(6)
  s_barrier
  v_add_u32 v2, 49152, v2
  v_add_u32 v3, 49152, v3
  v_add_u32 v4, 49152, v4
  v_add_u32 v5, 49152, v5
  v_add_u32 v6, 49152, v6
  v_add_u32 v7, 49152, v7
  v_mfma_f32_16x16x32_bf16 v[64:67], v[144:147], v[32:35], v[64:67]
  ds_read_b64_tr_b16 v[128:129], v4 offset:0
  v_mfma_f32_16x16x32_bf16 v[68:71], v[148:151], v[32:35], v[68:71]
  ds_read_b64_tr_b16 v[130:131], v4 offset:1024
  v_mfma_f32_16x16x32_bf16 v[72:75], v[152:155], v[32:35], v[72:75]
  ds_read_b128 v[16:19], v2 offset:0
  v_mfma_f32_16x16x32_bf16 v[76:79], v[156:159], v[32:35], v[76:79]
  ds_read_b64_tr_b16 v[132:133], v5 offset:0
  s_add_u32 s30, s23, 1327104
  s_add_u32 m0, s25, 0
  v_mfma_f32_16x16x32_bf16 v[92:95], v[156:159], v[36:39], v[92:95]
  ds_read_b64_tr_b16 v[134:135], v5 offset:1024
  buffer_load_dwordx4 v10, s[12:15], s30 offen  lds
  v_mfma_f32_16x16x32_bf16 v[88:91], v[152:155], v[36:39], v[88:91]
  ds_read_b64_tr_b16 v[136:137], v6 offset:0
  v_mfma_f32_16x16x32_bf16 v[84:87], v[148:151], v[36:39], v[84:87]
  ds_read_b64_tr_b16 v[138:139], v6 offset:1024
  v_mfma_f32_16x16x32_bf16 v[80:83], v[144:147], v[36:39], v[80:83]
  ds_read_b64_tr_b16 v[140:141], v7 offset:0
  v_mfma_f32_16x16x32_bf16 v[96:99], v[144:147], v[40:43], v[96:99]
  ds_read_b64_tr_b16 v[142:143], v7 offset:1024
  s_add_u32 s30, s23, 1340928
  s_add_u32 m0, s25, 1024
  v_mfma_f32_16x16x32_bf16 v[100:103], v[148:151], v[40:43], v[100:103]
  ds_read_b128 v[20:23], v2 offset:2048
  buffer_load_dwordx4 v10, s[12:15], s30 offen  lds
  v_mfma_f32_16x16x32_bf16 v[104:107], v[152:155], v[40:43], v[104:107]
  ds_read_b128 v[24:27], v2 offset:4096
  v_mfma_f32_16x16x32_bf16 v[108:111], v[156:159], v[40:43], v[108:111]
  ds_read_b128 v[28:31], v2 offset:6144
  v_mfma_f32_16x16x32_bf16 v[124:127], v[156:159], v[44:47], v[124:127]
  v_mfma_f32_16x16x32_bf16 v[120:123], v[152:155], v[44:47], v[120:123]
  s_add_u32 s30, s22, 768
  s_add_u32 m0, s24, 0
  v_mfma_f32_16x16x32_bf16 v[116:119], v[148:151], v[44:47], v[116:119]
  buffer_load_dwordx4 v8, s[8:11], s30 offen  lds
  v_mfma_f32_16x16x32_bf16 v[112:115], v[144:147], v[44:47], v[112:115]
  s_waitcnt lgkmcnt(0)
  v_mfma_f32_16x16x32_bf16 v[64:67], v[128:131], v[16:19], v[64:67]
  ds_read_b64_tr_b16 v[144:145], v4 offset:8192
  v_mfma_f32_16x16x32_bf16 v[68:71], v[132:135], v[16:19], v[68:71]
  ds_read_b64_tr_b16 v[146:147], v4 offset:9216
  v_mfma_f32_16x16x32_bf16 v[72:75], v[136:139], v[16:19], v[72:75]
  ds_read_b128 v[32:35], v3 offset:0
  v_mfma_f32_16x16x32_bf16 v[76:79], v[140:143], v[16:19], v[76:79]
  ds_read_b64_tr_b16 v[148:149], v5 offset:8192
  s_add_u32 s30, s22, 9984
  s_add_u32 m0, s24, 1024
  v_mfma_f32_16x16x32_bf16 v[92:95], v[140:143], v[20:23], v[92:95]
  ds_read_b64_tr_b16 v[150:151], v5 offset:9216
  buffer_load_dwordx4 v48, s[8:11], s30 offen  lds
  v_mfma_f32_16x16x32_bf16 v[88:91], v[136:139], v[20:23], v[88:91]
  ds_read_b64_tr_b16 v[152:153], v6 offset:8192
  v_mfma_f32_16x16x32_bf16 v[84:87], v[132:135], v[20:23], v[84:87]
  ds_read_b64_tr_b16 v[154:155], v6 offset:9216
  v_mfma_f32_16x16x32_bf16 v[80:83], v[128:131], v[20:23], v[80:83]
  ds_read_b64_tr_b16 v[156:157], v7 offset:8192
  v_mfma_f32_16x16x32_bf16 v[96:99], v[128:131], v[24:27], v[96:99]
  ds_read_b64_tr_b16 v[158:159], v7 offset:9216
  s_add_u32 s30, s22, 19200
  s_add_u32 m0, s24, 2048
  v_mfma_f32_16x16x32_bf16 v[100:103], v[132:135], v[24:27], v[100:103]
  ds_read_b128 v[36:39], v3 offset:2048
  buffer_load_dwordx4 v49, s[8:11], s30 offen  lds
  v_mfma_f32_16x16x32_bf16 v[104:107], v[136:139], v[24:27], v[104:107]
  ds_read_b128 v[40:43], v3 offset:4096
  v_mfma_f32_16x16x32_bf16 v[108:111], v[140:143], v[24:27], v[108:111]
  ds_read_b128 v[44:47], v3 offset:6144
  v_mfma_f32_16x16x32_bf16 v[124:127], v[140:143], v[28:31], v[124:127]
  v_mfma_f32_16x16x32_bf16 v[120:123], v[136:139], v[28:31], v[120:123]
  s_add_u32 s30, s22, 28416
  s_add_u32 m0, s24, 3072
  v_mfma_f32_16x16x32_bf16 v[116:119], v[132:135], v[28:31], v[116:119]
  buffer_load_dwordx4 v9, s[8:11], s30 offen  lds
  v_mfma_f32_16x16x32_bf16 v[112:115], v[128:131], v[28:31], v[112:115]
  s_waitcnt lgkmcnt(0)
  s_waitcnt vmcnt(6)
  s_barrier
  v_add_u32 v2, 49152, v2
  v_add_u32 v3, 49152, v3
  v_add_u32 v4, 49152, v4
  v_add_u32 v5, 49152, v5
  v_add_u32 v6, 49152, v6
  v_add_u32 v7, 49152, v7
  v_mfma_f32_16x16x32_bf16 v[64:67], v[144:147], v[32:35], v[64:67]
  ds_read_b64_tr_b16 v[128:129], v4 offset:0
  v_mfma_f32_16x16x32_bf16 v[68:71], v[148:151], v[32:35], v[68:71]
  ds_read_b64_tr_b16 v[130:131], v4 offset:1024
  v_mfma_f32_16x16x32_bf16 v[72:75], v[152:155], v[32:35], v[72:75]
  ds_read_b128 v[16:19], v2 offset:0
  v_mfma_f32_16x16x32_bf16 v[76:79], v[156:159], v[32:35], v[76:79]
  ds_read_b64_tr_b16 v[132:133], v5 offset:0
  s_add_u32 s30, s23, 1548288
  s_add_u32 m0, s25, 49152
  v_mfma_f32_16x16x32_bf16 v[92:95], v[156:159], v[36:39], v[92:95]
  ds_read_b64_tr_b16 v[134:135], v5 offset:1024
  buffer_load_dwordx4 v10, s[12:15], s30 offen  lds
  v_mfma_f32_16x16x32_bf16 v[88:91], v[152:155], v[36:39], v[88:91]
  ds_read_b64_tr_b16 v[136:137], v6 offset:0
  v_mfma_f32_16x16x32_bf16 v[84:87], v[148:151], v[36:39], v[84:87]
  ds_read_b64_tr_b16 v[138:139], v6 offset:1024
  v_mfma_f32_16x16x32_bf16 v[80:83], v[144:147], v[36:39], v[80:83]
  ds_read_b64_tr_b16 v[140:141], v7 offset:0
  v_mfma_f32_16x16x32_bf16 v[96:99], v[144:147], v[40:43], v[96:99]
  ds_read_b64_tr_b16 v[142:143], v7 offset:1024
  s_add_u32 s30, s23, 1562112
  s_add_u32 m0, s25, 50176
  v_mfma_f32_16x16x32_bf16 v[100:103], v[148:151], v[40:43], v[100:103]
  ds_read_b128 v[20:23], v2 offset:2048
  buffer_load_dwordx4 v10, s[12:15], s30 offen  lds
  v_mfma_f32_16x16x32_bf16 v[104:107], v[152:155], v[40:43], v[104:107]
  ds_read_b128 v[24:27], v2 offset:4096
  v_mfma_f32_16x16x32_bf16 v[108:111], v[156:159], v[40:43], v[108:111]
  ds_read_b128 v[28:31], v2 offset:6144
  v_mfma_f32_16x16x32_bf16 v[124:127], v[156:159], v[44:47], v[124:127]
  v_mfma_f32_16x16x32_bf16 v[120:123], v[152:155], v[44:47], v[120:123]
  s_add_u32 s30, s22, 896
  s_add_u32 m0, s24, 49152
  v_mfma_f32_16x16x32_bf16 v[116:119], v[148:151], v[44:47], v[116:119]
  buffer_load_dwordx4 v8, s[8:11], s30 offen  lds
  v_mfma_f32_16x16x32_bf16 v[112:115], v[144:147], v[44:47], v[112:115]
  s_waitcnt lgkmcnt(0)
  v_mfma_f32_16x16x32_bf16 v[64:67], v[128:131], v[16:19], v[64:67]
  ds_read_b64_tr_b16 v[144:145], v4 offset:8192
  v_mfma_f32_16x16x32_bf16 v[68:71], v[132:135], v[16:19], v[68:71]
  ds_read_b64_tr_b16 v[146:147], v4 offset:9216
  v_mfma_f32_16x16x32_bf16 v[72:75], v[136:139], v[16:19], v[72:75]
  ds_read_b128 v[32:35], v3 offset:0
  v_mfma_f32_16x16x32_bf16 v[76:79], v[140:143], v[16:19], v[76:79]
  ds_read_b64_tr_b16 v[148:149], v5 offset:8192
  s_add_u32 s30, s22, 10112
  s_add_u32 m0, s24, 50176
  v_mfma_f32_16x16x32_bf16 v[92:95], v[140:143], v[20:23], v[92:95]
  ds_read_b64_tr_b16 v[150:151], v5 offset:9216
  buffer_load_dwordx4 v48, s[8:11], s30 offen  lds
  v_mfma_f32_16x16x32_bf16 v[88:91], v[136:139], v[20:23], v[88:91]
  ds_read_b64_tr_b16 v[152:153], v6 offset:8192
  v_mfma_f32_16x16x32_bf16 v[84:87], v[132:135], v[20:23], v[84:87]
  ds_read_b64_tr_b16 v[154:155], v6 offset:9216
  v_mfma_f32_16x16x32_bf16 v[80:83], v[128:131], v[20:23], v[80:83]
  ds_read_b64_tr_b16 v[156:157], v7 offset:8192
  v_mfma_f32_16x16x32_bf16 v[96:99], v[128:131], v[24:27], v[96:99]
  ds_read_b64_tr_b16 v[158:159], v7 offset:9216
  s_add_u32 s30, s22, 19328
  s_add_u32 m0, s24, 51200
  v_mfma_f32_16x16x32_bf16 v[100:103], v[132:135], v[24:27], v[100:103]
  ds_read_b128 v[36:39], v3 offset:2048
  buffer_load_dwordx4 v49, s[8:11], s30 offen  lds
  v_mfma_f32_16x16x32_bf16 v[104:107], v[136:139], v[24:27], v[104:107]
  ds_read_b128 v[40:43], v3 offset:4096
  v_mfma_f32_16x16x32_bf16 v[108:111], v[140:143], v[24:27], v[108:111]
  ds_read_b128 v[44:47], v3 offset:6144
  v_mfma_f32_16x16x32_bf16 v[124:127], v[140:143], v[28:31], v[124:127]
  v_mfma_f32_16x16x32_bf16 v[120:123], v[136:139], v[28:31], v[120:123]
  s_add_u32 s30, s22, 28544
  s_add_u32 m0, s24, 52224
  v_mfma_f32_16x16x32_bf16 v[116:119], v[132:135], v[28:31], v[116:119]
  buffer_load_dwordx4 v9, s[8:11], s30 offen  lds
  v_mfma_f32_16x16x32_bf16 v[112:115], v[128:131], v[28:31], v[112:115]
  s_waitcnt lgkmcnt(0)
  s_waitcnt vmcnt(6)
  s_barrier
  v_subrev_u32 v2, 98304, v2
  v_subrev_u32 v3, 98304, v3
  v_subrev_u32 v4, 98304, v4
  v_subrev_u32 v5, 98304, v5
  v_subrev_u32 v6, 98304, v6
  v_subrev_u32 v7, 98304, v7
  v_mfma_f32_16x16x32_bf16 v[64:67], v[144:147], v[32:35], v[64:67]
  ds_read_b64_tr_b16 v[128:129], v4 offset:0
  v_mfma_f32_16x16x32_bf16 v[68:71], v[148:151], v[32:35], v[68:71]
  ds_read_b64_tr_b16 v[130:131], v4 offset:1024
  v_mfma_f32_16x16x32_bf16 v[72:75], v[152:155], v[32:35], v[72:75]
  ds_read_b128 v[16:19], v2 offset:0
  v_mfma_f32_16x16x32_bf16 v[76:79], v[156:159], v[32:35], v[76:79]
  ds_read_b64_tr_b16 v[132:133], v5 offset:0
  s_add_u32 s30, s23, 1769472
  s_add_u32 m0, s25, 98304
  v_mfma_f32_16x16x32_bf16 v[92:95], v[156:159], v[36:39], v[92:95]
  ds_read_b64_tr_b16 v[134:135], v5 offset:1024
  buffer_load_dwordx4 v10, s[12:15], s30 offen  lds
  v_mfma_f32_16x16x32_bf16 v[88:91], v[152:155], v[36:39], v[88:91]
  ds_read_b64_tr_b16 v[136:137], v6 offset:0
  v_mfma_f32_16x16x32_bf16 v[84:87], v[148:151], v[36:39], v[84:87]
  ds_read_b64_tr_b16 v[138:139], v6 offset:1024
  v_mfma_f32_16x16x32_bf16 v[80:83], v[144:147], v[36:39], v[80:83]
  ds_read_b64_tr_b16 v[140:141], v7 offset:0
  v_mfma_f32_16x16x32_bf16 v[96:99], v[144:147], v[40:43], v[96:99]
  ds_read_b64_tr_b16 v[142:143], v7 offset:1024
  s_add_u32 s30, s23, 1783296
  s_add_u32 m0, s25, 99328
  v_mfma_f32_16x16x32_bf16 v[100:103], v[148:151], v[40:43], v[100:103]
  ds_read_b128 v[20:23], v2 offset:2048
  buffer_load_dwordx4 v10, s[12:15], s30 offen  lds
  v_mfma_f32_16x16x32_bf16 v[104:107], v[152:155], v[40:43], v[104:107]
  ds_read_b128 v[24:27], v2 offset:4096
  v_mfma_f32_16x16x32_bf16 v[108:111], v[156:159], v[40:43], v[108:111]
  ds_read_b128 v[28:31], v2 offset:6144
  v_mfma_f32_16x16x32_bf16 v[124:127], v[156:159], v[44:47], v[124:127]
  v_mfma_f32_16x16x32_bf16 v[120:123], v[152:155], v[44:47], v[120:123]
  s_add_u32 s30, s22, 1024
  s_add_u32 m0, s24, 98304
  v_mfma_f32_16x16x32_bf16 v[116:119], v[148:151], v[44:47], v[116:119]
  buffer_load_dwordx4 v8, s[8:11], s30 offen  lds
  v_mfma_f32_16x16x32_bf16 v[112:115], v[144:147], v[44:47], v[112:115]
  s_waitcnt lgkmcnt(0)
  v_mfma_f32_16x16x32_bf16 v[64:67], v[128:131], v[16:19], v[64:67]
  ds_read_b64_tr_b16 v[144:145], v4 offset:8192
  v_mfma_f32_16x16x32_bf16 v[68:71], v[132:135], v[16:19], v[68:71]
  ds_read_b64_tr_b16 v[146:147], v4 offset:9216
  v_mfma_f32_16x16x32_bf16 v[72:75], v[136:139], v[16:19], v[72:75]
  ds_read_b128 v[32:35], v3 offset:0
  v_mfma_f32_16x16x32_bf16 v[76:79], v[140:143], v[16:19], v[76:79]
  ds_read_b64_tr_b16 v[148:149], v5 offset:8192
  s_add_u32 s30, s22, 10240
  s_add_u32 m0, s24, 99328
  v_mfma_f32_16x16x32_bf16 v[92:95], v[140:143], v[20:23], v[92:95]
  ds_read_b64_tr_b16 v[150:151], v5 offset:9216
  buffer_load_dwordx4 v48, s[8:11], s30 offen  lds
  v_mfma_f32_16x16x32_bf16 v[88:91], v[136:139], v[20:23], v[88:91]
  ds_read_b64_tr_b16 v[152:153], v6 offset:8192
  v_mfma_f32_16x16x32_bf16 v[84:87], v[132:135], v[20:23], v[84:87]
  ds_read_b64_tr_b16 v[154:155], v6 offset:9216
  v_mfma_f32_16x16x32_bf16 v[80:83], v[128:131], v[20:23], v[80:83]
  ds_read_b64_tr_b16 v[156:157], v7 offset:8192
  v_mfma_f32_16x16x32_bf16 v[96:99], v[128:131], v[24:27], v[96:99]
  ds_read_b64_tr_b16 v[158:159], v7 offset:9216
  s_add_u32 s30, s22, 19456
  s_add_u32 m0, s24, 100352
  v_mfma_f32_16x16x32_bf16 v[100:103], v[132:135], v[24:27], v[100:103]
  ds_read_b128 v[36:39], v3 offset:2048
  buffer_load_dwordx4 v49, s[8:11], s30 offen  lds
  v_mfma_f32_16x16x32_bf16 v[104:107], v[136:139], v[24:27], v[104:107]
  ds_read_b128 v[40:43], v3 offset:4096
  v_mfma_f32_16x16x32_bf16 v[108:111], v[140:143], v[24:27], v[108:111]
  ds_read_b128 v[44:47], v3 offset:6144
  v_mfma_f32_16x16x32_bf16 v[124:127], v[140:143], v[28:31], v[124:127]
  v_mfma_f32_16x16x32_bf16 v[120:123], v[136:139], v[28:31], v[120:123]
  s_add_u32 s30, s22, 28672
  s_add_u32 m0, s24, 101376
  v_mfma_f32_16x16x32_bf16 v[116:119], v[132:135], v[28:31], v[116:119]
  buffer_load_dwordx4 v9, s[8:11], s30 offen  lds
  v_mfma_f32_16x16x32_bf16 v[112:115], v[128:131], v[28:31], v[112:115]
  s_waitcnt lgkmcnt(0)
  s_waitcnt vmcnt(6)
  s_barrier
  v_add_u32 v2, 49152, v2
  v_add_u32 v3, 49152, v3
  v_add_u32 v4, 49152, v4
  v_add_u32 v5, 49152, v5
  v_add_u32 v6, 49152, v6
  v_add_u32 v7, 49152, v7
  v_mfma_f32_16x16x32_bf16 v[64:67], v[144:147], v[32:35], v[64:67]
  ds_read_b64_tr_b16 v[128:129], v4 offset:0
  ds_read_b64_tr_b16 v[130:131], v4 offset:1024
  v_mfma_f32_16x16x32_bf16 v[68:71], v[148:151], v[32:35], v[68:71]
  ds_read_b128 v[16:19], v2 offset:0
  ds_read_b128 v[24:27], v2 offset:2048
  v_mfma_f32_16x16x32_bf16 v[72:75], v[152:155], v[32:35], v[72:75]
  ds_read_b64_tr_b16 v[132:133], v5 offset:0
  ds_read_b64_tr_b16 v[134:135], v5 offset:1024
  v_mfma_f32_16x16x32_bf16 v[76:79], v[156:159], v[32:35], v[76:79]
  ds_read_b64_tr_b16 v[136:137], v6 offset:0
  ds_read_b64_tr_b16 v[138:139], v6 offset:1024
  v_mfma_f32_16x16x32_bf16 v[92:95], v[156:159], v[36:39], v[92:95]
  ds_read_b64_tr_b16 v[140:141], v7 offset:0
  v_mfma_f32_16x16x32_bf16 v[88:91], v[152:155], v[36:39], v[88:91]
  ds_read_b64_tr_b16 v[142:143], v7 offset:1024
  v_mfma_f32_16x16x32_bf16 v[84:87], v[148:151], v[36:39], v[84:87]
  ds_read_b64_tr_b16 v[160:161], v4 offset:8192
  v_mfma_f32_16x16x32_bf16 v[80:83], v[144:147], v[36:39], v[80:83]
  ds_read_b64_tr_b16 v[162:163], v4 offset:9216
  v_mfma_f32_16x16x32_bf16 v[96:99], v[144:147], v[40:43], v[96:99]
  ds_read_b128 v[20:23], v3 offset:0
  v_mfma_f32_16x16x32_bf16 v[100:103], v[148:151], v[40:43], v[100:103]
  ds_read_b128 v[28:31], v3 offset:2048
  v_mfma_f32_16x16x32_bf16 v[104:107], v[152:155], v[40:43], v[104:107]
  ds_read_b64_tr_b16 v[164:165], v5 offset:8192
  v_mfma_f32_16x16x32_bf16 v[108:111], v[156:159], v[40:43], v[108:111]
  ds_read_b64_tr_b16 v[166:167], v5 offset:9216
  v_mfma_f32_16x16x32_bf16 v[124:127], v[156:159], v[44:47], v[124:127]
  ds_read_b64_tr_b16 v[168:169], v6 offset:8192
  v_mfma_f32_16x16x32_bf16 v[120:123], v[152:155], v[44:47], v[120:123]
  ds_read_b64_tr_b16 v[170:171], v6 offset:9216
  v_mfma_f32_16x16x32_bf16 v[116:119], v[148:151], v[44:47], v[116:119]
  ds_read_b64_tr_b16 v[172:173], v7 offset:8192
  v_mfma_f32_16x16x32_bf16 v[112:115], v[144:147], v[44:47], v[112:115]
  ds_read_b64_tr_b16 v[174:175], v7 offset:9216
  s_waitcnt lgkmcnt(0)
  s_waitcnt vmcnt(0)
  s_barrier
  s_mov_b32 s36, s37
  v_mfma_f32_16x16x32_bf16 v[64:67], v[128:131], v[16:19], v[64:67]
  ds_read_b64_tr_b16 v[176:177], v4 offset:49152
  ds_read_b64_tr_b16 v[178:179], v4 offset:50176
  v_mfma_f32_16x16x32_bf16 v[68:71], v[132:135], v[16:19], v[68:71]
  ds_read_b128 v[32:35], v2 offset:49152
  ds_read_b128 v[40:43], v2 offset:51200
  v_mfma_f32_16x16x32_bf16 v[72:75], v[136:139], v[16:19], v[72:75]
  ds_read_b64_tr_b16 v[180:181], v5 offset:49152
  ds_read_b64_tr_b16 v[182:183], v5 offset:50176
  v_mfma_f32_16x16x32_bf16 v[76:79], v[140:143], v[16:19], v[76:79]
  ds_read_b64_tr_b16 v[184:185], v6 offset:49152
  ds_read_b64_tr_b16 v[186:187], v6 offset:50176
  v_mfma_f32_16x16x32_bf16 v[92:95], v[140:143], v[24:27], v[92:95]
  ds_read_b64_tr_b16 v[188:189], v7 offset:49152
  v_mfma_f32_16x16x32_bf16 v[88:91], v[136:139], v[24:27], v[88:91]
  ds_read_b64_tr_b16 v[190:191], v7 offset:50176
  v_mfma_f32_16x16x32_bf16 v[84:87], v[132:135], v[24:27], v[84:87]
  ds_read_b64_tr_b16 v[144:145], v4 offset:57344
  v_mfma_f32_16x16x32_bf16 v[80:83], v[128:131], v[24:27], v[80:83]
  ds_read_b64_tr_b16 v[146:147], v4 offset:58368
  v_mfma_f32_16x16x32_bf16 v[64:67], v[160:163], v[20:23], v[64:67]
  ds_read_b128 v[36:39], v3 offset:49152
  v_mfma_f32_16x16x32_bf16 v[68:71], v[164:167], v[20:23], v[68:71]
  ds_read_b128 v[44:47], v3 offset:51200
  v_mfma_f32_16x16x32_bf16 v[72:75], v[168:171], v[20:23], v[72:75]
  ds_read_b64_tr_b16 v[148:149], v5 offset:57344
  v_mfma_f32_16x16x32_bf16 v[76:79], v[172:175], v[20:23], v[76:79]
  ds_read_b64_tr_b16 v[150:151], v5 offset:58368
  v_mfma_f32_16x16x32_bf16 v[92:95], v[172:175], v[28:31], v[92:95]
  ds_read_b64_tr_b16 v[152:153], v6 offset:57344
  v_mfma_f32_16x16x32_bf16 v[88:91], v[168:171], v[28:31], v[88:91]
  ds_read_b64_tr_b16 v[154:155], v6 offset:58368
  v_mfma_f32_16x16x32_bf16 v[84:87], v[164:167], v[28:31], v[84:87]
  ds_read_b64_tr_b16 v[156:157], v7 offset:57344
  v_mfma_f32_16x16x32_bf16 v[80:83], v[160:163], v[28:31], v[80:83]
  ds_read_b64_tr_b16 v[158:159], v7 offset:58368
  s_waitcnt lgkmcnt(0)
  v_mfma_f32_16x16x32_bf16 v[64:67], v[176:179], v[32:35], v[64:67]
  ds_read_b128 v[16:19], v2 offset:4096
  v_mfma_f32_16x16x32_bf16 v[68:71], v[180:183], v[32:35], v[68:71]
  ds_read_b128 v[20:23], v3 offset:4096
  v_mfma_f32_16x16x32_bf16 v[72:75], v[184:187], v[32:35], v[72:75]
  ds_read_b128 v[24:27], v2 offset:53248
  v_mfma_f32_16x16x32_bf16 v[76:79], v[188:191], v[32:35], v[76:79]
  ds_read_b128 v[28:31], v3 offset:53248
  v_mfma_f32_16x16x32_bf16 v[64:67], v[144:147], v[36:39], v[64:67]
  v_mfma_f32_16x16x32_bf16 v[68:71], v[148:151], v[36:39], v[68:71]
  v_mfma_f32_16x16x32_bf16 v[72:75], v[152:155], v[36:39], v[72:75]
  v_mfma_f32_16x16x32_bf16 v[76:79], v[156:159], v[36:39], v[76:79]
  v_mfma_f32_16x16x32_bf16 v[80:83], v[176:179], v[40:43], v[80:83]
  v_mfma_f32_16x16x32_bf16 v[84:87], v[180:183], v[40:43], v[84:87]
  v_mfma_f32_16x16x32_bf16 v[88:91], v[184:187], v[40:43], v[88:91]
  v_mfma_f32_16x16x32_bf16 v[92:95], v[188:191], v[40:43], v[92:95]
  v_mfma_f32_16x16x32_bf16 v[80:83], v[144:147], v[44:47], v[80:83]
  v_mfma_f32_16x16x32_bf16 v[84:87], v[148:151], v[44:47], v[84:87]
  v_mfma_f32_16x16x32_bf16 v[88:91], v[152:155], v[44:47], v[88:91]
  v_mfma_f32_16x16x32_bf16 v[92:95], v[156:159], v[44:47], v[92:95]
  s_cmp_eq_u32 s78, 1
  s_cbranch_scc1 k1_qkv_kernel_e2q_k
  s_waitcnt lgkmcnt(0)
  v_mfma_f32_16x16x32_bf16 v[96:99], v[128:131], v[16:19], v[96:99]
  ds_read_b128 v[32:35], v2 offset:6144
  v_pk_mul_f32 v[64:65], v[64:65], s[36:37]
  v_pk_mul_f32 v[66:67], v[66:67], s[36:37]
  v_pk_mul_f32 v[68:69], v[68:69], s[36:37]
  v_mfma_f32_16x16x32_bf16 v[100:103], v[132:135], v[16:19], v[100:103]
  ds_read_b128 v[36:39], v3 offset:6144
  v_pk_mul_f32 v[70:71], v[70:71], s[36:37]
  v_pk_mul_f32 v[72:73], v[72:73], s[36:37]
  v_mfma_f32_16x16x32_bf16 v[104:107], v[136:139], v[16:19], v[104:107]
  ds_read_b128 v[40:43], v2 offset:55296
  v_pk_mul_f32 v[74:75], v[74:75], s[36:37]
  v_pk_mul_f32 v[76:77], v[76:77], s[36:37]
  v_mfma_f32_16x16x32_bf16 v[108:111], v[140:143], v[16:19], v[108:111]
  ds_read_b128 v[44:47], v3 offset:55296
  v_pk_mul_f32 v[78:79], v[78:79], s[36:37]
  v_cvt_pk_bf16_f32 v64, v64, v65
  v_mfma_f32_16x16x32_bf16 v[96:99], v[160:163], v[20:23], v[96:99]
  v_cvt_pk_bf16_f32 v65, v66, v67
  v_cvt_pk_bf16_f32 v66, v68, v69
  v_cvt_pk_bf16_f32 v67, v70, v71
  v_mfma_f32_16x16x32_bf16 v[100:103], v[164:167], v[20:23], v[100:103]
  v_cvt_pk_bf16_f32 v68, v72, v73
  v_cvt_pk_bf16_f32 v69, v74, v75
  v_mfma_f32_16x16x32_bf16 v[104:107], v[168:171], v[20:23], v[104:107]
  v_cvt_pk_bf16_f32 v70, v76, v77
  v_cvt_pk_bf16_f32 v71, v78, v79
  v_mfma_f32_16x16x32_bf16 v[108:111], v[172:175], v[20:23], v[108:111]
  buffer_store_dwordx4 v[64:67], v50, s[16:19], s38 offen offset:0 sc1
  buffer_store_dwordx4 v[68:71], v51, s[16:19], s38 offen offset:0 sc1
  v_mfma_f32_16x16x32_bf16 v[96:99], v[176:179], v[24:27], v[96:99]
  v_pk_mul_f32 v[80:81], v[80:81], s[36:37]
  v_pk_mul_f32 v[82:83], v[82:83], s[36:37]
  v_pk_mul_f32 v[84:85], v[84:85], s[36:37]
  v_mfma_f32_16x16x32_bf16 v[100:103], v[180:183], v[24:27], v[100:103]
  v_pk_mul_f32 v[86:87], v[86:87], s[36:37]
  v_pk_mul_f32 v[88:89], v[88:89], s[36:37]
  v_mfma_f32_16x16x32_bf16 v[104:107], v[184:187], v[24:27], v[104:107]
  v_pk_mul_f32 v[90:91], v[90:91], s[36:37]
  v_pk_mul_f32 v[92:93], v[92:93], s[36:37]
  v_mfma_f32_16x16x32_bf16 v[108:111], v[188:191], v[24:27], v[108:111]
  v_pk_mul_f32 v[94:95], v[94:95], s[36:37]
  v_cvt_pk_bf16_f32 v72, v80, v81
  v_mfma_f32_16x16x32_bf16 v[96:99], v[144:147], v[28:31], v[96:99]
  v_cvt_pk_bf16_f32 v73, v82, v83
  v_cvt_pk_bf16_f32 v74, v84, v85
  v_cvt_pk_bf16_f32 v75, v86, v87
  v_mfma_f32_16x16x32_bf16 v[100:103], v[148:151], v[28:31], v[100:103]
  v_cvt_pk_bf16_f32 v76, v88, v89
  v_cvt_pk_bf16_f32 v77, v90, v91
  v_mfma_f32_16x16x32_bf16 v[104:107], v[152:155], v[28:31], v[104:107]
  v_cvt_pk_bf16_f32 v78, v92, v93
  v_cvt_pk_bf16_f32 v79, v94, v95
  v_mfma_f32_16x16x32_bf16 v[108:111], v[156:159], v[28:31], v[108:111]
  buffer_store_dwordx4 v[72:75], v50, s[16:19], s38 offen offset:256 sc1
  buffer_store_dwordx4 v[76:79], v51, s[16:19], s38 offen offset:256 sc1
  s_waitcnt lgkmcnt(0)
  v_mfma_f32_16x16x32_bf16 v[112:115], v[128:131], v[32:35], v[112:115]
  v_mfma_f32_16x16x32_bf16 v[116:119], v[132:135], v[32:35], v[116:119]
  v_mfma_f32_16x16x32_bf16 v[120:123], v[136:139], v[32:35], v[120:123]
  v_mfma_f32_16x16x32_bf16 v[124:127], v[140:143], v[32:35], v[124:127]
  v_mfma_f32_16x16x32_bf16 v[112:115], v[160:163], v[36:39], v[112:115]
  v_mfma_f32_16x16x32_bf16 v[116:119], v[164:167], v[36:39], v[116:119]
  v_mfma_f32_16x16x32_bf16 v[120:123], v[168:171], v[36:39], v[120:123]
  v_mfma_f32_16x16x32_bf16 v[124:127], v[172:175], v[36:39], v[124:127]
  v_pk_mul_f32 v[96:97], v[96:97], s[36:37]
  v_pk_mul_f32 v[98:99], v[98:99], s[36:37]
  v_mfma_f32_16x16x32_bf16 v[112:115], v[176:179], v[40:43], v[112:115]
  v_pk_mul_f32 v[100:101], v[100:101], s[36:37]
  v_pk_mul_f32 v[102:103], v[102:103], s[36:37]
  v_mfma_f32_16x16x32_bf16 v[116:119], v[180:183], v[40:43], v[116:119]
  v_pk_mul_f32 v[104:105], v[104:105], s[36:37]
  v_pk_mul_f32 v[106:107], v[106:107], s[36:37]
  v_mfma_f32_16x16x32_bf16 v[120:123], v[184:187], v[40:43], v[120:123]
  v_pk_mul_f32 v[108:109], v[108:109], s[36:37]
  v_pk_mul_f32 v[110:111], v[110:111], s[36:37]
  v_mfma_f32_16x16x32_bf16 v[124:127], v[188:191], v[40:43], v[124:127]
  v_cvt_pk_bf16_f32 v80, v96, v97
  v_cvt_pk_bf16_f32 v81, v98, v99
  v_mfma_f32_16x16x32_bf16 v[112:115], v[144:147], v[44:47], v[112:115]
  v_cvt_pk_bf16_f32 v82, v100, v101
  v_cvt_pk_bf16_f32 v83, v102, v103
  v_mfma_f32_16x16x32_bf16 v[116:119], v[148:151], v[44:47], v[116:119]
  v_cvt_pk_bf16_f32 v84, v104, v105
  v_cvt_pk_bf16_f32 v85, v106, v107
  v_mfma_f32_16x16x32_bf16 v[120:123], v[152:155], v[44:47], v[120:123]
  v_cvt_pk_bf16_f32 v86, v108, v109
  v_cvt_pk_bf16_f32 v87, v110, v111
  v_mfma_f32_16x16x32_bf16 v[124:127], v[156:159], v[44:47], v[124:127]
  buffer_store_dwordx4 v[80:83], v50, s[16:19], s39 offen offset:0 sc1
  buffer_store_dwordx4 v[84:87], v51, s[16:19], s39 offen offset:0 sc1
  s_nop 3
  v_pk_mul_f32 v[112:113], v[112:113], s[36:37]
  v_pk_mul_f32 v[114:115], v[114:115], s[36:37]
  v_pk_mul_f32 v[116:117], v[116:117], s[36:37]
  v_pk_mul_f32 v[118:119], v[118:119], s[36:37]
  v_pk_mul_f32 v[120:121], v[120:121], s[36:37]
  v_pk_mul_f32 v[122:123], v[122:123], s[36:37]
  v_pk_mul_f32 v[124:125], v[124:125], s[36:37]
  v_pk_mul_f32 v[126:127], v[126:127], s[36:37]
  v_cvt_pk_bf16_f32 v88, v112, v113
  v_cvt_pk_bf16_f32 v89, v114, v115
  v_cvt_pk_bf16_f32 v90, v116, v117
  v_cvt_pk_bf16_f32 v91, v118, v119
  v_cvt_pk_bf16_f32 v92, v120, v121
  v_cvt_pk_bf16_f32 v93, v122, v123
  v_cvt_pk_bf16_f32 v94, v124, v125
  v_cvt_pk_bf16_f32 v95, v126, v127
  buffer_store_dwordx4 v[88:91], v50, s[16:19], s39 offen offset:256 sc1
  buffer_store_dwordx4 v[92:95], v51, s[16:19], s39 offen offset:256 sc1
  s_branch k1_qkv_kernel_e2q_d
k1_qkv_kernel_e2q_k:
  s_waitcnt lgkmcnt(0)
  v_mfma_f32_16x16x32_bf16 v[96:99], v[128:131], v[16:19], v[96:99]
  ds_read_b128 v[32:35], v2 offset:6144
  v_cvt_pk_bf16_f32 v64, v64, v65
  v_cvt_pk_bf16_f32 v65, v66, v67
  v_mfma_f32_16x16x32_bf16 v[100:103], v[132:135], v[16:19], v[100:103]
  ds_read_b128 v[36:39], v3 offset:6144
  v_cvt_pk_bf16_f32 v66, v68, v69
  v_mfma_f32_16x16x32_bf16 v[104:107], v[136:139], v[16:19], v[104:107]
  ds_read_b128 v[40:43], v2 offset:55296
  v_cvt_pk_bf16_f32 v67, v70, v71
  v_mfma_f32_16x16x32_bf16 v[108:111], v[140:143], v[16:19], v[108:111]
  ds_read_b128 v[44:47], v3 offset:55296
  v_cvt_pk_bf16_f32 v68, v72, v73
  v_mfma_f32_16x16x32_bf16 v[96:99], v[160:163], v[20:23], v[96:99]
  v_cvt_pk_bf16_f32 v69, v74, v75
  v_cvt_pk_bf16_f32 v70, v76, v77
  v_mfma_f32_16x16x32_bf16 v[100:103], v[164:167], v[20:23], v[100:103]
  v_cvt_pk_bf16_f32 v71, v78, v79
  v_mfma_f32_16x16x32_bf16 v[104:107], v[168:171], v[20:23], v[104:107]
  buffer_store_dwordx4 v[64:67], v50, s[16:19], s38 offen offset:0 sc1
  v_mfma_f32_16x16x32_bf16 v[108:111], v[172:175], v[20:23], v[108:111]
  buffer_store_dwordx4 v[68:71], v51, s[16:19], s38 offen offset:0 sc1
  v_mfma_f32_16x16x32_bf16 v[96:99], v[176:179], v[24:27], v[96:99]
  v_cvt_pk_bf16_f32 v72, v80, v81
  v_cvt_pk_bf16_f32 v73, v82, v83
  v_mfma_f32_16x16x32_bf16 v[100:103], v[180:183], v[24:27], v[100:103]
  v_cvt_pk_bf16_f32 v74, v84, v85
  v_mfma_f32_16x16x32_bf16 v[104:107], v[184:187], v[24:27], v[104:107]
  v_cvt_pk_bf16_f32 v75, v86, v87
  v_mfma_f32_16x16x32_bf16 v[108:111], v[188:191], v[24:27], v[108:111]
  v_cvt_pk_bf16_f32 v76, v88, v89
  v_mfma_f32_16x16x32_bf16 v[96:99], v[144:147], v[28:31], v[96:99]
  v_cvt_pk_bf16_f32 v77, v90, v91
  v_cvt_pk_bf16_f32 v78, v92, v93
  v_mfma_f32_16x16x32_bf16 v[100:103], v[148:151], v[28:31], v[100:103]
  v_cvt_pk_bf16_f32 v79, v94, v95
  v_mfma_f32_16x16x32_bf16 v[104:107], v[152:155], v[28:31], v[104:107]
  buffer_store_dwordx4 v[72:75], v50, s[16:19], s38 offen offset:256 sc1
  v_mfma_f32_16x16x32_bf16 v[108:111], v[156:159], v[28:31], v[108:111]
  buffer_store_dwordx4 v[76:79], v51, s[16:19], s38 offen offset:256 sc1
  s_waitcnt lgkmcnt(0)
  v_mfma_f32_16x16x32_bf16 v[112:115], v[128:131], v[32:35], v[112:115]
  v_mfma_f32_16x16x32_bf16 v[116:119], v[132:135], v[32:35], v[116:119]
  v_mfma_f32_16x16x32_bf16 v[120:123], v[136:139], v[32:35], v[120:123]
  v_mfma_f32_16x16x32_bf16 v[124:127], v[140:143], v[32:35], v[124:127]
  v_mfma_f32_16x16x32_bf16 v[112:115], v[160:163], v[36:39], v[112:115]
  v_mfma_f32_16x16x32_bf16 v[116:119], v[164:167], v[36:39], v[116:119]
  v_mfma_f32_16x16x32_bf16 v[120:123], v[168:171], v[36:39], v[120:123]
  v_mfma_f32_16x16x32_bf16 v[124:127], v[172:175], v[36:39], v[124:127]
  v_cvt_pk_bf16_f32 v80, v96, v97
  v_cvt_pk_bf16_f32 v81, v98, v99
  v_mfma_f32_16x16x32_bf16 v[112:115], v[176:179], v[40:43], v[112:115]
  v_cvt_pk_bf16_f32 v82, v100, v101
  v_mfma_f32_16x16x32_bf16 v[116:119], v[180:183], v[40:43], v[116:119]
  v_cvt_pk_bf16_f32 v83, v102, v103
  v_mfma_f32_16x16x32_bf16 v[120:123], v[184:187], v[40:43], v[120:123]
  v_cvt_pk_bf16_f32 v84, v104, v105
  v_mfma_f32_16x16x32_bf16 v[124:127], v[188:191], v[40:43], v[124:127]
  v_cvt_pk_bf16_f32 v85, v106, v107
  v_mfma_f32_16x16x32_bf16 v[112:115], v[144:147], v[44:47], v[112:115]
  v_cvt_pk_bf16_f32 v86, v108, v109
  v_mfma_f32_16x16x32_bf16 v[116:119], v[148:151], v[44:47], v[116:119]
  v_cvt_pk_bf16_f32 v87, v110, v111
  v_mfma_f32_16x16x32_bf16 v[120:123], v[152:155], v[44:47], v[120:123]
  buffer_store_dwordx4 v[80:83], v50, s[16:19], s39 offen offset:0 sc1
  v_mfma_f32_16x16x32_bf16 v[124:127], v[156:159], v[44:47], v[124:127]
  buffer_store_dwordx4 v[84:87], v51, s[16:19], s39 offen offset:0 sc1
  s_nop 4
  v_cvt_pk_bf16_f32 v88, v112, v113
  v_cvt_pk_bf16_f32 v89, v114, v115
  v_cvt_pk_bf16_f32 v90, v116, v117
  v_cvt_pk_bf16_f32 v91, v118, v119
  v_cvt_pk_bf16_f32 v92, v120, v121
  v_cvt_pk_bf16_f32 v93, v122, v123
  v_cvt_pk_bf16_f32 v94, v124, v125
  v_cvt_pk_bf16_f32 v95, v126, v127
  buffer_store_dwordx4 v[88:91], v50, s[16:19], s39 offen offset:256 sc1
  buffer_store_dwordx4 v[92:95], v51, s[16:19], s39 offen offset:256 sc1
k1_qkv_kernel_e2q_d:
  s_cmp_lg_u32 s79, 0
  s_cbranch_scc1 k1_qkv_kernel_epi1
  s_nop 1
  v_permlane32_swap_b32 v68, v84
  v_permlane32_swap_b32 v76, v92
  v_permlane32_swap_b32 v69, v85
  v_permlane32_swap_b32 v77, v93
  v_permlane32_swap_b32 v70, v86
  v_permlane32_swap_b32 v78, v94
  v_permlane32_swap_b32 v71, v87
  v_permlane32_swap_b32 v79, v95
  s_nop 1
  v_permlane16_swap_b32 v84, v92
  v_permlane16_swap_b32 v85, v93
  v_permlane16_swap_b32 v86, v94
  v_permlane16_swap_b32 v87, v95
  s_nop 1
  buffer_store_dword v92, v53, s[16:19], s84 offen
  buffer_store_dword v93, v53, s[16:19], s85 offen
  buffer_store_dword v94, v53, s[16:19], s86 offen
  buffer_store_dword v95, v53, s[16:19], s87 offen
  s_branch k1_qkv_kernel_epi_done
k1_qkv_kernel_epi1:
  s_cmp_lg_u32 s79, 1
  s_cbranch_scc1 k1_qkv_kernel_epi2
  s_nop 1
  v_permlane32_swap_b32 v68, v84
  v_permlane32_swap_b32 v76, v92
  v_permlane32_swap_b32 v69, v85
  v_permlane32_swap_b32 v77, v93
  v_permlane32_swap_b32 v70, v86
  v_permlane32_swap_b32 v78, v94
  v_permlane32_swap_b32 v71, v87
  v_permlane32_swap_b32 v79, v95
  s_nop 1
  v_permlane16_swap_b32 v84, v92
  v_permlane16_swap_b32 v85, v93
  v_permlane16_swap_b32 v86, v94
  v_permlane16_swap_b32 v87, v95
  s_nop 1
  buffer_store_dword v92, v53, s[16:19], s84 offen
  buffer_store_dword v93, v53, s[16:19], s85 offen
  buffer_store_dword v94, v53, s[16:19], s86 offen
  buffer_store_dword v95, v53, s[16:19], s87 offen
  s_branch k1_qkv_kernel_epi_done
k1_qkv_kernel_epi2:
  s_cmp_lg_u32 s79, 2
  s_cbranch_scc1 k1_qkv_kernel_epi3
  s_nop 1
  v_permlane32_swap_b32 v68, v84
  v_permlane32_swap_b32 v76, v92
  v_permlane32_swap_b32 v69, v85
  v_permlane32_swap_b32 v77, v93
  v_permlane32_swap_b32 v70, v86
  v_permlane32_swap_b32 v78, v94
  v_permlane32_swap_b32 v71, v87
  v_permlane32_swap_b32 v79, v95
  s_nop 1
  v_permlane16_swap_b32 v84, v92
  v_permlane16_swap_b32 v85, v93
  v_permlane16_swap_b32 v86, v94
  v_permlane16_swap_b32 v87, v95
  s_nop 1
  buffer_store_dwordx2 v[92:93], v52, s[16:19], s84 offen
  buffer_store_dword v94, v53, s[16:19], s85 offen
  buffer_store_dword v95, v53, s[16:19], s86 offen
  s_branch k1_qkv_kernel_epi_done
k1_qkv_kernel_epi3:
  s_cmp_lg_u32 s79, 3
  s_cbranch_scc1 k1_qkv_kernel_epi4
  s_nop 1
  v_permlane32_swap_b32 v68, v84
  v_permlane32_swap_b32 v76, v92
  v_permlane32_swap_b32 v69, v85
  v_permlane32_swap_b32 v77, v93
  v_permlane32_swap_b32 v70, v86
  v_permlane32_swap_b32 v78, v94
  v_permlane32_swap_b32 v71, v87
  v_permlane32_swap_b32 v79, v95
  s_nop 1
  v_permlane16_swap_b32 v84, v92
  v_permlane16_swap_b32 v85, v93
  v_permlane16_swap_b32 v86, v94
  v_permlane16_swap_b32 v87, v95
  s_nop 1
  buffer_store_dword v84, v53, s[16:19], s84 offen
  buffer_store_dword v85, v53, s[16:19], s85 offen
  buffer_store_dwordx2 v[86:87], v52, s[16:19], s86 offen
  buffer_store_dwordx2 v[92:93], v52, s[16:19], s87 offen
  buffer_store_dword v94, v53, s[16:19], s88 offen
  buffer_store_dword v95, v53, s[16:19], s89 offen
  s_branch k1_qkv_kernel_epi_done
k1_qkv_kernel_epi4:
  s_cmp_lg_u32 s79, 4
  s_cbranch_scc1 k1_qkv_kernel_epi5
  s_nop 1
  v_permlane32_swap_b32 v64, v80
  v_permlane32_swap_b32 v72, v88
  v_permlane32_swap_b32 v65, v81
  v_permlane32_swap_b32 v73, v89
  v_permlane32_swap_b32 v66, v82
  v_permlane32_swap_b32 v74, v90
  v_permlane32_swap_b32 v67, v83
  v_permlane32_swap_b32 v75, v91
  v_permlane32_swap_b32 v68, v84
  v_permlane32_swap_b32 v76, v92
  v_permlane32_swap_b32 v69, v85
  v_permlane32_swap_b32 v77, v93
  v_permlane32_swap_b32 v70, v86
  v_permlane32_swap_b32 v78, v94
  v_permlane32_swap_b32 v71, v87
  v_permlane32_swap_b32 v79, v95
  s_nop 1
  v_permlane16_swap_b32 v80, v88
  v_permlane16_swap_b32 v81, v89
  v_permlane16_swap_b32 v82, v90
  v_permlane16_swap_b32 v83, v91
  v_permlane16_swap_b32 v84, v92
  v_permlane16_swap_b32 v85, v93
  v_permlane16_swap_b32 v86, v94
  v_permlane16_swap_b32 v87, v95
  s_nop 1
  buffer_store_dword v88, v53, s[16:19], s84 offen
  buffer_store_dword v89, v53, s[16:19], s85 offen
  buffer_store_dwordx2 v[90:91], v52, s[16:19], s86 offen
  buffer_store_dwordx2 v[92:93], v52, s[16:19], s87 offen
  buffer_store_dword v94, v53, s[16:19], s88 offen
  buffer_store_dword v95, v53, s[16:19], s89 offen
  s_branch k1_qkv_kernel_epi_done
k1_qkv_kernel_epi5:
  s_cmp_lg_u32 s79, 5
  s_cbranch_scc1 k1_qkv_kernel_epi6
  s_nop 1
  v_permlane32_swap_b32 v68, v84
  v_permlane32_swap_b32 v76, v92
  v_permlane32_swap_b32 v69, v85
  v_permlane32_swap_b32 v77, v93
  v_permlane32_swap_b32 v70, v86
  v_permlane32_swap_b32 v78, v94
  v_permlane32_swap_b32 v71, v87
  v_permlane32_swap_b32 v79, v95
  s_nop 1
  v_permlane16_swap_b32 v84, v92
  v_permlane16_swap_b32 v85, v93
  v_permlane16_swap_b32 v86, v94
  v_permlane16_swap_b32 v87, v95
  s_nop 1
  buffer_store_dword v84, v53, s[16:19], s84 offen
  buffer_store_dword v85, v53, s[16:19], s85 offen
  buffer_store_dwordx2 v[86:87], v52, s[16:19], s86 offen
  buffer_store_dwordx2 v[92:93], v52, s[16:19], s87 offen
  buffer_store_dword v94, v53, s[16:19], s88 offen
  buffer_store_dword v95, v53, s[16:19], s89 offen
  s_branch k1_qkv_kernel_epi_done
k1_qkv_kernel_epi6:
  s_cmp_lg_u32 s79, 6
  s_cbranch_scc1 k1_qkv_kernel_epi7
  s_nop 1
  v_permlane32_swap_b32 v68, v84
  v_permlane32_swap_b32 v76, v92
  v_permlane32_swap_b32 v69, v85
  v_permlane32_swap_b32 v77, v93
  v_permlane32_swap_b32 v70, v86
  v_permlane32_swap_b32 v78, v94
  v_permlane32_swap_b32 v71, v87
  v_permlane32_swap_b32 v79, v95
  s_nop 1
  v_permlane16_swap_b32 v84, v92
  v_permlane16_swap_b32 v85, v93
  v_permlane16_swap_b32 v86, v94
  v_permlane16_swap_b32 v87, v95
  s_nop 1
  buffer_store_dword v92, v53, s[16:19], s84 offen
  buffer_store_dword v93, v53, s[16:19], s85 offen
  buffer_store_dwordx2 v[94:95], v52, s[16:19], s86 offen
  s_branch k1_qkv_kernel_epi_done
k1_qkv_kernel_epi7:
  s_cmp_lg_u32 s79, 7
  s_cbranch_scc1 k1_qkv_kernel_epi8
  s_nop 1
  v_permlane32_swap_b32 v68, v84
  v_permlane32_swap_b32 v76, v92
  v_permlane32_swap_b32 v69, v85
  v_permlane32_swap_b32 v77, v93
  v_permlane32_swap_b32 v70, v86
  v_permlane32_swap_b32 v78, v94
  v_permlane32_swap_b32 v71, v87
  v_permlane32_swap_b32 v79, v95
  s_nop 1
  v_permlane16_swap_b32 v84, v92
  v_permlane16_swap_b32 v85, v93
  v_permlane16_swap_b32 v86, v94
  v_permlane16_swap_b32 v87, v95
  s_nop 1
  buffer_store_dword v92, v53, s[16:19], s84 offen
  buffer_store_dword v93, v53, s[16:19], s85 offen
  buffer_store_dword v94, v53, s[16:19], s86 offen
  buffer_store_dword v95, v53, s[16:19], s87 offen
  s_branch k1_qkv_kernel_epi_done
k1_qkv_kernel_epi8:
  s_nop 1
  v_permlane32_swap_b32 v68, v84
  v_permlane32_swap_b32 v76, v92
  v_permlane32_swap_b32 v69, v85
  v_permlane32_swap_b32 v77, v93
  v_permlane32_swap_b32 v70, v86
  v_permlane32_swap_b32 v78, v94
  v_permlane32_swap_b32 v71, v87
  v_permlane32_swap_b32 v79, v95
  s_nop 1
  v_permlane16_swap_b32 v84, v92
  v_permlane16_swap_b32 v85, v93
  v_permlane16_swap_b32 v86, v94
  v_permlane16_swap_b32 v87, v95
  s_nop 1
  buffer_store_dword v92, v53, s[16:19], s84 offen
  buffer_store_dword v93, v53, s[16:19], s85 offen
  buffer_store_dword v94, v53, s[16:19], s86 offen
  buffer_store_dword v95, v53, s[16:19], s87 offen
k1_qkv_kernel_epi_done:
  s_endpgm
k1_qkv_kernel_vtype:
  s_cmp_ge_u32 s32, 576
  s_cbranch_scc1 k1_qkv_kernel_pad
  ds_read_b64_tr_b16 v[128:129], v4 offset:0
  ds_read_b64_tr_b16 v[130:131], v4 offset:1024
  ds_read_b128 v[16:19], v2 offset:0
  ds_read_b64_tr_b16 v[132:133], v5 offset:0
  ds_read_b64_tr_b16 v[134:135], v5 offset:1024
  ds_read_b64_tr_b16 v[136:137], v6 offset:0
  ds_read_b64_tr_b16 v[138:139], v6 offset:1024
  ds_read_b64_tr_b16 v[140:141], v7 offset:0
  ds_read_b64_tr_b16 v[142:143], v7 offset:1024
  ds_read_b128 v[20:23], v2 offset:1024
  ds_read_b128 v[24:27], v2 offset:4096
  ds_read_b128 v[28:31], v2 offset:5120
  s_waitcnt lgkmcnt(0)
  v_mfma_f32_16x16x32_bf16 v[64:67], v[16:19], v[128:131], 0
  ds_read_b64_tr_b16 v[144:145], v4 offset:8192
  v_mfma_f32_16x16x32_bf16 v[72:75], v[16:19], v[132:135], 0
  ds_read_b64_tr_b16 v[146:147], v4 offset:9216
  s_add_u32 s30, s23, 442368
  s_add_u32 m0, s25, 98304
  v_mfma_f32_16x16x32_bf16 v[80:83], v[16:19], v[136:139], 0
  ds_read_b128 v[32:35], v3 offset:0
  buffer_load_dwordx4 v10, s[12:15], s30 offen  lds
  v_mfma_f32_16x16x32_bf16 v[88:91], v[16:19], v[140:143], 0
  ds_read_b64_tr_b16 v[148:149], v5 offset:8192
  s_add_u32 s30, s23, 456192
  s_add_u32 m0, s25, 99328
  v_mfma_f32_16x16x32_bf16 v[92:95], v[20:23], v[140:143], 0
  ds_read_b64_tr_b16 v[150:151], v5 offset:9216
  buffer_load_dwordx4 v10, s[12:15], s30 offen  lds
  v_mfma_f32_16x16x32_bf16 v[84:87], v[20:23], v[136:139], 0
  ds_read_b64_tr_b16 v[152:153], v6 offset:8192
  v_mfma_f32_16x16x32_bf16 v[76:79], v[20:23], v[132:135], 0
  ds_read_b64_tr_b16 v[154:155], v6 offset:9216
  s_add_u32 s30, s22, 256
  s_add_u32 m0, s24, 98304
  v_mfma_f32_16x16x32_bf16 v[68:71], v[20:23], v[128:131], 0
  ds_read_b64_tr_b16 v[156:157], v7 offset:8192
  buffer_load_dwordx4 v8, s[8:11], s30 offen  lds
  v_mfma_f32_16x16x32_bf16 v[96:99], v[24:27], v[128:131], 0
  ds_read_b64_tr_b16 v[158:159], v7 offset:9216
  s_add_u32 s30, s22, 9472
  s_add_u32 m0, s24, 99328
  v_mfma_f32_16x16x32_bf16 v[104:107], v[24:27], v[132:135], 0
  ds_read_b128 v[36:39], v3 offset:1024
  buffer_load_dwordx4 v48, s[8:11], s30 offen  lds
  v_mfma_f32_16x16x32_bf16 v[112:115], v[24:27], v[136:139], 0
  ds_read_b128 v[40:43], v3 offset:4096
  v_mfma_f32_16x16x32_bf16 v[120:123], v[24:27], v[140:143], 0
  ds_read_b128 v[44:47], v3 offset:5120
  s_add_u32 s30, s22, 18688
  s_add_u32 m0, s24, 100352
  v_mfma_f32_16x16x32_bf16 v[124:127], v[28:31], v[140:143], 0
  buffer_load_dwordx4 v49, s[8:11], s30 offen  lds
  v_mfma_f32_16x16x32_bf16 v[116:119], v[28:31], v[136:139], 0
  s_add_u32 s30, s22, 27904
  s_add_u32 m0, s24, 101376
  v_mfma_f32_16x16x32_bf16 v[108:111], v[28:31], v[132:135], 0
  buffer_load_dwordx4 v9, s[8:11], s30 offen  lds
  v_mfma_f32_16x16x32_bf16 v[100:103], v[28:31], v[128:131], 0
  s_waitcnt lgkmcnt(0)
  s_waitcnt vmcnt(6)
  s_barrier
  v_add_u32 v2, 49152, v2
  v_add_u32 v3, 49152, v3
  v_add_u32 v4, 49152, v4
  v_add_u32 v5, 49152, v5
  v_add_u32 v6, 49152, v6
  v_add_u32 v7, 49152, v7
  v_mfma_f32_16x16x32_bf16 v[64:67], v[32:35], v[144:147], v[64:67]
  ds_read_b64_tr_b16 v[128:129], v4 offset:0
  v_mfma_f32_16x16x32_bf16 v[72:75], v[32:35], v[148:151], v[72:75]
  ds_read_b64_tr_b16 v[130:131], v4 offset:1024
  s_add_u32 s30, s23, 663552
  s_add_u32 m0, s25, 0
  v_mfma_f32_16x16x32_bf16 v[80:83], v[32:35], v[152:155], v[80:83]
  ds_read_b128 v[16:19], v2 offset:0
  buffer_load_dwordx4 v10, s[12:15], s30 offen  lds
  v_mfma_f32_16x16x32_bf16 v[88:91], v[32:35], v[156:159], v[88:91]
  ds_read_b64_tr_b16 v[132:133], v5 offset:0
  s_add_u32 s30, s23, 677376
  s_add_u32 m0, s25, 1024
  v_mfma_f32_16x16x32_bf16 v[92:95], v[36:39], v[156:159], v[92:95]
  ds_read_b64_tr_b16 v[134:135], v5 offset:1024
  buffer_load_dwordx4 v10, s[12:15], s30 offen  lds
  v_mfma_f32_16x16x32_bf16 v[84:87], v[36:39], v[152:155], v[84:87]
  ds_read_b64_tr_b16 v[136:137], v6 offset:0
  v_mfma_f32_16x16x32_bf16 v[76:79], v[36:39], v[148:151], v[76:79]
  ds_read_b64_tr_b16 v[138:139], v6 offset:1024
  s_add_u32 s30, s22, 384
  s_add_u32 m0, s24, 0
  v_mfma_f32_16x16x32_bf16 v[68:71], v[36:39], v[144:147], v[68:71]
  ds_read_b64_tr_b16 v[140:141], v7 offset:0
  buffer_load_dwordx4 v8, s[8:11], s30 offen  lds
  v_mfma_f32_16x16x32_bf16 v[96:99], v[40:43], v[144:147], v[96:99]
  ds_read_b64_tr_b16 v[142:143], v7 offset:1024
  s_add_u32 s30, s22, 9600
  s_add_u32 m0, s24, 1024
  v_mfma_f32_16x16x32_bf16 v[104:107], v[40:43], v[148:151], v[104:107]
  ds_read_b128 v[20:23], v2 offset:1024
  buffer_load_dwordx4 v48, s[8:11], s30 offen  lds
  v_mfma_f32_16x16x32_bf16 v[112:115], v[40:43], v[152:155], v[112:115]
  ds_read_b128 v[24:27], v2 offset:4096
  v_mfma_f32_16x16x32_bf16 v[120:123], v[40:43], v[156:159], v[120:123]
  ds_read_b128 v[28:31], v2 offset:5120
  s_add_u32 s30, s22, 18816
  s_add_u32 m0, s24, 2048
  v_mfma_f32_16x16x32_bf16 v[124:127], v[44:47], v[156:159], v[124:127]
  buffer_load_dwordx4 v49, s[8:11], s30 offen  lds
  v_mfma_f32_16x16x32_bf16 v[116:119], v[44:47], v[152:155], v[116:119]
  s_add_u32 s30, s22, 28032
  s_add_u32 m0, s24, 3072
  v_mfma_f32_16x16x32_bf16 v[108:111], v[44:47], v[148:151], v[108:111]
  buffer_load_dwordx4 v9, s[8:11], s30 offen  lds
  v_mfma_f32_16x16x32_bf16 v[100:103], v[44:47], v[144:147], v[100:103]
  s_waitcnt lgkmcnt(0)
  v_mfma_f32_16x16x32_bf16 v[64:67], v[16:19], v[128:131], v[64:67]
  ds_read_b64_tr_b16 v[144:145], v4 offset:8192
  v_mfma_f32_16x16x32_bf16 v[72:75], v[16:19], v[132:135], v[72:75]
  ds_read_b64_tr_b16 v[146:147], v4 offset:9216
  v_mfma_f32_16x16x32_bf16 v[80:83], v[16:19], v[136:139], v[80:83]
  ds_read_b128 v[32:35], v3 offset:0
  v_mfma_f32_16x16x32_bf16 v[88:91], v[16:19], v[140:143], v[88:91]
  ds_read_b64_tr_b16 v[148:149], v5 offset:8192
  v_mfma_f32_16x16x32_bf16 v[92:95], v[20:23], v[140:143], v[92:95]
  ds_read_b64_tr_b16 v[150:151], v5 offset:9216
  v_mfma_f32_16x16x32_bf16 v[84:87], v[20:23], v[136:139], v[84:87]
  ds_read_b64_tr_b16 v[152:153], v6 offset:8192
  v_mfma_f32_16x16x32_bf16 v[76:79], v[20:23], v[132:135], v[76:79]
  ds_read_b64_tr_b16 v[154:155], v6 offset:9216
  v_mfma_f32_16x16x32_bf16 v[68:71], v[20:23], v[128:131], v[68:71]
  ds_read_b64_tr_b16 v[156:157], v7 offset:8192
  v_mfma_f32_16x16x32_bf16 v[96:99], v[24:27], v[128:131], v[96:99]
  ds_read_b64_tr_b16 v[158:159], v7 offset:9216
  v_mfma_f32_16x16x32_bf16 v[104:107], v[24:27], v[132:135], v[104:107]
  ds_read_b128 v[36:39], v3 offset:1024
  v_mfma_f32_16x16x32_bf16 v[112:115], v[24:27], v[136:139], v[112:115]
  ds_read_b128 v[40:43], v3 offset:4096
  v_mfma_f32_16x16x32_bf16 v[120:123], v[24:27], v[140:143], v[120:123]
  ds_read_b128 v[44:47], v3 offset:5120
  v_mfma_f32_16x16x32_bf16 v[124:127], v[28:31], v[140:143], v[124:127]
  v_mfma_f32_16x16x32_bf16 v[116:119], v[28:31], v[136:139], v[116:119]
  v_mfma_f32_16x16x32_bf16 v[108:111], v[28:31], v[132:135], v[108:111]
  v_mfma_f32_16x16x32_bf16 v[100:103], v[28:31], v[128:131], v[100:103]
  s_waitcnt lgkmcnt(0)
  s_waitcnt vmcnt(6)
  s_barrier
  v_add_u32 v2, 49152, v2
  v_add_u32 v3, 49152, v3
  v_add_u32 v4, 49152, v4
  v_add_u32 v5, 49152, v5
  v_add_u32 v6, 49152, v6
  v_add_u32 v7, 49152, v7
  v_mfma_f32_16x16x32_bf16 v[64:67], v[32:35], v[144:147], v[64:67]
  ds_read_b64_tr_b16 v[128:129], v4 offset:0
  v_mfma_f32_16x16x32_bf16 v[72:75], v[32:35], v[148:151], v[72:75]
  ds_read_b64_tr_b16 v[130:131], v4 offset:1024
  v_mfma_f32_16x16x32_bf16 v[80:83], v[32:35], v[152:155], v[80:83]
  ds_read_b128 v[16:19], v2 offset:0
  v_mfma_f32_16x16x32_bf16 v[88:91], v[32:35], v[156:159], v[88:91]
  ds_read_b64_tr_b16 v[132:133], v5 offset:0
  s_add_u32 s30, s23, 884736
  s_add_u32 m0, s25, 49152
  v_mfma_f32_16x16x32_bf16 v[92:95], v[36:39], v[156:159], v[92:95]
  ds_read_b64_tr_b16 v[134:135], v5 offset:1024
  buffer_load_dwordx4 v10, s[12:15], s30 offen  lds
  v_mfma_f32_16x16x32_bf16 v[84:87], v[36:39], v[152:155], v[84:87]
  ds_read_b64_tr_b16 v[136:137], v6 offset:0
  v_mfma_f32_16x16x32_bf16 v[76:79], v[36:39], v[148:151], v[76:79]
  ds_read_b64_tr_b16 v[138:139], v6 offset:1024
  v_mfma_f32_16x16x32_bf16 v[68:71], v[36:39], v[144:147], v[68:71]
  ds_read_b64_tr_b16 v[140:141], v7 offset:0
  v_mfma_f32_16x16x32_bf16 v[96:99], v[40:43], v[144:147], v[96:99]
  ds_read_b64_tr_b16 v[142:143], v7 offset:1024
  s_add_u32 s30, s23, 898560
  s_add_u32 m0, s25, 50176
  v_mfma_f32_16x16x32_bf16 v[104:107], v[40:43], v[148:151], v[104:107]
  ds_read_b128 v[20:23], v2 offset:1024
  buffer_load_dwordx4 v10, s[12:15], s30 offen  lds
  v_mfma_f32_16x16x32_bf16 v[112:115], v[40:43], v[152:155], v[112:115]
  ds_read_b128 v[24:27], v2 offset:4096
  v_mfma_f32_16x16x32_bf16 v[120:123], v[40:43], v[156:159], v[120:123]
  ds_read_b128 v[28:31], v2 offset:5120
  v_mfma_f32_16x16x32_bf16 v[124:127], v[44:47], v[156:159], v[124:127]
  v_mfma_f32_16x16x32_bf16 v[116:119], v[44:47], v[152:155], v[116:119]
  s_add_u32 s30, s22, 512
  s_add_u32 m0, s24, 49152
  v_mfma_f32_16x16x32_bf16 v[108:111], v[44:47], v[148:151], v[108:111]
  buffer_load_dwordx4 v8, s[8:11], s30 offen  lds
  v_mfma_f32_16x16x32_bf16 v[100:103], v[44:47], v[144:147], v[100:103]
  s_waitcnt lgkmcnt(0)
  v_mfma_f32_16x16x32_bf16 v[64:67], v[16:19], v[128:131], v[64:67]
  ds_read_b64_tr_b16 v[144:145], v4 offset:8192
  v_mfma_f32_16x16x32_bf16 v[72:75], v[16:19], v[132:135], v[72:75]
  ds_read_b64_tr_b16 v[146:147], v4 offset:9216
  v_mfma_f32_16x16x32_bf16 v[80:83], v[16:19], v[136:139], v[80:83]
  ds_read_b128 v[32:35], v3 offset:0
  v_mfma_f32_16x16x32_bf16 v[88:91], v[16:19], v[140:143], v[88:91]
  ds_read_b64_tr_b16 v[148:149], v5 offset:8192
  s_add_u32 s30, s22, 9728
  s_add_u32 m0, s24, 50176
  v_mfma_f32_16x16x32_bf16 v[92:95], v[20:23], v[140:143], v[92:95]
  ds_read_b64_tr_b16 v[150:151], v5 offset:9216
  buffer_load_dwordx4 v48, s[8:11], s30 offen  lds
  v_mfma_f32_16x16x32_bf16 v[84:87], v[20:23], v[136:139], v[84:87]
  ds_read_b64_tr_b16 v[152:153], v6 offset:8192
  v_mfma_f32_16x16x32_bf16 v[76:79], v[20:23], v[132:135], v[76:79]
  ds_read_b64_tr_b16 v[154:155], v6 offset:9216
  v_mfma_f32_16x16x32_bf16 v[68:71], v[20:23], v[128:131], v[68:71]
  ds_read_b64_tr_b16 v[156:157], v7 offset:8192
  v_mfma_f32_16x16x32_bf16 v[96:99], v[24:27], v[128:131], v[96:99]
  ds_read_b64_tr_b16 v[158:159], v7 offset:9216
  s_add_u32 s30, s22, 18944
  s_add_u32 m0, s24, 51200
  v_mfma_f32_16x16x32_bf16 v[104:107], v[24:27], v[132:135], v[104:107]
  ds_read_b128 v[36:39], v3 offset:1024
  buffer_load_dwordx4 v49, s[8:11], s30 offen  lds
  v_mfma_f32_16x16x32_bf16 v[112:115], v[24:27], v[136:139], v[112:115]
  ds_read_b128 v[40:43], v3 offset:4096
  v_mfma_f32_16x16x32_bf16 v[120:123], v[24:27], v[140:143], v[120:123]
  ds_read_b128 v[44:47], v3 offset:5120
  v_mfma_f32_16x16x32_bf16 v[124:127], v[28:31], v[140:143], v[124:127]
  v_mfma_f32_16x16x32_bf16 v[116:119], v[28:31], v[136:139], v[116:119]
  s_add_u32 s30, s22, 28160
  s_add_u32 m0, s24, 52224
  v_mfma_f32_16x16x32_bf16 v[108:111], v[28:31], v[132:135], v[108:111]
  buffer_load_dwordx4 v9, s[8:11], s30 offen  lds
  v_mfma_f32_16x16x32_bf16 v[100:103], v[28:31], v[128:131], v[100:103]
  s_waitcnt lgkmcnt(0)
  s_waitcnt vmcnt(6)
  s_barrier
  v_subrev_u32 v2, 98304, v2
  v_subrev_u32 v3, 98304, v3
  v_subrev_u32 v4, 98304, v4
  v_subrev_u32 v5, 98304, v5
  v_subrev_u32 v6, 98304, v6
  v_subrev_u32 v7, 98304, v7
  v_mfma_f32_16x16x32_bf16 v[64:67], v[32:35], v[144:147], v[64:67]
  ds_read_b64_tr_b16 v[128:129], v4 offset:0
  v_mfma_f32_16x16x32_bf16 v[72:75], v[32:35], v[148:151], v[72:75]
  ds_read_b64_tr_b16 v[130:131], v4 offset:1024
  v_mfma_f32_16x16x32_bf16 v[80:83], v[32:35], v[152:155], v[80:83]
  ds_read_b128 v[16:19], v2 offset:0
  v_mfma_f32_16x16x32_bf16 v[88:91], v[32:35], v[156:159], v[88:91]
  ds_read_b64_tr_b16 v[132:133], v5 offset:0
  s_add_u32 s30, s23, 1105920
  s_add_u32 m0, s25, 98304
  v_mfma_f32_16x16x32_bf16 v[92:95], v[36:39], v[156:159], v[92:95]
  ds_read_b64_tr_b16 v[134:135], v5 offset:1024
  buffer_load_dwordx4 v10, s[12:15], s30 offen  lds
  v_mfma_f32_16x16x32_bf16 v[84:87], v[36:39], v[152:155], v[84:87]
  ds_read_b64_tr_b16 v[136:137], v6 offset:0
  v_mfma_f32_16x16x32_bf16 v[76:79], v[36:39], v[148:151], v[76:79]
  ds_read_b64_tr_b16 v[138:139], v6 offset:1024
  v_mfma_f32_16x16x32_bf16 v[68:71], v[36:39], v[144:147], v[68:71]
  ds_read_b64_tr_b16 v[140:141], v7 offset:0
  v_mfma_f32_16x16x32_bf16 v[96:99], v[40:43], v[144:147], v[96:99]
  ds_read_b64_tr_b16 v[142:143], v7 offset:1024
  s_add_u32 s30, s23, 1119744
  s_add_u32 m0, s25, 99328
  v_mfma_f32_16x16x32_bf16 v[104:107], v[40:43], v[148:151], v[104:107]
  ds_read_b128 v[20:23], v2 offset:1024
  buffer_load_dwordx4 v10, s[12:15], s30 offen  lds
  v_mfma_f32_16x16x32_bf16 v[112:115], v[40:43], v[152:155], v[112:115]
  ds_read_b128 v[24:27], v2 offset:4096
  v_mfma_f32_16x16x32_bf16 v[120:123], v[40:43], v[156:159], v[120:123]
  ds_read_b128 v[28:31], v2 offset:5120
  v_mfma_f32_16x16x32_bf16 v[124:127], v[44:47], v[156:159], v[124:127]
  v_mfma_f32_16x16x32_bf16 v[116:119], v[44:47], v[152:155], v[116:119]
  s_add_u32 s30, s22, 640
  s_add_u32 m0, s24, 98304
  v_mfma_f32_16x16x32_bf16 v[108:111], v[44:47], v[148:151], v[108:111]
  buffer_load_dwordx4 v8, s[8:11], s30 offen  lds
  v_mfma_f32_16x16x32_bf16 v[100:103], v[44:47], v[144:147], v[100:103]
  s_waitcnt lgkmcnt(0)
  v_mfma_f32_16x16x32_bf16 v[64:67], v[16:19], v[128:131], v[64:67]
  ds_read_b64_tr_b16 v[144:145], v4 offset:8192
  v_mfma_f32_16x16x32_bf16 v[72:75], v[16:19], v[132:135], v[72:75]
  ds_read_b64_tr_b16 v[146:147], v4 offset:9216
  v_mfma_f32_16x16x32_bf16 v[80:83], v[16:19], v[136:139], v[80:83]
  ds_read_b128 v[32:35], v3 offset:0
  v_mfma_f32_16x16x32_bf16 v[88:91], v[16:19], v[140:143], v[88:91]
  ds_read_b64_tr_b16 v[148:149], v5 offset:8192
  s_add_u32 s30, s22, 9856
  s_add_u32 m0, s24, 99328
  v_mfma_f32_16x16x32_bf16 v[92:95], v[20:23], v[140:143], v[92:95]
  ds_read_b64_tr_b16 v[150:151], v5 offset:9216
  buffer_load_dwordx4 v48, s[8:11], s30 offen  lds
  v_mfma_f32_16x16x32_bf16 v[84:87], v[20:23], v[136:139], v[84:87]
  ds_read_b64_tr_b16 v[152:153], v6 offset:8192
  v_mfma_f32_16x16x32_bf16 v[76:79], v[20:23], v[132:135], v[76:79]
  ds_read_b64_tr_b16 v[154:155], v6 offset:9216
  v_mfma_f32_16x16x32_bf16 v[68:71], v[20:23], v[128:131], v[68:71]
  ds_read_b64_tr_b16 v[156:157], v7 offset:8192
  v_mfma_f32_16x16x32_bf16 v[96:99], v[24:27], v[128:131], v[96:99]
  ds_read_b64_tr_b16 v[158:159], v7 offset:9216
  s_add_u32 s30, s22, 19072
  s_add_u32 m0, s24, 100352
  v_mfma_f32_16x16x32_bf16 v[104:107], v[24:27], v[132:135], v[104:107]
  ds_read_b128 v[36:39], v3 offset:1024
  buffer_load_dwordx4 v49, s[8:11], s30 offen  lds
  v_mfma_f32_16x16x32_bf16 v[112:115], v[24:27], v[136:139], v[112:115]
  ds_read_b128 v[40:43], v3 offset:4096
  v_mfma_f32_16x16x32_bf16 v[120:123], v[24:27], v[140:143], v[120:123]
  ds_read_b128 v[44:47], v3 offset:5120
  v_mfma_f32_16x16x32_bf16 v[124:127], v[28:31], v[140:143], v[124:127]
  v_mfma_f32_16x16x32_bf16 v[116:119], v[28:31], v[136:139], v[116:119]
  s_add_u32 s30, s22, 28288
  s_add_u32 m0, s24, 101376
  v_mfma_f32_16x16x32_bf16 v[108:111], v[28:31], v[132:135], v[108:111]
  buffer_load_dwordx4 v9, s[8:11], s30 offen  lds
  v_mfma_f32_16x16x32_bf16 v[100:103], v[28:31], v[128:131], v[100:103]
  s_waitcnt lgkmcnt(0)
  s_waitcnt vmcnt(6)
  s_barrier
  v_add_u32 v2, 49152, v2
  v_add_u32 v3, 49152, v3
  v_add_u32 v4, 49152, v4
  v_add_u32 v5, 49152, v5
  v_add_u32 v6, 49152, v6
  v_add_u32 v7, 49152, v7
  v_mfma_f32_16x16x32_bf16 v[64:67], v[32:35], v[144:147], v[64:67]
  ds_read_b64_tr_b16 v[128:129], v4 offset:0
  v_mfma_f32_16x16x32_bf16 v[72:75], v[32:35], v[148:151], v[72:75]
  ds_read_b64_tr_b16 v[130:131], v4 offset:1024
  v_mfma_f32_16x16x32_bf16 v[80:83], v[32:35], v[152:155], v[80:83]
  ds_read_b128 v[16:19], v2 offset:0
  v_mfma_f32_16x16x32_bf16 v[88:91], v[32:35], v[156:159], v[88:91]
  ds_read_b64_tr_b16 v[132:133], v5 offset:0
  s_add_u32 s30, s23, 1327104
  s_add_u32 m0, s25, 0
  v_mfma_f32_16x16x32_bf16 v[92:95], v[36:39], v[156:159], v[92:95]
  ds_read_b64_tr_b16 v[134:135], v5 offset:1024
  buffer_load_dwordx4 v10, s[12:15], s30 offen  lds
  v_mfma_f32_16x16x32_bf16 v[84:87], v[36:39], v[152:155], v[84:87]
  ds_read_b64_tr_b16 v[136:137], v6 offset:0
  v_mfma_f32_16x16x32_bf16 v[76:79], v[36:39], v[148:151], v[76:79]
  ds_read_b64_tr_b16 v[138:139], v6 offset:1024
  v_mfma_f32_16x16x32_bf16 v[68:71], v[36:39], v[144:147], v[68:71]
  ds_read_b64_tr_b16 v[140:141], v7 offset:0
  v_mfma_f32_16x16x32_bf16 v[96:99], v[40:43], v[144:147], v[96:99]
  ds_read_b64_tr_b16 v[142:143], v7 offset:1024
  s_add_u32 s30, s23, 1340928
  s_add_u32 m0, s25, 1024
  v_mfma_f32_16x16x32_bf16 v[104:107], v[40:43], v[148:151], v[104:107]
  ds_read_b128 v[20:23], v2 offset:1024
  buffer_load_dwordx4 v10, s[12:15], s30 offen  lds
  v_mfma_f32_16x16x32_bf16 v[112:115], v[40:43], v[152:155], v[112:115]
  ds_read_b128 v[24:27], v2 offset:4096
  v_mfma_f32_16x16x32_bf16 v[120:123], v[40:43], v[156:159], v[120:123]
  ds_read_b128 v[28:31], v2 offset:5120
  v_mfma_f32_16x16x32_bf16 v[124:127], v[44:47], v[156:159], v[124:127]
  v_mfma_f32_16x16x32_bf16 v[116:119], v[44:47], v[152:155], v[116:119]
  s_add_u32 s30, s22, 768
  s_add_u32 m0, s24, 0
  v_mfma_f32_16x16x32_bf16 v[108:111], v[44:47], v[148:151], v[108:111]
  buffer_load_dwordx4 v8, s[8:11], s30 offen  lds
  v_mfma_f32_16x16x32_bf16 v[100:103], v[44:47], v[144:147], v[100:103]
  s_waitcnt lgkmcnt(0)
  v_mfma_f32_16x16x32_bf16 v[64:67], v[16:19], v[128:131], v[64:67]
  ds_read_b64_tr_b16 v[144:145], v4 offset:8192
  v_mfma_f32_16x16x32_bf16 v[72:75], v[16:19], v[132:135], v[72:75]
  ds_read_b64_tr_b16 v[146:147], v4 offset:9216
  v_mfma_f32_16x16x32_bf16 v[80:83], v[16:19], v[136:139], v[80:83]
  ds_read_b128 v[32:35], v3 offset:0
  v_mfma_f32_16x16x32_bf16 v[88:91], v[16:19], v[140:143], v[88:91]
  ds_read_b64_tr_b16 v[148:149], v5 offset:8192
  s_add_u32 s30, s22, 9984
  s_add_u32 m0, s24, 1024
  v_mfma_f32_16x16x32_bf16 v[92:95], v[20:23], v[140:143], v[92:95]
  ds_read_b64_tr_b16 v[150:151], v5 offset:9216
  buffer_load_dwordx4 v48, s[8:11], s30 offen  lds
  v_mfma_f32_16x16x32_bf16 v[84:87], v[20:23], v[136:139], v[84:87]
  ds_read_b64_tr_b16 v[152:153], v6 offset:8192
  v_mfma_f32_16x16x32_bf16 v[76:79], v[20:23], v[132:135], v[76:79]
  ds_read_b64_tr_b16 v[154:155], v6 offset:9216
  v_mfma_f32_16x16x32_bf16 v[68:71], v[20:23], v[128:131], v[68:71]
  ds_read_b64_tr_b16 v[156:157], v7 offset:8192
  v_mfma_f32_16x16x32_bf16 v[96:99], v[24:27], v[128:131], v[96:99]
  ds_read_b64_tr_b16 v[158:159], v7 offset:9216
  s_add_u32 s30, s22, 19200
  s_add_u32 m0, s24, 2048
  v_mfma_f32_16x16x32_bf16 v[104:107], v[24:27], v[132:135], v[104:107]
  ds_read_b128 v[36:39], v3 offset:1024
  buffer_load_dwordx4 v49, s[8:11], s30 offen  lds
  v_mfma_f32_16x16x32_bf16 v[112:115], v[24:27], v[136:139], v[112:115]
  ds_read_b128 v[40:43], v3 offset:4096
  v_mfma_f32_16x16x32_bf16 v[120:123], v[24:27], v[140:143], v[120:123]
  ds_read_b128 v[44:47], v3 offset:5120
  v_mfma_f32_16x16x32_bf16 v[124:127], v[28:31], v[140:143], v[124:127]
  v_mfma_f32_16x16x32_bf16 v[116:119], v[28:31], v[136:139], v[116:119]
  s_add_u32 s30, s22, 28416
  s_add_u32 m0, s24, 3072
  v_mfma_f32_16x16x32_bf16 v[108:111], v[28:31], v[132:135], v[108:111]
  buffer_load_dwordx4 v9, s[8:11], s30 offen  lds
  v_mfma_f32_16x16x32_bf16 v[100:103], v[28:31], v[128:131], v[100:103]
  s_waitcnt lgkmcnt(0)
  s_waitcnt vmcnt(6)
  s_barrier
  v_add_u32 v2, 49152, v2
  v_add_u32 v3, 49152, v3
  v_add_u32 v4, 49152, v4
  v_add_u32 v5, 49152, v5
  v_add_u32 v6, 49152, v6
  v_add_u32 v7, 49152, v7
  v_mfma_f32_16x16x32_bf16 v[64:67], v[32:35], v[144:147], v[64:67]
  ds_read_b64_tr_b16 v[128:129], v4 offset:0
  v_mfma_f32_16x16x32_bf16 v[72:75], v[32:35], v[148:151], v[72:75]
  ds_read_b64_tr_b16 v[130:131], v4 offset:1024
  v_mfma_f32_16x16x32_bf16 v[80:83], v[32:35], v[152:155], v[80:83]
  ds_read_b128 v[16:19], v2 offset:0
  v_mfma_f32_16x16x32_bf16 v[88:91], v[32:35], v[156:159], v[88:91]
  ds_read_b64_tr_b16 v[132:133], v5 offset:0
  s_add_u32 s30, s23, 1548288
  s_add_u32 m0, s25, 49152
  v_mfma_f32_16x16x32_bf16 v[92:95], v[36:39], v[156:159], v[92:95]
  ds_read_b64_tr_b16 v[134:135], v5 offset:1024
  buffer_load_dwordx4 v10, s[12:15], s30 offen  lds
  v_mfma_f32_16x16x32_bf16 v[84:87], v[36:39], v[152:155], v[84:87]
  ds_read_b64_tr_b16 v[136:137], v6 offset:0
  v_mfma_f32_16x16x32_bf16 v[76:79], v[36:39], v[148:151], v[76:79]
  ds_read_b64_tr_b16 v[138:139], v6 offset:1024
  v_mfma_f32_16x16x32_bf16 v[68:71], v[36:39], v[144:147], v[68:71]
  ds_read_b64_tr_b16 v[140:141], v7 offset:0
  v_mfma_f32_16x16x32_bf16 v[96:99], v[40:43], v[144:147], v[96:99]
  ds_read_b64_tr_b16 v[142:143], v7 offset:1024
  s_add_u32 s30, s23, 1562112
  s_add_u32 m0, s25, 50176
  v_mfma_f32_16x16x32_bf16 v[104:107], v[40:43], v[148:151], v[104:107]
  ds_read_b128 v[20:23], v2 offset:1024
  buffer_load_dwordx4 v10, s[12:15], s30 offen  lds
  v_mfma_f32_16x16x32_bf16 v[112:115], v[40:43], v[152:155], v[112:115]
  ds_read_b128 v[24:27], v2 offset:4096
  v_mfma_f32_16x16x32_bf16 v[120:123], v[40:43], v[156:159], v[120:123]
  ds_read_b128 v[28:31], v2 offset:5120
  v_mfma_f32_16x16x32_bf16 v[124:127], v[44:47], v[156:159], v[124:127]
  v_mfma_f32_16x16x32_bf16 v[116:119], v[44:47], v[152:155], v[116:119]
  s_add_u32 s30, s22, 896
  s_add_u32 m0, s24, 49152
  v_mfma_f32_16x16x32_bf16 v[108:111], v[44:47], v[148:151], v[108:111]
  buffer_load_dwordx4 v8, s[8:11], s30 offen  lds
  v_mfma_f32_16x16x32_bf16 v[100:103], v[44:47], v[144:147], v[100:103]
  s_waitcnt lgkmcnt(0)
  v_mfma_f32_16x16x32_bf16 v[64:67], v[16:19], v[128:131], v[64:67]
  ds_read_b64_tr_b16 v[144:145], v4 offset:8192
  v_mfma_f32_16x16x32_bf16 v[72:75], v[16:19], v[132:135], v[72:75]
  ds_read_b64_tr_b16 v[146:147], v4 offset:9216
  v_mfma_f32_16x16x32_bf16 v[80:83], v[16:19], v[136:139], v[80:83]
  ds_read_b128 v[32:35], v3 offset:0
  v_mfma_f32_16x16x32_bf16 v[88:91], v[16:19], v[140:143], v[88:91]
  ds_read_b64_tr_b16 v[148:149], v5 offset:8192
  s_add_u32 s30, s22, 10112
  s_add_u32 m0, s24, 50176
  v_mfma_f32_16x16x32_bf16 v[92:95], v[20:23], v[140:143], v[92:95]
  ds_read_b64_tr_b16 v[150:151], v5 offset:9216
  buffer_load_dwordx4 v48, s[8:11], s30 offen  lds
  v_mfma_f32_16x16x32_bf16 v[84:87], v[20:23], v[136:139], v[84:87]
  ds_read_b64_tr_b16 v[152:153], v6 offset:8192
  v_mfma_f32_16x16x32_bf16 v[76:79], v[20:23], v[132:135], v[76:79]
  ds_read_b64_tr_b16 v[154:155], v6 offset:9216
  v_mfma_f32_16x16x32_bf16 v[68:71], v[20:23], v[128:131], v[68:71]
  ds_read_b64_tr_b16 v[156:157], v7 offset:8192
  v_mfma_f32_16x16x32_bf16 v[96:99], v[24:27], v[128:131], v[96:99]
  ds_read_b64_tr_b16 v[158:159], v7 offset:9216
  s_add_u32 s30, s22, 19328
  s_add_u32 m0, s24, 51200
  v_mfma_f32_16x16x32_bf16 v[104:107], v[24:27], v[132:135], v[104:107]
  ds_read_b128 v[36:39], v3 offset:1024
  buffer_load_dwordx4 v49, s[8:11], s30 offen  lds
  v_mfma_f32_16x16x32_bf16 v[112:115], v[24:27], v[136:139], v[112:115]
  ds_read_b128 v[40:43], v3 offset:4096
  v_mfma_f32_16x16x32_bf16 v[120:123], v[24:27], v[140:143], v[120:123]
  ds_read_b128 v[44:47], v3 offset:5120
  v_mfma_f32_16x16x32_bf16 v[124:127], v[28:31], v[140:143], v[124:127]
  v_mfma_f32_16x16x32_bf16 v[116:119], v[28:31], v[136:139], v[116:119]
  s_add_u32 s30, s22, 28544
  s_add_u32 m0, s24, 52224
  v_mfma_f32_16x16x32_bf16 v[108:111], v[28:31], v[132:135], v[108:111]
  buffer_load_dwordx4 v9, s[8:11], s30 offen  lds
  v_mfma_f32_16x16x32_bf16 v[100:103], v[28:31], v[128:131], v[100:103]
  s_waitcnt lgkmcnt(0)
  s_waitcnt vmcnt(6)
  s_barrier
  v_subrev_u32 v2, 98304, v2
  v_subrev_u32 v3, 98304, v3
  v_subrev_u32 v4, 98304, v4
  v_subrev_u32 v5, 98304, v5
  v_subrev_u32 v6, 98304, v6
  v_subrev_u32 v7, 98304, v7
  v_mfma_f32_16x16x32_bf16 v[64:67], v[32:35], v[144:147], v[64:67]
  ds_read_b64_tr_b16 v[128:129], v4 offset:0
  v_mfma_f32_16x16x32_bf16 v[72:75], v[32:35], v[148:151], v[72:75]
  ds_read_b64_tr_b16 v[130:131], v4 offset:1024
  v_mfma_f32_16x16x32_bf16 v[80:83], v[32:35], v[152:155], v[80:83]
  ds_read_b128 v[16:19], v2 offset:0
  v_mfma_f32_16x16x32_bf16 v[88:91], v[32:35], v[156:159], v[88:91]
  ds_read_b64_tr_b16 v[132:133], v5 offset:0
  s_add_u32 s30, s23, 1769472
  s_add_u32 m0, s25, 98304
  v_mfma_f32_16x16x32_bf16 v[92:95], v[36:39], v[156:159], v[92:95]
  ds_read_b64_tr_b16 v[134:135], v5 offset:1024
  buffer_load_dwordx4 v10, s[12:15], s30 offen  lds
  v_mfma_f32_16x16x32_bf16 v[84:87], v[36:39], v[152:155], v[84:87]
  ds_read_b64_tr_b16 v[136:137], v6 offset:0
  v_mfma_f32_16x16x32_bf16 v[76:79], v[36:39], v[148:151], v[76:79]
  ds_read_b64_tr_b16 v[138:139], v6 offset:1024
  v_mfma_f32_16x16x32_bf16 v[68:71], v[36:39], v[144:147], v[68:71]
  ds_read_b64_tr_b16 v[140:141], v7 offset:0
  v_mfma_f32_16x16x32_bf16 v[96:99], v[40:43], v[144:147], v[96:99]
  ds_read_b64_tr_b16 v[142:143], v7 offset:1024
  s_add_u32 s30, s23, 1783296
  s_add_u32 m0, s25, 99328
  v_mfma_f32_16x16x32_bf16 v[104:107], v[40:43], v[148:151], v[104:107]
  ds_read_b128 v[20:23], v2 offset:1024
  buffer_load_dwordx4 v10, s[12:15], s30 offen  lds
  v_mfma_f32_16x16x32_bf16 v[112:115], v[40:43], v[152:155], v[112:115]
  ds_read_b128 v[24:27], v2 offset:4096
  v_mfma_f32_16x16x32_bf16 v[120:123], v[40:43], v[156:159], v[120:123]
  ds_read_b128 v[28:31], v2 offset:5120
  v_mfma_f32_16x16x32_bf16 v[124:127], v[44:47], v[156:159], v[124:127]
  v_mfma_f32_16x16x32_bf16 v[116:119], v[44:47], v[152:155], v[116:119]
  s_add_u32 s30, s22, 1024
  s_add_u32 m0, s24, 98304
  v_mfma_f32_16x16x32_bf16 v[108:111], v[44:47], v[148:151], v[108:111]
  buffer_load_dwordx4 v8, s[8:11], s30 offen  lds
  v_mfma_f32_16x16x32_bf16 v[100:103], v[44:47], v[144:147], v[100:103]
  s_waitcnt lgkmcnt(0)
  v_mfma_f32_16x16x32_bf16 v[64:67], v[16:19], v[128:131], v[64:67]
  ds_read_b64_tr_b16 v[144:145], v4 offset:8192
  v_mfma_f32_16x16x32_bf16 v[72:75], v[16:19], v[132:135], v[72:75]
  ds_read_b64_tr_b16 v[146:147], v4 offset:9216
  v_mfma_f32_16x16x32_bf16 v[80:83], v[16:19], v[136:139], v[80:83]
  ds_read_b128 v[32:35], v3 offset:0
  v_mfma_f32_16x16x32_bf16 v[88:91], v[16:19], v[140:143], v[88:91]
  ds_read_b64_tr_b16 v[148:149], v5 offset:8192
  s_add_u32 s30, s22, 10240
  s_add_u32 m0, s24, 99328
  v_mfma_f32_16x16x32_bf16 v[92:95], v[20:23], v[140:143], v[92:95]
  ds_read_b64_tr_b16 v[150:151], v5 offset:9216
  buffer_load_dwordx4 v48, s[8:11], s30 offen  lds
  v_mfma_f32_16x16x32_bf16 v[84:87], v[20:23], v[136:139], v[84:87]
  ds_read_b64_tr_b16 v[152:153], v6 offset:8192
  v_mfma_f32_16x16x32_bf16 v[76:79], v[20:23], v[132:135], v[76:79]
  ds_read_b64_tr_b16 v[154:155], v6 offset:9216
  v_mfma_f32_16x16x32_bf16 v[68:71], v[20:23], v[128:131], v[68:71]
  ds_read_b64_tr_b16 v[156:157], v7 offset:8192
  v_mfma_f32_16x16x32_bf16 v[96:99], v[24:27], v[128:131], v[96:99]
  ds_read_b64_tr_b16 v[158:159], v7 offset:9216
  s_add_u32 s30, s22, 19456
  s_add_u32 m0, s24, 100352
  v_mfma_f32_16x16x32_bf16 v[104:107], v[24:27], v[132:135], v[104:107]
  ds_read_b128 v[36:39], v3 offset:1024
  buffer_load_dwordx4 v49, s[8:11], s30 offen  lds
  v_mfma_f32_16x16x32_bf16 v[112:115], v[24:27], v[136:139], v[112:115]
  ds_read_b128 v[40:43], v3 offset:4096
  v_mfma_f32_16x16x32_bf16 v[120:123], v[24:27], v[140:143], v[120:123]
  ds_read_b128 v[44:47], v3 offset:5120
  v_mfma_f32_16x16x32_bf16 v[124:127], v[28:31], v[140:143], v[124:127]
  v_mfma_f32_16x16x32_bf16 v[116:119], v[28:31], v[136:139], v[116:119]
  s_add_u32 s30, s22, 28672
  s_add_u32 m0, s24, 101376
  v_mfma_f32_16x16x32_bf16 v[108:111], v[28:31], v[132:135], v[108:111]
  buffer_load_dwordx4 v9, s[8:11], s30 offen  lds
  v_mfma_f32_16x16x32_bf16 v[100:103], v[28:31], v[128:131], v[100:103]
  s_waitcnt lgkmcnt(0)
  s_waitcnt vmcnt(6)
  s_barrier
  v_add_u32 v2, 49152, v2
  v_add_u32 v3, 49152, v3
  v_add_u32 v4, 49152, v4
  v_add_u32 v5, 49152, v5
  v_add_u32 v6, 49152, v6
  v_add_u32 v7, 49152, v7
  v_mfma_f32_16x16x32_bf16 v[64:67], v[32:35], v[144:147], v[64:67]
  ds_read_b64_tr_b16 v[128:129], v4 offset:0
  ds_read_b64_tr_b16 v[130:131], v4 offset:1024
  v_mfma_f32_16x16x32_bf16 v[72:75], v[32:35], v[148:151], v[72:75]
  ds_read_b128 v[16:19], v2 offset:0
  ds_read_b128 v[24:27], v2 offset:1024
  v_mfma_f32_16x16x32_bf16 v[80:83], v[32:35], v[152:155], v[80:83]
  ds_read_b64_tr_b16 v[132:133], v5 offset:0
  ds_read_b64_tr_b16 v[134:135], v5 offset:1024
  v_mfma_f32_16x16x32_bf16 v[88:91], v[32:35], v[156:159], v[88:91]
  ds_read_b64_tr_b16 v[136:137], v6 offset:0
  ds_read_b64_tr_b16 v[138:139], v6 offset:1024
  v_mfma_f32_16x16x32_bf16 v[92:95], v[36:39], v[156:159], v[92:95]
  ds_read_b64_tr_b16 v[140:141], v7 offset:0
  v_mfma_f32_16x16x32_bf16 v[84:87], v[36:39], v[152:155], v[84:87]
  ds_read_b64_tr_b16 v[142:143], v7 offset:1024
  v_mfma_f32_16x16x32_bf16 v[76:79], v[36:39], v[148:151], v[76:79]
  ds_read_b64_tr_b16 v[160:161], v4 offset:8192
  v_mfma_f32_16x16x32_bf16 v[68:71], v[36:39], v[144:147], v[68:71]
  ds_read_b64_tr_b16 v[162:163], v4 offset:9216
  v_mfma_f32_16x16x32_bf16 v[96:99], v[40:43], v[144:147], v[96:99]
  ds_read_b128 v[20:23], v3 offset:0
  v_mfma_f32_16x16x32_bf16 v[104:107], v[40:43], v[148:151], v[104:107]
  ds_read_b128 v[28:31], v3 offset:1024
  v_mfma_f32_16x16x32_bf16 v[112:115], v[40:43], v[152:155], v[112:115]
  ds_read_b64_tr_b16 v[164:165], v5 offset:8192
  v_mfma_f32_16x16x32_bf16 v[120:123], v[40:43], v[156:159], v[120:123]
  ds_read_b64_tr_b16 v[166:167], v5 offset:9216
  v_mfma_f32_16x16x32_bf16 v[124:127], v[44:47], v[156:159], v[124:127]
  ds_read_b64_tr_b16 v[168:169], v6 offset:8192
  v_mfma_f32_16x16x32_bf16 v[116:119], v[44:47], v[152:155], v[116:119]
  ds_read_b64_tr_b16 v[170:171], v6 offset:9216
  v_mfma_f32_16x16x32_bf16 v[108:111], v[44:47], v[148:151], v[108:111]
  ds_read_b64_tr_b16 v[172:173], v7 offset:8192
  v_mfma_f32_16x16x32_bf16 v[100:103], v[44:47], v[144:147], v[100:103]
  ds_read_b64_tr_b16 v[174:175], v7 offset:9216
  s_waitcnt lgkmcnt(0)
  s_waitcnt vmcnt(0)
  s_barrier
  buffer_store_dwordx4 v[56:59], v54, s[16:19], s38 offen sc1
  v_mfma_f32_16x16x32_bf16 v[64:67], v[16:19], v[128:131], v[64:67]
  ds_read_b64_tr_b16 v[176:177], v4 offset:49152
  ds_read_b64_tr_b16 v[178:179], v4 offset:50176
  v_mfma_f32_16x16x32_bf16 v[72:75], v[16:19], v[132:135], v[72:75]
  ds_read_b128 v[32:35], v2 offset:49152
  ds_read_b128 v[40:43], v2 offset:50176
  v_mfma_f32_16x16x32_bf16 v[80:83], v[16:19], v[136:139], v[80:83]
  ds_read_b64_tr_b16 v[180:181], v5 offset:49152
  ds_read_b64_tr_b16 v[182:183], v5 offset:50176
  v_mfma_f32_16x16x32_bf16 v[88:91], v[16:19], v[140:143], v[88:91]
  ds_read_b64_tr_b16 v[184:185], v6 offset:49152
  ds_read_b64_tr_b16 v[186:187], v6 offset:50176
  v_mfma_f32_16x16x32_bf16 v[92:95], v[24:27], v[140:143], v[92:95]
  ds_read_b64_tr_b16 v[188:189], v7 offset:49152
  v_mfma_f32_16x16x32_bf16 v[84:87], v[24:27], v[136:139], v[84:87]
  ds_read_b64_tr_b16 v[190:191], v7 offset:50176
  v_mfma_f32_16x16x32_bf16 v[76:79], v[24:27], v[132:135], v[76:79]
  ds_read_b64_tr_b16 v[144:145], v4 offset:57344
  v_mfma_f32_16x16x32_bf16 v[68:71], v[24:27], v[128:131], v[68:71]
  ds_read_b64_tr_b16 v[146:147], v4 offset:58368
  v_mfma_f32_16x16x32_bf16 v[64:67], v[20:23], v[160:163], v[64:67]
  ds_read_b128 v[36:39], v3 offset:49152
  v_mfma_f32_16x16x32_bf16 v[72:75], v[20:23], v[164:167], v[72:75]
  ds_read_b128 v[44:47], v3 offset:50176
  v_mfma_f32_16x16x32_bf16 v[80:83], v[20:23], v[168:171], v[80:83]
  ds_read_b64_tr_b16 v[148:149], v5 offset:57344
  v_mfma_f32_16x16x32_bf16 v[88:91], v[20:23], v[172:175], v[88:91]
  ds_read_b64_tr_b16 v[150:151], v5 offset:58368
  v_mfma_f32_16x16x32_bf16 v[92:95], v[28:31], v[172:175], v[92:95]
  ds_read_b64_tr_b16 v[152:153], v6 offset:57344
  v_mfma_f32_16x16x32_bf16 v[84:87], v[28:31], v[168:171], v[84:87]
  ds_read_b64_tr_b16 v[154:155], v6 offset:58368
  v_mfma_f32_16x16x32_bf16 v[76:79], v[28:31], v[164:167], v[76:79]
  ds_read_b64_tr_b16 v[156:157], v7 offset:57344
  v_mfma_f32_16x16x32_bf16 v[68:71], v[28:31], v[160:163], v[68:71]
  ds_read_b64_tr_b16 v[158:159], v7 offset:58368
  s_waitcnt lgkmcnt(0)
  v_mfma_f32_16x16x32_bf16 v[64:67], v[32:35], v[176:179], v[64:67]
  ds_read_b128 v[16:19], v2 offset:4096
  v_mfma_f32_16x16x32_bf16 v[72:75], v[32:35], v[180:183], v[72:75]
  ds_read_b128 v[24:27], v2 offset:5120
  v_mfma_f32_16x16x32_bf16 v[80:83], v[32:35], v[184:187], v[80:83]
  ds_read_b128 v[20:23], v3 offset:4096
  v_mfma_f32_16x16x32_bf16 v[88:91], v[32:35], v[188:191], v[88:91]
  ds_read_b128 v[28:31], v3 offset:5120
  v_mfma_f32_16x16x32_bf16 v[68:71], v[40:43], v[176:179], v[68:71]
  v_mfma_f32_16x16x32_bf16 v[76:79], v[40:43], v[180:183], v[76:79]
  v_mfma_f32_16x16x32_bf16 v[84:87], v[40:43], v[184:187], v[84:87]
  v_mfma_f32_16x16x32_bf16 v[92:95], v[40:43], v[188:191], v[92:95]
  v_mfma_f32_16x16x32_bf16 v[64:67], v[36:39], v[144:147], v[64:67]
  v_mfma_f32_16x16x32_bf16 v[68:71], v[44:47], v[144:147], v[68:71]
  v_mfma_f32_16x16x32_bf16 v[72:75], v[36:39], v[148:151], v[72:75]
  v_mfma_f32_16x16x32_bf16 v[76:79], v[44:47], v[148:151], v[76:79]
  v_mfma_f32_16x16x32_bf16 v[80:83], v[36:39], v[152:155], v[80:83]
  v_mfma_f32_16x16x32_bf16 v[84:87], v[44:47], v[152:155], v[84:87]
  v_mfma_f32_16x16x32_bf16 v[88:91], v[36:39], v[156:159], v[88:91]
  v_mfma_f32_16x16x32_bf16 v[92:95], v[44:47], v[156:159], v[92:95]
  s_waitcnt lgkmcnt(0)
  v_mfma_f32_16x16x32_bf16 v[96:99], v[16:19], v[128:131], v[96:99]
  ds_read_b128 v[32:35], v2 offset:53248
  v_mfma_f32_16x16x32_bf16 v[104:107], v[16:19], v[132:135], v[104:107]
  ds_read_b128 v[40:43], v2 offset:54272
  v_mfma_f32_16x16x32_bf16 v[112:115], v[16:19], v[136:139], v[112:115]
  ds_read_b128 v[36:39], v3 offset:53248
  v_cvt_pk_bf16_f32 v64, v64, v65
  v_cvt_pk_bf16_f32 v65, v66, v67
  v_mfma_f32_16x16x32_bf16 v[120:123], v[16:19], v[140:143], v[120:123]
  ds_read_b128 v[44:47], v3 offset:54272
  v_cvt_pk_bf16_f32 v66, v68, v69
  v_cvt_pk_bf16_f32 v67, v70, v71
  v_mfma_f32_16x16x32_bf16 v[124:127], v[24:27], v[140:143], v[124:127]
  buffer_store_dwordx4 v[64:67], v50, s[16:19], s38 offen sc1
  v_mfma_f32_16x16x32_bf16 v[116:119], v[24:27], v[136:139], v[116:119]
  v_cvt_pk_bf16_f32 v68, v72, v73
  v_cvt_pk_bf16_f32 v69, v74, v75
  v_mfma_f32_16x16x32_bf16 v[108:111], v[24:27], v[132:135], v[108:111]
  v_cvt_pk_bf16_f32 v70, v76, v77
  v_cvt_pk_bf16_f32 v71, v78, v79
  v_mfma_f32_16x16x32_bf16 v[100:103], v[24:27], v[128:131], v[100:103]
  buffer_store_dwordx4 v[68:71], v51, s[16:19], s38 offen sc1
  v_mfma_f32_16x16x32_bf16 v[96:99], v[20:23], v[160:163], v[96:99]
  v_cvt_pk_bf16_f32 v72, v80, v81
  v_cvt_pk_bf16_f32 v73, v82, v83
  v_mfma_f32_16x16x32_bf16 v[104:107], v[20:23], v[164:167], v[104:107]
  v_cvt_pk_bf16_f32 v74, v84, v85
  v_cvt_pk_bf16_f32 v75, v86, v87
  v_mfma_f32_16x16x32_bf16 v[112:115], v[20:23], v[168:171], v[112:115]
  buffer_store_dwordx4 v[72:75], v52, s[16:19], s38 offen sc1
  v_mfma_f32_16x16x32_bf16 v[120:123], v[20:23], v[172:175], v[120:123]
  v_cvt_pk_bf16_f32 v76, v88, v89
  v_cvt_pk_bf16_f32 v77, v90, v91
  v_mfma_f32_16x16x32_bf16 v[124:127], v[28:31], v[172:175], v[124:127]
  v_cvt_pk_bf16_f32 v78, v92, v93
  v_cvt_pk_bf16_f32 v79, v94, v95
  v_mfma_f32_16x16x32_bf16 v[116:119], v[28:31], v[168:171], v[116:119]
  buffer_store_dwordx4 v[76:79], v53, s[16:19], s38 offen sc1
  v_mfma_f32_16x16x32_bf16 v[108:111], v[28:31], v[164:167], v[108:111]
  v_mfma_f32_16x16x32_bf16 v[100:103], v[28:31], v[160:163], v[100:103]
  s_waitcnt lgkmcnt(0)
  v_mfma_f32_16x16x32_bf16 v[96:99], v[32:35], v[176:179], v[96:99]
  v_mfma_f32_16x16x32_bf16 v[104:107], v[32:35], v[180:183], v[104:107]
  v_mfma_f32_16x16x32_bf16 v[112:115], v[32:35], v[184:187], v[112:115]
  v_mfma_f32_16x16x32_bf16 v[120:123], v[32:35], v[188:191], v[120:123]
  v_mfma_f32_16x16x32_bf16 v[100:103], v[40:43], v[176:179], v[100:103]
  v_mfma_f32_16x16x32_bf16 v[108:111], v[40:43], v[180:183], v[108:111]
  v_mfma_f32_16x16x32_bf16 v[116:119], v[40:43], v[184:187], v[116:119]
  v_mfma_f32_16x16x32_bf16 v[124:127], v[40:43], v[188:191], v[124:127]
  v_mfma_f32_16x16x32_bf16 v[96:99], v[36:39], v[144:147], v[96:99]
  v_mfma_f32_16x16x32_bf16 v[100:103], v[44:47], v[144:147], v[100:103]
  v_mfma_f32_16x16x32_bf16 v[104:107], v[36:39], v[148:151], v[104:107]
  v_mfma_f32_16x16x32_bf16 v[108:111], v[44:47], v[148:151], v[108:111]
  v_mfma_f32_16x16x32_bf16 v[112:115], v[36:39], v[152:155], v[112:115]
  v_mfma_f32_16x16x32_bf16 v[116:119], v[44:47], v[152:155], v[116:119]
  v_mfma_f32_16x16x32_bf16 v[120:123], v[36:39], v[156:159], v[120:123]
  v_mfma_f32_16x16x32_bf16 v[124:127], v[44:47], v[156:159], v[124:127]
  s_nop 1
  v_cvt_pk_bf16_f32 v80, v96, v97
  v_cvt_pk_bf16_f32 v81, v98, v99
  v_cvt_pk_bf16_f32 v82, v100, v101
  v_cvt_pk_bf16_f32 v83, v102, v103
  buffer_store_dwordx4 v[80:83], v50, s[16:19], s39 offen sc1
  v_cvt_pk_bf16_f32 v84, v104, v105
  v_cvt_pk_bf16_f32 v85, v106, v107
  v_cvt_pk_bf16_f32 v86, v108, v109
  v_cvt_pk_bf16_f32 v87, v110, v111
  buffer_store_dwordx4 v[84:87], v51, s[16:19], s39 offen sc1
  v_cvt_pk_bf16_f32 v88, v112, v113
  v_cvt_pk_bf16_f32 v89, v114, v115
  v_cvt_pk_bf16_f32 v90, v116, v117
  v_cvt_pk_bf16_f32 v91, v118, v119
  buffer_store_dwordx4 v[88:91], v52, s[16:19], s39 offen sc1
  v_cvt_pk_bf16_f32 v92, v120, v121
  v_cvt_pk_bf16_f32 v93, v122, v123
  v_cvt_pk_bf16_f32 v94, v124, v125
  v_cvt_pk_bf16_f32 v95, v126, v127
  buffer_store_dwordx4 v[92:95], v53, s[16:19], s39 offen sc1
  s_endpgm
k1_qkv_kernel_pad:
  s_add_u32 s30, s23, 442368
  s_add_u32 m0, s25, 98304
  s_nop 0
  buffer_load_dwordx4 v10, s[12:15], s30 offen  lds
  s_add_u32 s30, s23, 456192
  s_add_u32 m0, s25, 99328
  s_nop 0
  buffer_load_dwordx4 v10, s[12:15], s30 offen  lds
  s_add_u32 s30, s22, 256
  s_add_u32 m0, s24, 98304
  s_nop 0
  buffer_load_dwordx4 v8, s[8:11], s30 offen  lds
  s_add_u32 s30, s22, 9472
  s_add_u32 m0, s24, 99328
  s_nop 0
  buffer_load_dwordx4 v48, s[8:11], s30 offen  lds
  s_add_u32 s30, s22, 18688
  s_add_u32 m0, s24, 100352
  s_nop 0
  buffer_load_dwordx4 v49, s[8:11], s30 offen  lds
  s_add_u32 s30, s22, 27904
  s_add_u32 m0, s24, 101376
  s_nop 0
  buffer_load_dwordx4 v9, s[8:11], s30 offen  lds
  s_waitcnt vmcnt(6)
  s_barrier
  s_add_u32 s30, s23, 663552
  s_add_u32 m0, s25, 0
  s_nop 0
  buffer_load_dwordx4 v10, s[12:15], s30 offen  lds
  s_add_u32 s30, s23, 677376
  s_add_u32 m0, s25, 1024
  s_nop 0
  buffer_load_dwordx4 v10, s[12:15], s30 offen  lds
  s_add_u32 s30, s22, 384
  s_add_u32 m0, s24, 0
  s_nop 0
  buffer_load_dwordx4 v8, s[8:11], s30 offen  lds
  s_add_u32 s30, s22, 9600
  s_add_u32 m0, s24, 1024
  s_nop 0
  buffer_load_dwordx4 v48, s[8:11], s30 offen  lds
  s_add_u32 s30, s22, 18816
  s_add_u32 m0, s24, 2048
  s_nop 0
  buffer_load_dwordx4 v49, s[8:11], s30 offen  lds
  s_add_u32 s30, s22, 28032
  s_add_u32 m0, s24, 3072
  s_nop 0
  buffer_load_dwordx4 v9, s[8:11], s30 offen  lds
  s_waitcnt vmcnt(6)
  s_barrier
  s_add_u32 s30, s23, 884736
  s_add_u32 m0, s25, 49152
  s_nop 0
  buffer_load_dwordx4 v10, s[12:15], s30 offen  lds
  s_add_u32 s30, s23, 898560
  s_add_u32 m0, s25, 50176
  s_nop 0
  buffer_load_dwordx4 v10, s[12:15], s30 offen  lds
  s_add_u32 s30, s22, 512
  s_add_u32 m0, s24, 49152
  s_nop 0
  buffer_load_dwordx4 v8, s[8:11], s30 offen  lds
  s_add_u32 s30, s22, 9728
  s_add_u32 m0, s24, 50176
  s_nop 0
  buffer_load_dwordx4 v48, s[8:11], s30 offen  lds
  s_add_u32 s30, s22, 18944
  s_add_u32 m0, s24, 51200
  s_nop 0
  buffer_load_dwordx4 v49, s[8:11], s30 offen  lds
  s_add_u32 s30, s22, 28160
  s_add_u32 m0, s24, 52224
  s_nop 0
  buffer_load_dwordx4 v9, s[8:11], s30 offen  lds
  s_waitcnt vmcnt(6)
  s_barrier
  s_add_u32 s30, s23, 1105920
  s_add_u32 m0, s25, 98304
  s_nop 0
  buffer_load_dwordx4 v10, s[12:15], s30 offen  lds
  s_add_u32 s30, s23, 1119744
  s_add_u32 m0, s25, 99328
  s_nop 0
  buffer_load_dwordx4 v10, s[12:15], s30 offen  lds
  s_add_u32 s30, s22, 640
  s_add_u32 m0, s24, 98304
  s_nop 0
  buffer_load_dwordx4 v8, s[8:11], s30 offen  lds
  s_add_u32 s30, s22, 9856
  s_add_u32 m0, s24, 99328
  s_nop 0
  buffer_load_dwordx4 v48, s[8:11], s30 offen  lds
  s_add_u32 s30, s22, 19072
  s_add_u32 m0, s24, 100352
  s_nop 0
  buffer_load_dwordx4 v49, s[8:11], s30 offen  lds
  s_add_u32 s30, s22, 28288
  s_add_u32 m0, s24, 101376
  s_nop 0
  buffer_load_dwordx4 v9, s[8:11], s30 offen  lds
  s_waitcnt vmcnt(6)
  s_barrier
  s_add_u32 s30, s23, 1327104
  s_add_u32 m0, s25, 0
  s_nop 0
  buffer_load_dwordx4 v10, s[12:15], s30 offen  lds
  s_add_u32 s30, s23, 1340928
  s_add_u32 m0, s25, 1024
  s_nop 0
  buffer_load_dwordx4 v10, s[12:15], s30 offen  lds
  s_add_u32 s30, s22, 768
  s_add_u32 m0, s24, 0
  s_nop 0
  buffer_load_dwordx4 v8, s[8:11], s30 offen  lds
  s_add_u32 s30, s22, 9984
  s_add_u32 m0, s24, 1024
  s_nop 0
  buffer_load_dwordx4 v48, s[8:11], s30 offen  lds
  s_add_u32 s30, s22, 19200
  s_add_u32 m0, s24, 2048
  s_nop 0
  buffer_load_dwordx4 v49, s[8:11], s30 offen  lds
  s_add_u32 s30, s22, 28416
  s_add_u32 m0, s24, 3072
  s_nop 0
  buffer_load_dwordx4 v9, s[8:11], s30 offen  lds
  s_waitcnt vmcnt(6)
  s_barrier
  s_add_u32 s30, s23, 1548288
  s_add_u32 m0, s25, 49152
  s_nop 0
  buffer_load_dwordx4 v10, s[12:15], s30 offen  lds
  s_add_u32 s30, s23, 1562112
  s_add_u32 m0, s25, 50176
  s_nop 0
  buffer_load_dwordx4 v10, s[12:15], s30 offen  lds
  s_add_u32 s30, s22, 896
  s_add_u32 m0, s24, 49152
  s_nop 0
  buffer_load_dwordx4 v8, s[8:11], s30 offen  lds
  s_add_u32 s30, s22, 10112
  s_add_u32 m0, s24, 50176
  s_nop 0
  buffer_load_dwordx4 v48, s[8:11], s30 offen  lds
  s_add_u32 s30, s22, 19328
  s_add_u32 m0, s24, 51200
  s_nop 0
  buffer_load_dwordx4 v49, s[8:11], s30 offen  lds
  s_add_u32 s30, s22, 28544
  s_add_u32 m0, s24, 52224
  s_nop 0
  buffer_load_dwordx4 v9, s[8:11], s30 offen  lds
  s_waitcnt vmcnt(6)
  s_barrier
  s_add_u32 s30, s23, 1769472
  s_add_u32 m0, s25, 98304
  s_nop 0
  buffer_load_dwordx4 v10, s[12:15], s30 offen  lds
  s_add_u32 s30, s23, 1783296
  s_add_u32 m0, s25, 99328
  s_nop 0
  buffer_load_dwordx4 v10, s[12:15], s30 offen  lds
  s_add_u32 s30, s22, 1024
  s_add_u32 m0, s24, 98304
  s_nop 0
  buffer_load_dwordx4 v8, s[8:11], s30 offen  lds
  s_add_u32 s30, s22, 10240
  s_add_u32 m0, s24, 99328
  s_nop 0
  buffer_load_dwordx4 v48, s[8:11], s30 offen  lds
  s_add_u32 s30, s22, 19456
  s_add_u32 m0, s24, 100352
  s_nop 0
  buffer_load_dwordx4 v49, s[8:11], s30 offen  lds
  s_add_u32 s30, s22, 28672
  s_add_u32 m0, s24, 101376
  s_nop 0
  buffer_load_dwordx4 v9, s[8:11], s30 offen  lds
  s_waitcnt vmcnt(6)
  s_barrier
  s_waitcnt vmcnt(0)
  s_barrier
  s_endpgm
k1_qkv_kernel_gate0:
k1_qkv_kernel_gate:
  s_load_dwordx2 s[12:13], s[0:1], 48
  s_load_dwordx2 s[22:23], s[0:1], 8
  s_load_dwordx2 s[24:25], s[0:1], 32
  s_and_b32 s3, s2, 7
  s_sub_u32 s4, s2, 224
  s_lshr_b32 s4, s4, 3
  s_and_b32 s28, s3, 1
  s_lshr_b32 s29, s3, 1
  s_lshl_b32 s6, s28, 10
  s_lshl_b32 s7, s29, 8
  s_add_u32 s6, s6, s7
  s_lshl_b32 s7, s4, 6
  s_add_u32 s6, s6, s7
  s_lshl_b32 s7, s5, 3
  s_add_u32 s6, s6, s7
  v_lshrrev_b32 v11, 3, v1
  v_add_u32 v11, s6, v11
  v_and_b32 v12, 7, v1
  v_lshlrev_b32 v12, 4, v12
  v_mul_u32_u24 v13, 1152, v11
  v_add_u32 v13, v13, v12
  s_waitcnt lgkmcnt(0)
  s_and_b32 s9, s9, 0xffff
  s_mov_b32 s10, 2359296
  s_mov_b32 s11, 0x20000
  s_and_b32 s13, s13, 0xffff
  s_mov_b32 s14, 1152
  s_mov_b32 s15, 0x20000
  buffer_load_dwordx4 v[16:19], v13, s[8:11], 0 offen offset:0
  buffer_load_dwordx4 v[64:67], v12, s[12:15], 0 offen offset:0
  buffer_load_dwordx4 v[20:23], v13, s[8:11], 0 offen offset:128
  buffer_load_dwordx4 v[68:71], v12, s[12:15], 0 offen offset:128
  buffer_load_dwordx4 v[24:27], v13, s[8:11], 0 offen offset:256
  buffer_load_dwordx4 v[72:75], v12, s[12:15], 0 offen offset:256
  buffer_load_dwordx4 v[28:31], v13, s[8:11], 0 offen offset:384
  buffer_load_dwordx4 v[76:79], v12, s[12:15], 0 offen offset:384
  buffer_load_dwordx4 v[32:35], v13, s[8:11], 0 offen offset:512
  buffer_load_dwordx4 v[80:83], v12, s[12:15], 0 offen offset:512
  buffer_load_dwordx4 v[36:39], v13, s[8:11], 0 offen offset:640
  buffer_load_dwordx4 v[84:87], v12, s[12:15], 0 offen offset:640
  buffer_load_dwordx4 v[40:43], v13, s[8:11], 0 offen offset:768
  buffer_load_dwordx4 v[88:91], v12, s[12:15], 0 offen offset:768
  buffer_load_dwordx4 v[44:47], v13, s[8:11], 0 offen offset:896
  buffer_load_dwordx4 v[92:95], v12, s[12:15], 0 offen offset:896
  buffer_load_dwordx4 v[48:51], v13, s[8:11], 0 offen offset:1024
  buffer_load_dwordx4 v[96:99], v12, s[12:15], 0 offen offset:1024
  s_mov_b32 s16, s20
  s_and_b32 s17, s21, 0xffff
  s_mov_b32 s18, 0x2000000
  s_mov_b32 s19, 0x20000
  v_mov_b32 v14, 0
  v_mov_b32 v15, 0
  s_waitcnt vmcnt(16)
  v_dot2_f32_bf16 v14, v16, v64, v14
  v_dot2_f32_bf16 v15, v17, v65, v15
  v_dot2_f32_bf16 v14, v18, v66, v14
  v_dot2_f32_bf16 v15, v19, v67, v15
  s_waitcnt vmcnt(14)
  v_dot2_f32_bf16 v14, v20, v68, v14
  v_dot2_f32_bf16 v15, v21, v69, v15
  v_dot2_f32_bf16 v14, v22, v70, v14
  v_dot2_f32_bf16 v15, v23, v71, v15
  s_waitcnt vmcnt(12)
  v_dot2_f32_bf16 v14, v24, v72, v14
  v_dot2_f32_bf16 v15, v25, v73, v15
  v_dot2_f32_bf16 v14, v26, v74, v14
  v_dot2_f32_bf16 v15, v27, v75, v15
  s_waitcnt vmcnt(10)
  v_dot2_f32_bf16 v14, v28, v76, v14
  v_dot2_f32_bf16 v15, v29, v77, v15
  v_dot2_f32_bf16 v14, v30, v78, v14
  v_dot2_f32_bf16 v15, v31, v79, v15
  s_waitcnt vmcnt(8)
  v_dot2_f32_bf16 v14, v32, v80, v14
  v_dot2_f32_bf16 v15, v33, v81, v15
  v_dot2_f32_bf16 v14, v34, v82, v14
  v_dot2_f32_bf16 v15, v35, v83, v15
  s_waitcnt vmcnt(6)
  v_dot2_f32_bf16 v14, v36, v84, v14
  v_dot2_f32_bf16 v15, v37, v85, v15
  v_dot2_f32_bf16 v14, v38, v86, v14
  v_dot2_f32_bf16 v15, v39, v87, v15
  s_waitcnt vmcnt(4)
  v_dot2_f32_bf16 v14, v40, v88, v14
  v_dot2_f32_bf16 v15, v41, v89, v15
  v_dot2_f32_bf16 v14, v42, v90, v14
  v_dot2_f32_bf16 v15, v43, v91, v15
  s_waitcnt vmcnt(2)
  v_dot2_f32_bf16 v14, v44, v92, v14
  v_dot2_f32_bf16 v15, v45, v93, v15
  v_dot2_f32_bf16 v14, v46, v94, v14
  v_dot2_f32_bf16 v15, v47, v95, v15
  s_waitcnt vmcnt(0)
  v_dot2_f32_bf16 v14, v48, v96, v14
  v_dot2_f32_bf16 v15, v49, v97, v15
  v_dot2_f32_bf16 v14, v50, v98, v14
  v_dot2_f32_bf16 v15, v51, v99, v15
  s_nop 4
  v_add_f32 v14, v14, v15
  s_nop 1
  v_add_f32_dpp v14, v14, v14 quad_perm:[1,0,3,2] row_mask:0xf bank_mask:0xf
  s_nop 1
  v_add_f32_dpp v14, v14, v14 quad_perm:[2,3,0,1] row_mask:0xf bank_mask:0xf
  s_nop 1
  v_add_f32_dpp v14, v14, v14 row_half_mirror row_mask:0xf bank_mask:0xf
  s_nop 1
  v_mul_f32 v14, 3216550459, v14
  v_exp_f32 v14, v14
  s_nop 0
  v_add_f32 v14, 1.0, v14
  v_rcp_f32 v14, v14
  v_lshlrev_b32 v11, 2, v11
  v_add_u32 v11, 23068672, v11
  v_and_b32 v12, 7, v1
  v_cmp_eq_u32 vcc, 0, v12
  s_and_saveexec_b64 s[30:31], vcc
  buffer_store_dword v14, v11, s[16:19], 0 offen
  s_mov_b64 exec, -1
  s_load_dwordx2 s[12:13], s[0:1], 16
  s_load_dwordx2 s[22:23], s[0:1], 40
  s_sub_u32 s44, s2, 224
  s_lshl_b32 s44, s44, 3
  s_add_u32 s44, s44, s5
  v_lshlrev_b32 v15, 4, v1
  v_mov_b32 v136, 0
  v_mov_b32 v137, 0
  v_mov_b32 v138, 0
  v_mov_b32 v139, 0
  s_cmp_ge_u32 s44, 40
  s_cbranch_scc1 k1_qkv_kernel_nozero
  s_lshl_b32 s6, s44, 10
  s_add_u32 s6, s6, 23134208
  buffer_store_dwordx4 v[136:139], v15, s[16:19], s6 offen
k1_qkv_kernel_nozero:
  v_and_b32 v11, 15, v1
  v_lshlrev_b32 v150, 1, v11
  v_lshrrev_b32 v151, 2, v11
  v_lshlrev_b32 v151, 4, v151
  v_and_b32 v11, 3, v11
  v_lshl_add_u32 v151, v11, 1, v151
  v_mov_b32 v11, 0
  v_lshrrev_b32 v12, 4, v1
  v_mul_u32_u24 v13, 82944, v12
  v_add_u32 v13, 18432, v13
  v_add_u32 v13, v13, v11
  v_lshrrev_b32 v14, 1, v12
  v_mul_u32_u24 v14, 20736, v14
  v_add_u32 v14, v14, v11
  v_and_b32 v12, 1, v12
  v_mul_u32_u24 v12, 4608, v12
  v_add_u32 v14, v14, v12
  s_waitcnt lgkmcnt(0)
  s_and_b32 s13, s13, 0xffff
  s_mov_b32 s14, 663552
  s_mov_b32 s15, 0x20000
  s_mov_b32 s24, s22
  s_and_b32 s25, s23, 0xffff
  s_mov_b32 s26, 663552
  s_mov_b32 s27, 0x20000
  s_add_u32 s45, s44, 0
  s_min_u32 s45, s45, 647
  s_mov_b32 s48, s45
  s_mul_i32 s46, s45, 3641
  s_lshr_b32 s46, s46, 16
  s_mul_i32 s47, s46, 18
  s_sub_u32 s47, s45, s47
  s_mul_i32 s6, s46, 7282
  s_lshr_b32 s6, s6, 16
  s_mul_i32 s7, s6, 9
  s_sub_u32 s7, s46, s7
  s_mul_i32 s46, s6, 288
  s_and_b32 s6, s6, 1
  s_lshl_b32 s52, s6, 5
  s_lshr_b32 s53, s7, 1
  s_lshl_b32 s53, s53, 6
  s_add_u32 s52, s52, s53
  s_and_b32 s53, s7, 1
  s_lshl_b32 s53, s53, 3
  s_add_u32 s52, s52, s53
  s_cmp_eq_u32 s6, 0
  s_cselect_b32 s53, 256, 0
  s_cmp_eq_u32 s7, 8
  s_cselect_b32 s52, s53, s52
  s_cselect_b64 s[54:55], -1, 0
  s_add_u32 s46, s46, s52
  s_mul_i32 s6, s47, 41472
  s_sub_u32 s7, s47, 16
  s_mul_i32 s7, s7, 331776
  s_cmp_lt_u32 s47, 16
  s_cselect_b32 s6, s6, s7
  s_cselect_b64 vcc, -1, 0
  s_add_u32 s46, s46, s6
  s_cmp_lt_u32 s47, 16
  v_cndmask_b32 v11, v13, v14, vcc
  v_cndmask_b32 v152, v151, v150, s[54:55]
  v_add_u32 v11, v11, v152
  s_mov_b32 s6, 0
  s_cselect_b32 s6, 0, s6
  s_add_u32 s6, s6, s46
  s_cmp_lt_u32 s47, 16
  buffer_load_ushort v100, v11, s[12:15], s6 offen
  buffer_load_ushort v16, v11, s[24:27], s6 offen
  s_mov_b32 s6, 1152
  s_cselect_b32 s6, 1152, s6
  s_add_u32 s6, s6, s46
  s_cmp_lt_u32 s47, 16
  buffer_load_ushort v101, v11, s[12:15], s6 offen
  buffer_load_ushort v17, v11, s[24:27], s6 offen
  s_mov_b32 s6, 20736
  s_cselect_b32 s6, 2304, s6
  s_add_u32 s6, s6, s46
  s_cmp_lt_u32 s47, 16
  buffer_load_ushort v102, v11, s[12:15], s6 offen
  buffer_load_ushort v18, v11, s[24:27], s6 offen
  s_mov_b32 s6, 21888
  s_cselect_b32 s6, 3456, s6
  s_add_u32 s6, s6, s46
  s_cmp_lt_u32 s47, 16
  buffer_load_ushort v103, v11, s[12:15], s6 offen
  buffer_load_ushort v19, v11, s[24:27], s6 offen
  s_mov_b32 s6, 41472
  s_cselect_b32 s6, 9216, s6
  s_add_u32 s6, s6, s46
  s_cmp_lt_u32 s47, 16
  buffer_load_ushort v104, v11, s[12:15], s6 offen
  buffer_load_ushort v20, v11, s[24:27], s6 offen
  s_mov_b32 s6, 42624
  s_cselect_b32 s6, 10368, s6
  s_add_u32 s6, s6, s46
  s_cmp_lt_u32 s47, 16
  buffer_load_ushort v105, v11, s[12:15], s6 offen
  buffer_load_ushort v21, v11, s[24:27], s6 offen
  s_mov_b32 s6, 62208
  s_cselect_b32 s6, 11520, s6
  s_add_u32 s6, s6, s46
  s_cmp_lt_u32 s47, 16
  buffer_load_ushort v106, v11, s[12:15], s6 offen
  buffer_load_ushort v22, v11, s[24:27], s6 offen
  s_mov_b32 s6, 63360
  s_cselect_b32 s6, 12672, s6
  s_add_u32 s6, s6, s46
  s_cmp_lt_u32 s47, 16
  buffer_load_ushort v107, v11, s[12:15], s6 offen
  buffer_load_ushort v23, v11, s[24:27], s6 offen
  s_add_u32 s45, s44, 256
  s_min_u32 s45, s45, 647
  s_mov_b32 s49, s45
  s_mul_i32 s46, s45, 3641
  s_lshr_b32 s46, s46, 16
  s_mul_i32 s47, s46, 18
  s_sub_u32 s47, s45, s47
  s_mul_i32 s6, s46, 7282
  s_lshr_b32 s6, s6, 16
  s_mul_i32 s7, s6, 9
  s_sub_u32 s7, s46, s7
  s_mul_i32 s46, s6, 288
  s_and_b32 s6, s6, 1
  s_lshl_b32 s52, s6, 5
  s_lshr_b32 s53, s7, 1
  s_lshl_b32 s53, s53, 6
  s_add_u32 s52, s52, s53
  s_and_b32 s53, s7, 1
  s_lshl_b32 s53, s53, 3
  s_add_u32 s52, s52, s53
  s_cmp_eq_u32 s6, 0
  s_cselect_b32 s53, 256, 0
  s_cmp_eq_u32 s7, 8
  s_cselect_b32 s52, s53, s52
  s_cselect_b64 s[54:55], -1, 0
  s_add_u32 s46, s46, s52
  s_mul_i32 s6, s47, 41472
  s_sub_u32 s7, s47, 16
  s_mul_i32 s7, s7, 331776
  s_cmp_lt_u32 s47, 16
  s_cselect_b32 s6, s6, s7
  s_cselect_b64 vcc, -1, 0
  s_add_u32 s46, s46, s6
  s_cmp_lt_u32 s47, 16
  v_cndmask_b32 v11, v13, v14, vcc
  v_cndmask_b32 v152, v151, v150, s[54:55]
  v_add_u32 v11, v11, v152
  s_mov_b32 s6, 0
  s_cselect_b32 s6, 0, s6
  s_add_u32 s6, s6, s46
  s_cmp_lt_u32 s47, 16
  buffer_load_ushort v108, v11, s[12:15], s6 offen
  buffer_load_ushort v24, v11, s[24:27], s6 offen
  s_mov_b32 s6, 1152
  s_cselect_b32 s6, 1152, s6
  s_add_u32 s6, s6, s46
  s_cmp_lt_u32 s47, 16
  buffer_load_ushort v109, v11, s[12:15], s6 offen
  buffer_load_ushort v25, v11, s[24:27], s6 offen
  s_mov_b32 s6, 20736
  s_cselect_b32 s6, 2304, s6
  s_add_u32 s6, s6, s46
  s_cmp_lt_u32 s47, 16
  buffer_load_ushort v110, v11, s[12:15], s6 offen
  buffer_load_ushort v26, v11, s[24:27], s6 offen
  s_mov_b32 s6, 21888
  s_cselect_b32 s6, 3456, s6
  s_add_u32 s6, s6, s46
  s_cmp_lt_u32 s47, 16
  buffer_load_ushort v111, v11, s[12:15], s6 offen
  buffer_load_ushort v27, v11, s[24:27], s6 offen
  s_mov_b32 s6, 41472
  s_cselect_b32 s6, 9216, s6
  s_add_u32 s6, s6, s46
  s_cmp_lt_u32 s47, 16
  buffer_load_ushort v112, v11, s[12:15], s6 offen
  buffer_load_ushort v28, v11, s[24:27], s6 offen
  s_mov_b32 s6, 42624
  s_cselect_b32 s6, 10368, s6
  s_add_u32 s6, s6, s46
  s_cmp_lt_u32 s47, 16
  buffer_load_ushort v113, v11, s[12:15], s6 offen
  buffer_load_ushort v29, v11, s[24:27], s6 offen
  s_mov_b32 s6, 62208
  s_cselect_b32 s6, 11520, s6
  s_add_u32 s6, s6, s46
  s_cmp_lt_u32 s47, 16
  buffer_load_ushort v114, v11, s[12:15], s6 offen
  buffer_load_ushort v30, v11, s[24:27], s6 offen
  s_mov_b32 s6, 63360
  s_cselect_b32 s6, 12672, s6
  s_add_u32 s6, s6, s46
  s_cmp_lt_u32 s47, 16
  buffer_load_ushort v115, v11, s[12:15], s6 offen
  buffer_load_ushort v31, v11, s[24:27], s6 offen
  s_add_u32 s45, s44, 512
  s_min_u32 s45, s45, 647
  s_mov_b32 s50, s45
  s_mul_i32 s46, s45, 3641
  s_lshr_b32 s46, s46, 16
  s_mul_i32 s47, s46, 18
  s_sub_u32 s47, s45, s47
  s_mul_i32 s6, s46, 7282
  s_lshr_b32 s6, s6, 16
  s_mul_i32 s7, s6, 9
  s_sub_u32 s7, s46, s7
  s_mul_i32 s46, s6, 288
  s_and_b32 s6, s6, 1
  s_lshl_b32 s52, s6, 5
  s_lshr_b32 s53, s7, 1
  s_lshl_b32 s53, s53, 6
  s_add_u32 s52, s52, s53
  s_and_b32 s53, s7, 1
  s_lshl_b32 s53, s53, 3
  s_add_u32 s52, s52, s53
  s_cmp_eq_u32 s6, 0
  s_cselect_b32 s53, 256, 0
  s_cmp_eq_u32 s7, 8
  s_cselect_b32 s52, s53, s52
  s_cselect_b64 s[54:55], -1, 0
  s_add_u32 s46, s46, s52
  s_mul_i32 s6, s47, 41472
  s_sub_u32 s7, s47, 16
  s_mul_i32 s7, s7, 331776
  s_cmp_lt_u32 s47, 16
  s_cselect_b32 s6, s6, s7
  s_cselect_b64 vcc, -1, 0
  s_add_u32 s46, s46, s6
  s_cmp_lt_u32 s47, 16
  v_cndmask_b32 v11, v13, v14, vcc
  v_cndmask_b32 v152, v151, v150, s[54:55]
  v_add_u32 v11, v11, v152
  s_mov_b32 s6, 0
  s_cselect_b32 s6, 0, s6
  s_add_u32 s6, s6, s46
  s_cmp_lt_u32 s47, 16
  buffer_load_ushort v116, v11, s[12:15], s6 offen
  buffer_load_ushort v32, v11, s[24:27], s6 offen
  s_mov_b32 s6, 1152
  s_cselect_b32 s6, 1152, s6
  s_add_u32 s6, s6, s46
  s_cmp_lt_u32 s47, 16
  buffer_load_ushort v117, v11, s[12:15], s6 offen
  buffer_load_ushort v33, v11, s[24:27], s6 offen
  s_mov_b32 s6, 20736
  s_cselect_b32 s6, 2304, s6
  s_add_u32 s6, s6, s46
  s_cmp_lt_u32 s47, 16
  buffer_load_ushort v118, v11, s[12:15], s6 offen
  buffer_load_ushort v34, v11, s[24:27], s6 offen
  s_mov_b32 s6, 21888
  s_cselect_b32 s6, 3456, s6
  s_add_u32 s6, s6, s46
  s_cmp_lt_u32 s47, 16
  buffer_load_ushort v119, v11, s[12:15], s6 offen
  buffer_load_ushort v35, v11, s[24:27], s6 offen
  s_mov_b32 s6, 41472
  s_cselect_b32 s6, 9216, s6
  s_add_u32 s6, s6, s46
  s_cmp_lt_u32 s47, 16
  buffer_load_ushort v120, v11, s[12:15], s6 offen
  buffer_load_ushort v36, v11, s[24:27], s6 offen
  s_mov_b32 s6, 42624
  s_cselect_b32 s6, 10368, s6
  s_add_u32 s6, s6, s46
  s_cmp_lt_u32 s47, 16
  buffer_load_ushort v121, v11, s[12:15], s6 offen
  buffer_load_ushort v37, v11, s[24:27], s6 offen
  s_mov_b32 s6, 62208
  s_cselect_b32 s6, 11520, s6
  s_add_u32 s6, s6, s46
  s_cmp_lt_u32 s47, 16
  buffer_load_ushort v122, v11, s[12:15], s6 offen
  buffer_load_ushort v38, v11, s[24:27], s6 offen
  s_mov_b32 s6, 63360
  s_cselect_b32 s6, 12672, s6
  s_add_u32 s6, s6, s46
  s_cmp_lt_u32 s47, 16
  buffer_load_ushort v123, v11, s[12:15], s6 offen
  buffer_load_ushort v39, v11, s[24:27], s6 offen
  s_waitcnt vmcnt(32)
  v_lshl_or_b32 v124, v101, 16, v100
  v_lshl_or_b32 v125, v103, 16, v102
  v_lshl_or_b32 v126, v105, 16, v104
  v_lshl_or_b32 v127, v107, 16, v106
  s_lshl_b32 s6, s48, 10
  s_add_u32 s6, s6, 24117248
  buffer_store_dwordx4 v[124:127], v15, s[16:19], s6 offen sc1
  v_lshl_or_b32 v40, v17, 16, v16
  v_lshl_or_b32 v41, v19, 16, v18
  v_lshl_or_b32 v42, v21, 16, v20
  v_lshl_or_b32 v43, v23, 16, v22
  s_lshl_b32 s6, s48, 10
  s_add_u32 s6, s6, 26214400
  buffer_store_dwordx4 v[40:43], v15, s[16:19], s6 offen sc1
  s_waitcnt vmcnt(18)
  v_lshl_or_b32 v128, v109, 16, v108
  v_lshl_or_b32 v129, v111, 16, v110
  v_lshl_or_b32 v130, v113, 16, v112
  v_lshl_or_b32 v131, v115, 16, v114
  s_lshl_b32 s6, s49, 10
  s_add_u32 s6, s6, 24117248
  buffer_store_dwordx4 v[128:131], v15, s[16:19], s6 offen sc1
  v_lshl_or_b32 v44, v25, 16, v24
  v_lshl_or_b32 v45, v27, 16, v26
  v_lshl_or_b32 v46, v29, 16, v28
  v_lshl_or_b32 v47, v31, 16, v30
  s_lshl_b32 s6, s49, 10
  s_add_u32 s6, s6, 26214400
  buffer_store_dwordx4 v[44:47], v15, s[16:19], s6 offen sc1
  s_waitcnt vmcnt(4)
  v_lshl_or_b32 v132, v117, 16, v116
  v_lshl_or_b32 v133, v119, 16, v118
  v_lshl_or_b32 v134, v121, 16, v120
  v_lshl_or_b32 v135, v123, 16, v122
  s_lshl_b32 s6, s50, 10
  s_add_u32 s6, s6, 24117248
  buffer_store_dwordx4 v[132:135], v15, s[16:19], s6 offen sc1
  v_lshl_or_b32 v48, v33, 16, v32
  v_lshl_or_b32 v49, v35, 16, v34
  v_lshl_or_b32 v50, v37, 16, v36
  v_lshl_or_b32 v51, v39, 16, v38
  s_lshl_b32 s6, s50, 10
  s_add_u32 s6, s6, 26214400
  buffer_store_dwordx4 v[48:51], v15, s[16:19], s6 offen sc1
  v_mov_b32 v140, -1
  v_mov_b32 v141, -1
  v_mov_b32 v142, -1
  v_mov_b32 v143, -1
  s_mul_i32 s6, s44, 9216
  s_add_u32 s6, s6, 16777216
  buffer_store_dwordx4 v[140:143], v15, s[16:19], s6 offen offset:0 sc1
  buffer_store_dwordx4 v[140:143], v15, s[16:19], s6 offen offset:1024 sc1
  buffer_store_dwordx4 v[140:143], v15, s[16:19], s6 offen offset:2048 sc1
  buffer_store_dwordx4 v[140:143], v15, s[16:19], s6 offen offset:3072 sc1
  s_add_u32 s6, s6, 4096
  buffer_store_dwordx4 v[140:143], v15, s[16:19], s6 offen offset:0 sc1
  buffer_store_dwordx4 v[140:143], v15, s[16:19], s6 offen offset:1024 sc1
  buffer_store_dwordx4 v[140:143], v15, s[16:19], s6 offen offset:2048 sc1
  buffer_store_dwordx4 v[140:143], v15, s[16:19], s6 offen offset:3072 sc1
  s_add_u32 s6, s6, 4096
  buffer_store_dwordx4 v[140:143], v15, s[16:19], s6 offen offset:0 sc1
k1_qkv_kernel_end:
  s_endpgm
.section .rodata,"a"
.p2align 6
.amdhsa_kernel k1_qkv_kernel
  .amdhsa_next_free_vgpr 192
  .amdhsa_next_free_sgpr 102
  .amdhsa_accum_offset 192
  .amdhsa_group_segment_fixed_size 0
  .amdhsa_kernarg_size 80
  .amdhsa_user_sgpr_count 2
  .amdhsa_user_sgpr_kernarg_segment_ptr 1
  .amdhsa_system_sgpr_workgroup_id_x 1
  .amdhsa_float_denorm_mode_32 3
.end_amdhsa_kernel
.text
.globl k2_attn_kernel
.p2align 8
.type k2_attn_kernel,@function
k2_attn_kernel:
  s_cmp_ge_u32 s2, 256
  s_cbranch_scc1 k2_attn_kernel_end
  s_load_dwordx2 s[20:21], s[0:1], 72
  s_load_dwordx2 s[76:77], s[0:1], 56
  v_and_b32 v1, 63, v0
  v_lshrrev_b32 v5, 6, v0
  s_and_b32 s3, s2, 7
  v_readfirstlane_b32 s5, v5
  s_nop 3
  s_mov_b32 s70, s5
  s_mov_b32 s71, 0x07060302
  s_lshl_b32 s3, s3, 2
  s_lshr_b32 s4, s2, 3
  s_and_b32 s6, s4, 3
  s_add_u32 s3, s3, s6
  s_lshr_b32 s4, s2, 5
  s_lshl_b32 s7, s4, 3
  s_add_u32 s7, s7, s5
  v_lshlrev_b32 v2, 4, v1
  v_mov_b32 v100, v2
  v_and_b32 v5, 31, v1
  v_lshlrev_b32 v3, 2, v5
  v_add_u32 v3, 2240, v3
  v_lshrrev_b32 v6, 5, v1
  v_lshrrev_b32 v7, 2, v5
  v_add_u32 v6, v6, v7
  v_and_b32 v6, 3, v6
  v_lshlrev_b32 v6, 4, v6
  v_lshl_add_u32 v4, v5, 6, v6
  v_add_u32 v4, 1024, v4
  v_mov_b32 v205, v4
  v_cmp_lt_u32 vcc, 18, v5
  v_mov_b32 v7, 0x40000
  v_cndmask_b32 v4, v4, v7, vcc
  v_lshlrev_b32 v6, 2, v1
  s_mul_i32 s6, s3, 151552
  s_lshl_b32 s30, s3, 6
  s_add_u32 s30, s30, s7
  s_mul_i32 s30, s30, 1152
  s_mul_i32 s31, s7, 2368
  s_cmp_eq_u32 s7, 0
  s_cselect_b32 s34, 0, -1
  s_sub_u32 s35, s31, 2368
  s_cselect_b32 s35, s35, s35
  s_cmp_eq_u32 s7, 0
  s_cselect_b32 s35, s31, s35
  s_waitcnt lgkmcnt(0)
  s_add_u32 s8, s20, s6
  s_addc_u32 s9, s21, 0
  s_and_b32 s9, s9, 0xffff
  s_mov_b32 s10, 151552
  s_mov_b32 s11, 0x20000
  s_add_u32 s12, s20, s30
  s_addc_u32 s13, s21, 0
  s_add_u32 s12, s12, 5242880
  s_addc_u32 s13, s13, 0
  s_and_b32 s13, s13, 0xffff
  s_mov_b32 s14, 1152
  s_mov_b32 s15, 0x20000
  buffer_load_dwordx4 v[8:11], v2, s[12:15], 0 offen
  buffer_load_dword v12, v6, s[12:15], 0 offen offset:1024
  s_lshl_b32 s22, s5, 10
  s_mov_b32 m0, s22
  s_nop 0
  buffer_load_dwordx4 v100, s[8:11], s22 offen lds
  s_add_u32 s22, s22, 8192
  s_mov_b32 m0, s22
  s_nop 0
  buffer_load_dwordx4 v100, s[8:11], s22 offen lds
  s_add_u32 s22, s22, 8192
  s_mov_b32 m0, s22
  s_nop 0
  buffer_load_dwordx4 v100, s[8:11], s22 offen lds
  s_add_u32 s22, s22, 8192
  s_add_u32 s24, s20, 8388608
  s_addc_u32 s25, s21, 0
  s_and_b32 s25, s25, 0xffff
  s_mov_b32 s26, 8388608
  s_mov_b32 s27, 0x20000
  s_mov_b32 s36, s20
  s_and_b32 s37, s21, 0xffff
  s_mov_b32 s38, 0x2000000
  s_mov_b32 s39, 0x20000
  s_mov_b32 s16, s76
  s_and_b32 s17, s77, 0xffff
  s_mov_b32 s18, 2359296
  s_mov_b32 s19, 0x20000
  v_mov_b32 v102, v6
  v_xor_b32 v6, 32, v4
  v_mov_b32 v103, v3
  s_and_b32 s98, s5, 3
  s_lshl_b32 s29, s4, 3
  s_add_u32 s29, s29, s98
  s_add_u32 s28, s29, 4
  v_bfe_u32 v5, v1, 4, 1
  v_lshlrev_b32 v5, 14, v5
  v_lshrrev_b32 v7, 5, v1
  v_lshl_add_u32 v5, v7, 8, v5
  v_and_b32 v7, 15, v1
  v_lshl_add_u32 v206, v7, 4, v5
  s_cmp_ge_u32 s5, 4
  s_cbranch_scc1 k2_attn_kernel_nobias
  v_mov_b32 v101, 0xf149f2ca
  v_mov_b32 v7, 0
  s_mov_b32 s32, 21845
  s_mov_b32 s33, 349520
  v_cndmask_b32 v180, v101, v7, s[32:33]
  s_mov_b32 s32, 43690
  s_mov_b32 s33, 699040
  v_cndmask_b32 v181, v101, v7, s[32:33]
  s_mov_b32 s32, 87380
  s_mov_b32 s33, 1398080
  v_cndmask_b32 v182, v101, v7, s[32:33]
  s_mov_b32 s32, 174760
  s_mov_b32 s33, 2796160
  v_cndmask_b32 v183, v101, v7, s[32:33]
  s_mov_b32 s32, 5592320
  s_mov_b32 s33, 89477120
  v_cndmask_b32 v184, v101, v7, s[32:33]
  s_mov_b32 s32, 11184640
  s_mov_b32 s33, 178954240
  v_cndmask_b32 v185, v101, v7, s[32:33]
  s_mov_b32 s32, 22369280
  s_mov_b32 s33, 357908480
  v_cndmask_b32 v186, v101, v7, s[32:33]
  s_mov_b32 s32, 44738560
  s_mov_b32 s33, 715816960
  v_cndmask_b32 v187, v101, v7, s[32:33]
  s_mov_b32 s32, 1431633920
  s_mov_b32 s33, 1431306240
  v_cndmask_b32 v188, v101, v7, s[32:33]
  s_mov_b32 s32, 2863267840
  s_mov_b32 s33, 2862612480
  v_cndmask_b32 v189, v101, v7, s[32:33]
  s_mov_b32 s32, 1431568384
  s_mov_b32 s33, 1430257664
  v_cndmask_b32 v190, v101, v7, s[32:33]
  s_mov_b32 s32, 2863136768
  s_mov_b32 s33, 2860515328
  v_cndmask_b32 v191, v101, v7, s[32:33]
  s_mov_b32 s32, 1426063360
  s_mov_b32 s33, 1342177280
  v_cndmask_b32 v192, v101, v7, s[32:33]
  s_mov_b32 s32, 2852126720
  s_mov_b32 s33, 2684354560
  v_cndmask_b32 v193, v101, v7, s[32:33]
  s_mov_b32 s32, 1409286144
  s_mov_b32 s33, 1073741824
  v_cndmask_b32 v194, v101, v7, s[32:33]
  s_mov_b32 s32, 2818572288
  s_mov_b32 s33, 2147483648
  v_cndmask_b32 v195, v101, v7, s[32:33]
  s_mov_b32 s32, 0
  s_mov_b32 s33, 5
  v_cndmask_b32 v196, v101, v7, s[32:33]
  s_mov_b32 s32, 0
  s_mov_b32 s33, 10
  v_cndmask_b32 v197, v101, v7, s[32:33]
  s_mov_b32 s32, 1
  s_mov_b32 s33, 21
  v_cndmask_b32 v198, v101, v7, s[32:33]
  s_mov_b32 s32, 2
  s_mov_b32 s33, 42
  v_cndmask_b32 v199, v101, v7, s[32:33]
  s_mov_b32 s32, 85
  s_mov_b32 s33, 1365
  v_cndmask_b32 v200, v101, v7, s[32:33]
  s_mov_b32 s32, 170
  s_mov_b32 s33, 2730
  v_cndmask_b32 v201, v101, v7, s[32:33]
  s_mov_b32 s32, 341
  s_mov_b32 s33, 5461
  v_cndmask_b32 v202, v101, v7, s[32:33]
  s_mov_b32 s32, 682
  s_mov_b32 s33, 10922
  v_cndmask_b32 v203, v101, v7, s[32:33]
  v_mov_b32 v88, 163832
  v_mov_b32 v90, 0
  v_mov_b32 v91, 0
  ds_write_b64 v88, v[90:91]
k2_attn_kernel_nobias:
  v_mov_b32 v21, 0x3f803f80
  v_mov_b32 v109, 0x3f803f80
  v_mov_b32 v13, 0
  v_mov_b32 v40, 0
  v_mov_b32 v41, 0
  v_mov_b32 v42, 0
  v_mov_b32 v43, 0
  v_mov_b32 v44, 0
  v_mov_b32 v45, 0
  v_mov_b32 v46, 0
  v_mov_b32 v47, 0
  v_mov_b32 v48, 0
  v_mov_b32 v49, 0
  v_mov_b32 v50, 0
  v_mov_b32 v51, 0
  v_mov_b32 v52, 0
  v_mov_b32 v53, 0
  v_mov_b32 v54, 0
  v_mov_b32 v55, 0
  v_mov_b32 v28, 0
  v_mov_b32 v29, 0
  v_mov_b32 v30, 0
  v_mov_b32 v31, 0
  v_mov_b32 v36, 0
  v_mov_b32 v37, 0
  v_mov_b32 v38, 0
  v_mov_b32 v39, 0
  s_waitcnt vmcnt(2)
  s_barrier
  ds_read_b128 v[16:19], v2
  ds_read_b32 v20, v3
  v_mov_b32 v14, v12
  v_mov_b32 v15, 0
  s_waitcnt lgkmcnt(0)
  v_mfma_f32_32x32x16_bf16 v[56:71], v[16:19], v[8:11], 0
  ds_read_b128 v[16:19], v2 offset:2368
  s_nop 9
  v_mfma_f32_32x32x8_bf16 v[56:71], v[20:21], v[12:13], v[56:71]
  ds_read_b32 v20, v3 offset:2368
  ds_read_b128 v[24:27], v4
  s_nop 9
  v_max3_f32 v88, v56, v57, v58
  v_max_f32 v88, v88, v59
  v_max3_f32 v88, v88, v60, v61
  v_max3_f32 v88, v88, v62, v63
  v_max3_f32 v88, v88, v64, v65
  v_max3_f32 v88, v88, v66, v67
  v_max3_f32 v88, v88, v68, v69
  v_max3_f32 v88, v88, v70, v71
  v_mov_b32 v89, v88
  s_nop 1
  v_permlane32_swap_b32 v88, v89
  s_nop 1
  v_max_f32 v88, v88, v89
  v_sub_f32 v90, 0, v88
  v_and_b32 v91, 0xffff0000, v90
  v_sub_f32 v90, v90, v91
  v_and_b32 v92, 0xffff0000, v90
  v_sub_f32 v90, v90, v92
  v_lshrrev_b32 v91, 16, v91
  v_or_b32 v91, v91, v92
  v_lshrrev_b32 v90, 16, v90
  v_cmp_gt_u32 vcc, 32, v1
  s_nop 1
  v_cndmask_b32 v13, v90, v91, vcc
  v_pk_add_f32 v[56:57], v[56:57], v[88:89] op_sel_hi:[1,0] neg_lo:[0,1] neg_hi:[0,1]
  v_pk_add_f32 v[58:59], v[58:59], v[88:89] op_sel_hi:[1,0] neg_lo:[0,1] neg_hi:[0,1]
  v_pk_add_f32 v[60:61], v[60:61], v[88:89] op_sel_hi:[1,0] neg_lo:[0,1] neg_hi:[0,1]
  v_pk_add_f32 v[62:63], v[62:63], v[88:89] op_sel_hi:[1,0] neg_lo:[0,1] neg_hi:[0,1]
  v_pk_add_f32 v[64:65], v[64:65], v[88:89] op_sel_hi:[1,0] neg_lo:[0,1] neg_hi:[0,1]
  v_pk_add_f32 v[66:67], v[66:67], v[88:89] op_sel_hi:[1,0] neg_lo:[0,1] neg_hi:[0,1]
  v_pk_add_f32 v[68:69], v[68:69], v[88:89] op_sel_hi:[1,0] neg_lo:[0,1] neg_hi:[0,1]
  v_pk_add_f32 v[70:71], v[70:71], v[88:89] op_sel_hi:[1,0] neg_lo:[0,1] neg_hi:[0,1]
  s_waitcnt lgkmcnt(0)
  s_waitcnt vmcnt(0)
  s_barrier
  s_waitcnt lgkmcnt(0)
  v_mfma_f32_32x32x16_bf16 v[72:87], v[16:19], v[8:11], 0
  ds_read_b128 v[104:107], v2 offset:4736
  ds_read_b128 v[114:117], v6 offset:0
  v_exp_f32 v56, v56
  v_exp_f32 v57, v57
  v_exp_f32 v58, v58
  v_exp_f32 v59, v59
  v_mfma_f32_32x32x16_bf16 v[40:55], v[28:31], v[36:39], v[40:55]
  ds_read_b32 v108, v3 offset:4736
  ds_read_b128 v[110:113], v4 offset:2368
  v_cvt_pk_bf16_f32 v32, v56, v57
  v_cvt_pk_bf16_f32 v33, v58, v59
  v_exp_f32 v60, v60
  v_exp_f32 v61, v61
  v_exp_f32 v62, v62
  s_cmp_ge_u32 s5, 4
  s_cbranch_scc1 k2_attn_kernel_dk1
  s_add_u32 s30, s22, 4096
  s_mov_b32 m0, s30
  s_nop 0
  buffer_load_dwordx4 v100, s[8:11], s30 offen lds
  k2_attn_kernel_dk1:
  v_exp_f32 v63, v63
  v_mfma_f32_32x32x8_bf16 v[72:87], v[20:21], v[12:13], v[72:87]
  v_cvt_pk_bf16_f32 v34, v60, v61
  v_cvt_pk_bf16_f32 v35, v62, v63
  v_exp_f32 v64, v64
  v_exp_f32 v65, v65
  v_exp_f32 v66, v66
  v_exp_f32 v67, v67
  v_mfma_f32_32x32x16_bf16 v[40:55], v[24:27], v[32:35], v[40:55]
  v_cvt_pk_bf16_f32 v36, v64, v65
  v_cvt_pk_bf16_f32 v37, v66, v67
  v_exp_f32 v68, v68
  v_exp_f32 v69, v69
  v_exp_f32 v70, v70
  s_cmp_ge_u32 s5, 4
  s_cbranch_scc1 k2_attn_kernel_dk2
  s_mov_b32 m0, s22
  s_nop 0
  buffer_load_dwordx4 v100, s[8:11], s22 offen lds
  s_add_u32 s22, s22, 8192
  k2_attn_kernel_dk2:
  v_exp_f32 v71, v71
  v_cvt_pk_bf16_f32 v38, v68, v69
  v_cvt_pk_bf16_f32 v39, v70, v71
  s_waitcnt lgkmcnt(0)
  v_mfma_f32_32x32x16_bf16 v[56:71], v[104:107], v[8:11], 0
  ds_read_b128 v[16:19], v2 offset:7104
  ds_read_b128 v[28:31], v6 offset:2368
  v_exp_f32 v72, v72
  v_exp_f32 v73, v73
  v_exp_f32 v74, v74
  v_exp_f32 v75, v75
  v_mfma_f32_32x32x16_bf16 v[40:55], v[114:117], v[36:39], v[40:55]
  ds_read_b32 v20, v3 offset:7104
  ds_read_b128 v[24:27], v4 offset:4736
  v_cvt_pk_bf16_f32 v32, v72, v73
  v_cvt_pk_bf16_f32 v33, v74, v75
  v_exp_f32 v76, v76
  v_exp_f32 v77, v77
  v_exp_f32 v78, v78
  s_cmp_ge_u32 s5, 4
  s_cbranch_scc1 k2_attn_kernel_dk3
  s_add_u32 s30, s22, 4096
  s_mov_b32 m0, s30
  s_nop 0
  buffer_load_dwordx4 v100, s[8:11], s30 offen lds
  k2_attn_kernel_dk3:
  v_exp_f32 v79, v79
  v_mfma_f32_32x32x8_bf16 v[56:71], v[108:109], v[12:13], v[56:71]
  v_cvt_pk_bf16_f32 v34, v76, v77
  v_cvt_pk_bf16_f32 v35, v78, v79
  v_exp_f32 v80, v80
  v_exp_f32 v81, v81
  v_exp_f32 v82, v82
  v_exp_f32 v83, v83
  v_mfma_f32_32x32x16_bf16 v[40:55], v[110:113], v[32:35], v[40:55]
  v_cvt_pk_bf16_f32 v36, v80, v81
  v_cvt_pk_bf16_f32 v37, v82, v83
  v_exp_f32 v84, v84
  v_exp_f32 v85, v85
  v_exp_f32 v86, v86
  s_cmp_ge_u32 s5, 4
  s_cbranch_scc1 k2_attn_kernel_dk4
  s_mov_b32 m0, s22
  s_nop 0
  buffer_load_dwordx4 v100, s[8:11], s22 offen lds
  s_add_u32 s22, s22, 8192
  k2_attn_kernel_dk4:
  v_exp_f32 v87, v87
  v_cvt_pk_bf16_f32 v38, v84, v85
  v_cvt_pk_bf16_f32 v39, v86, v87
  s_waitcnt lgkmcnt(0)
  v_mfma_f32_32x32x16_bf16 v[72:87], v[16:19], v[8:11], 0
  ds_read_b128 v[104:107], v2 offset:9472
  ds_read_b128 v[114:117], v6 offset:4736
  v_exp_f32 v56, v56
  v_exp_f32 v57, v57
  v_exp_f32 v58, v58
  v_exp_f32 v59, v59
  v_mfma_f32_32x32x16_bf16 v[40:55], v[28:31], v[36:39], v[40:55]
  ds_read_b32 v108, v3 offset:9472
  ds_read_b128 v[110:113], v4 offset:7104
  v_cvt_pk_bf16_f32 v32, v56, v57
  v_cvt_pk_bf16_f32 v33, v58, v59
  v_exp_f32 v60, v60
  v_exp_f32 v61, v61
  v_exp_f32 v62, v62
  s_cmp_ge_u32 s5, 4
  s_cbranch_scc1 k2_attn_kernel_dk5
  s_add_u32 s30, s22, 4096
  s_mov_b32 m0, s30
  s_nop 0
  buffer_load_dwordx4 v100, s[8:11], s30 offen lds
  k2_attn_kernel_dk5:
  v_exp_f32 v63, v63
  v_mfma_f32_32x32x8_bf16 v[72:87], v[20:21], v[12:13], v[72:87]
  v_cvt_pk_bf16_f32 v34, v60, v61
  v_cvt_pk_bf16_f32 v35, v62, v63
  v_exp_f32 v64, v64
  v_exp_f32 v65, v65
  v_exp_f32 v66, v66
  v_exp_f32 v67, v67
  v_mfma_f32_32x32x16_bf16 v[40:55], v[24:27], v[32:35], v[40:55]
  v_cvt_pk_bf16_f32 v36, v64, v65
  v_cvt_pk_bf16_f32 v37, v66, v67
  v_exp_f32 v68, v68
  v_exp_f32 v69, v69
  v_exp_f32 v70, v70
  s_cmp_ge_u32 s5, 4
  s_cbranch_scc1 k2_attn_kernel_dk6
  s_mov_b32 m0, s22
  s_nop 0
  buffer_load_dwordx4 v100, s[8:11], s22 offen lds
  s_add_u32 s22, s22, 8192
  k2_attn_kernel_dk6:
  v_exp_f32 v71, v71
  v_cvt_pk_bf16_f32 v38, v68, v69
  v_cvt_pk_bf16_f32 v39, v70, v71
  s_waitcnt lgkmcnt(0)
  v_mfma_f32_32x32x16_bf16 v[56:71], v[104:107], v[8:11], 0
  ds_read_b128 v[16:19], v2 offset:11840
  ds_read_b128 v[28:31], v6 offset:7104
  v_exp_f32 v72, v72
  v_exp_f32 v73, v73
  v_exp_f32 v74, v74
  v_exp_f32 v75, v75
  v_mfma_f32_32x32x16_bf16 v[40:55], v[114:117], v[36:39], v[40:55]
  ds_read_b32 v20, v3 offset:11840
  ds_read_b128 v[24:27], v4 offset:9472
  v_cvt_pk_bf16_f32 v32, v72, v73
  v_cvt_pk_bf16_f32 v33, v74, v75
  v_exp_f32 v76, v76
  v_exp_f32 v77, v77
  v_exp_f32 v78, v78
  s_cmp_ge_u32 s5, 4
  s_cbranch_scc1 k2_attn_kernel_dk7
  s_add_u32 s30, s22, 4096
  s_mov_b32 m0, s30
  s_nop 0
  buffer_load_dwordx4 v100, s[8:11], s30 offen lds
  k2_attn_kernel_dk7:
  v_exp_f32 v79, v79
  v_mfma_f32_32x32x8_bf16 v[56:71], v[108:109], v[12:13], v[56:71]
  v_cvt_pk_bf16_f32 v34, v76, v77
  v_cvt_pk_bf16_f32 v35, v78, v79
  v_exp_f32 v80, v80
  v_exp_f32 v81, v81
  v_exp_f32 v82, v82
  v_exp_f32 v83, v83
  v_mfma_f32_32x32x16_bf16 v[40:55], v[110:113], v[32:35], v[40:55]
  v_cvt_pk_bf16_f32 v36, v80, v81
  v_cvt_pk_bf16_f32 v37, v82, v83
  v_exp_f32 v84, v84
  v_exp_f32 v85, v85
  v_exp_f32 v86, v86
  s_cmp_ge_u32 s5, 4
  s_cbranch_scc1 k2_attn_kernel_dk8
  s_mov_b32 m0, s22
  s_nop 0
  buffer_load_dwordx4 v100, s[8:11], s22 offen lds
  s_add_u32 s22, s22, 8192
  k2_attn_kernel_dk8:
  v_exp_f32 v87, v87
  v_cvt_pk_bf16_f32 v38, v84, v85
  v_cvt_pk_bf16_f32 v39, v86, v87
  s_waitcnt lgkmcnt(0)
  v_mfma_f32_32x32x16_bf16 v[72:87], v[16:19], v[8:11], 0
  ds_read_b128 v[104:107], v2 offset:14208
  ds_read_b128 v[114:117], v6 offset:9472
  v_exp_f32 v56, v56
  v_exp_f32 v57, v57
  v_exp_f32 v58, v58
  v_exp_f32 v59, v59
  v_mfma_f32_32x32x16_bf16 v[40:55], v[28:31], v[36:39], v[40:55]
  ds_read_b32 v108, v3 offset:14208
  ds_read_b128 v[110:113], v4 offset:11840
  v_cvt_pk_bf16_f32 v32, v56, v57
  v_cvt_pk_bf16_f32 v33, v58, v59
  v_exp_f32 v60, v60
  v_exp_f32 v61, v61
  v_exp_f32 v62, v62
  s_cmp_ge_u32 s5, 4
  s_cbranch_scc1 k2_attn_kernel_dk9
  s_add_u32 s30, s22, 4096
  s_mov_b32 m0, s30
  s_nop 0
  buffer_load_dwordx4 v100, s[8:11], s30 offen lds
  k2_attn_kernel_dk9:
  v_exp_f32 v63, v63
  v_mfma_f32_32x32x8_bf16 v[72:87], v[20:21], v[12:13], v[72:87]
  v_cvt_pk_bf16_f32 v34, v60, v61
  v_cvt_pk_bf16_f32 v35, v62, v63
  v_exp_f32 v64, v64
  v_exp_f32 v65, v65
  v_exp_f32 v66, v66
  v_exp_f32 v67, v67
  v_mfma_f32_32x32x16_bf16 v[40:55], v[24:27], v[32:35], v[40:55]
  v_cvt_pk_bf16_f32 v36, v64, v65
  v_cvt_pk_bf16_f32 v37, v66, v67
  v_exp_f32 v68, v68
  v_exp_f32 v69, v69
  v_exp_f32 v70, v70
  s_cmp_ge_u32 s5, 4
  s_cbranch_scc1 k2_attn_kernel_dk10
  s_mov_b32 m0, s22
  s_nop 0
  buffer_load_dwordx4 v100, s[8:11], s22 offen lds
  s_add_u32 s22, s22, 8192
  k2_attn_kernel_dk10:
  v_exp_f32 v71, v71
  v_cvt_pk_bf16_f32 v38, v68, v69
  v_cvt_pk_bf16_f32 v39, v70, v71
  s_waitcnt lgkmcnt(0)
  v_mfma_f32_32x32x16_bf16 v[56:71], v[104:107], v[8:11], 0
  ds_read_b128 v[16:19], v2 offset:16576
  ds_read_b128 v[28:31], v6 offset:11840
  v_exp_f32 v72, v72
  v_exp_f32 v73, v73
  v_exp_f32 v74, v74
  v_exp_f32 v75, v75
  v_mfma_f32_32x32x16_bf16 v[40:55], v[114:117], v[36:39], v[40:55]
  ds_read_b32 v20, v3 offset:16576
  ds_read_b128 v[24:27], v4 offset:14208
  v_cvt_pk_bf16_f32 v32, v72, v73
  v_cvt_pk_bf16_f32 v33, v74, v75
  v_exp_f32 v76, v76
  v_exp_f32 v77, v77
  v_exp_f32 v78, v78
  s_cmp_ge_u32 s5, 4
  s_cbranch_scc1 k2_attn_kernel_dk11
  s_add_u32 s30, s22, 4096
  s_mov_b32 m0, s30
  s_nop 0
  buffer_load_dwordx4 v100, s[8:11], s30 offen lds
  k2_attn_kernel_dk11:
  v_exp_f32 v79, v79
  v_mfma_f32_32x32x8_bf16 v[56:71], v[108:109], v[12:13], v[56:71]
  v_cvt_pk_bf16_f32 v34, v76, v77
  v_cvt_pk_bf16_f32 v35, v78, v79
  v_exp_f32 v80, v80
  v_exp_f32 v81, v81
  v_exp_f32 v82, v82
  v_exp_f32 v83, v83
  v_mfma_f32_32x32x16_bf16 v[40:55], v[110:113], v[32:35], v[40:55]
  v_cvt_pk_bf16_f32 v36, v80, v81
  v_cvt_pk_bf16_f32 v37, v82, v83
  v_exp_f32 v84, v84
  v_exp_f32 v85, v85
  v_exp_f32 v86, v86
  s_cmp_ge_u32 s5, 4
  s_cbranch_scc1 k2_attn_kernel_dk12
  s_mov_b32 m0, s22
  s_nop 0
  buffer_load_dwordx4 v100, s[8:11], s22 offen lds
  s_add_u32 s22, s22, 8192
  k2_attn_kernel_dk12:
  v_exp_f32 v87, v87
  v_cvt_pk_bf16_f32 v38, v84, v85
  v_cvt_pk_bf16_f32 v39, v86, v87
  s_waitcnt lgkmcnt(0)
  v_mfma_f32_32x32x16_bf16 v[72:87], v[16:19], v[8:11], 0
  ds_read_b128 v[104:107], v2 offset:18944
  ds_read_b128 v[114:117], v6 offset:14208
  v_exp_f32 v56, v56
  v_exp_f32 v57, v57
  v_exp_f32 v58, v58
  v_exp_f32 v59, v59
  v_mfma_f32_32x32x16_bf16 v[40:55], v[28:31], v[36:39], v[40:55]
  ds_read_b32 v108, v3 offset:18944
  ds_read_b128 v[110:113], v4 offset:16576
  v_cvt_pk_bf16_f32 v32, v56, v57
  v_cvt_pk_bf16_f32 v33, v58, v59
  v_exp_f32 v60, v60
  v_exp_f32 v61, v61
  v_exp_f32 v62, v62
  s_cmp_ge_u32 s5, 4
  s_cbranch_scc1 k2_attn_kernel_dk13
  s_add_u32 s30, s22, 4096
  s_mov_b32 m0, s30
  s_nop 0
  buffer_load_dwordx4 v100, s[8:11], s30 offen lds
  k2_attn_kernel_dk13:
  v_exp_f32 v63, v63
  v_mfma_f32_32x32x8_bf16 v[72:87], v[20:21], v[12:13], v[72:87]
  v_cvt_pk_bf16_f32 v34, v60, v61
  v_cvt_pk_bf16_f32 v35, v62, v63
  v_exp_f32 v64, v64
  v_exp_f32 v65, v65
  v_exp_f32 v66, v66
  v_exp_f32 v67, v67
  v_mfma_f32_32x32x16_bf16 v[40:55], v[24:27], v[32:35], v[40:55]
  v_cvt_pk_bf16_f32 v36, v64, v65
  v_cvt_pk_bf16_f32 v37, v66, v67
  v_exp_f32 v68, v68
  v_exp_f32 v69, v69
  v_exp_f32 v70, v70
  s_cmp_ge_u32 s5, 4
  s_cbranch_scc1 k2_attn_kernel_dk14
  s_mov_b32 m0, s22
  s_nop 0
  buffer_load_dwordx4 v100, s[8:11], s22 offen lds
  s_add_u32 s22, s22, 8192
  k2_attn_kernel_dk14:
  v_exp_f32 v71, v71
  v_cvt_pk_bf16_f32 v38, v68, v69
  v_cvt_pk_bf16_f32 v39, v70, v71
  s_waitcnt lgkmcnt(0)
  v_mfma_f32_32x32x16_bf16 v[56:71], v[104:107], v[8:11], 0
  ds_read_b128 v[16:19], v2 offset:21312
  ds_read_b128 v[28:31], v6 offset:16576
  v_exp_f32 v72, v72
  v_exp_f32 v73, v73
  v_exp_f32 v74, v74
  v_exp_f32 v75, v75
  v_mfma_f32_32x32x16_bf16 v[40:55], v[114:117], v[36:39], v[40:55]
  ds_read_b32 v20, v3 offset:21312
  ds_read_b128 v[24:27], v4 offset:18944
  v_cvt_pk_bf16_f32 v32, v72, v73
  v_cvt_pk_bf16_f32 v33, v74, v75
  v_exp_f32 v76, v76
  v_exp_f32 v77, v77
  v_exp_f32 v78, v78
  s_cmp_ge_u32 s5, 4
  s_cbranch_scc1 k2_attn_kernel_dk15
  s_add_u32 s30, s22, 4096
  s_mov_b32 m0, s30
  s_nop 0
  buffer_load_dwordx4 v100, s[8:11], s30 offen lds
  k2_attn_kernel_dk15:
  v_exp_f32 v79, v79
  v_mfma_f32_32x32x8_bf16 v[56:71], v[108:109], v[12:13], v[56:71]
  v_cvt_pk_bf16_f32 v34, v76, v77
  v_cvt_pk_bf16_f32 v35, v78, v79
  v_exp_f32 v80, v80
  v_exp_f32 v81, v81
  v_exp_f32 v82, v82
  v_exp_f32 v83, v83
  v_mfma_f32_32x32x16_bf16 v[40:55], v[110:113], v[32:35], v[40:55]
  v_cvt_pk_bf16_f32 v36, v80, v81
  v_cvt_pk_bf16_f32 v37, v82, v83
  v_exp_f32 v84, v84
  v_exp_f32 v85, v85
  v_exp_f32 v86, v86
  s_cmp_ge_u32 s5, 4
  s_cbranch_scc1 k2_attn_kernel_dk16
  s_mov_b32 m0, s22
  s_nop 0
  buffer_load_dwordx4 v100, s[8:11], s22 offen lds
  s_add_u32 s22, s22, 8192
  k2_attn_kernel_dk16:
  v_exp_f32 v87, v87
  v_cvt_pk_bf16_f32 v38, v84, v85
  v_cvt_pk_bf16_f32 v39, v86, v87
  v_add_u32 v2, 18944, v2
  v_add_u32 v3, 18944, v3
  v_add_u32 v4, 18944, v4
  v_xor_b32 v6, 32, v4
  s_waitcnt vmcnt(6)
  s_barrier
  s_cmp_ge_u32 s5, 4
  s_cbranch_scc1 k2_attn_kernel_young
  s_lshl_b32 s30, s3, 6
  s_add_u32 s30, s30, s28
  s_mul_i32 s30, s30, 1152
  s_add_u32 s80, s30, 5242880
  s_mul_i32 s6, s3, 151552
  s_mul_i32 s30, s28, 2368
  s_add_u32 s81, s30, s6
  s_sub_u32 s82, s81, 2368
  s_cmp_eq_u32 s28, 0
  s_cselect_b32 s82, s81, s82
  s_lshl_b32 s30, s3, 6
  s_add_u32 s30, s30, s29
  s_mul_i32 s30, s30, 1152
  s_add_u32 s83, s30, 5242880
  s_mul_i32 s6, s3, 151552
  s_mul_i32 s30, s29, 2368
  s_add_u32 s84, s30, s6
  s_sub_u32 s67, s84, 2368
  s_cmp_eq_u32 s29, 0
  s_cselect_b32 s67, s84, s67
  s_waitcnt lgkmcnt(0)
  v_mfma_f32_32x32x16_bf16 v[72:87], v[16:19], v[8:11], 0
  ds_read_b128 v[104:107], v2 offset:4736
  ds_read_b128 v[114:117], v6 offset:0
  v_exp_f32 v56, v56
  v_exp_f32 v57, v57
  v_exp_f32 v58, v58
  buffer_load_dwordx4 v[120:123], v100, s[24:27], s80 offen
  v_exp_f32 v59, v59
  v_mfma_f32_32x32x16_bf16 v[40:55], v[28:31], v[36:39], v[40:55]
  ds_read_b32 v108, v3 offset:4736
  ds_read_b128 v[110:113], v4 offset:2368
  v_cvt_pk_bf16_f32 v32, v56, v57
  v_cvt_pk_bf16_f32 v33, v58, v59
  v_exp_f32 v60, v60
  v_exp_f32 v61, v61
  v_exp_f32 v62, v62
  buffer_load_dword v124, v102, s[24:27], s80 offen offset:1024
  v_exp_f32 v63, v63
  v_mfma_f32_32x32x8_bf16 v[72:87], v[20:21], v[12:13], v[72:87]
  v_cvt_pk_bf16_f32 v34, v60, v61
  v_cvt_pk_bf16_f32 v35, v62, v63
  v_exp_f32 v64, v64
  v_exp_f32 v65, v65
  v_exp_f32 v66, v66
  v_exp_f32 v67, v67
  v_mfma_f32_32x32x16_bf16 v[40:55], v[24:27], v[32:35], v[40:55]
  v_cvt_pk_bf16_f32 v36, v64, v65
  v_cvt_pk_bf16_f32 v37, v66, v67
  v_exp_f32 v68, v68
  v_exp_f32 v69, v69
  v_exp_f32 v70, v70
  buffer_load_dwordx4 v[126:129], v100, s[24:27], s81 offen
  v_exp_f32 v71, v71
  v_cvt_pk_bf16_f32 v38, v68, v69
  v_cvt_pk_bf16_f32 v39, v70, v71
  s_waitcnt lgkmcnt(0)
  v_mfma_f32_32x32x16_bf16 v[56:71], v[104:107], v[8:11], 0
  ds_read_b128 v[16:19], v2 offset:7104
  ds_read_b128 v[28:31], v6 offset:2368
  v_exp_f32 v72, v72
  v_exp_f32 v73, v73
  v_exp_f32 v74, v74
  buffer_load_dword v134, v103, s[24:27], s81 offen
  v_exp_f32 v75, v75
  v_mfma_f32_32x32x16_bf16 v[40:55], v[114:117], v[36:39], v[40:55]
  ds_read_b32 v20, v3 offset:7104
  ds_read_b128 v[24:27], v4 offset:4736
  v_cvt_pk_bf16_f32 v32, v72, v73
  v_cvt_pk_bf16_f32 v33, v74, v75
  v_exp_f32 v76, v76
  v_exp_f32 v77, v77
  v_exp_f32 v78, v78
  buffer_load_dwordx4 v[130:133], v100, s[24:27], s82 offen
  v_exp_f32 v79, v79
  v_mfma_f32_32x32x8_bf16 v[56:71], v[108:109], v[12:13], v[56:71]
  v_cvt_pk_bf16_f32 v34, v76, v77
  v_cvt_pk_bf16_f32 v35, v78, v79
  v_exp_f32 v80, v80
  v_exp_f32 v81, v81
  v_exp_f32 v82, v82
  v_exp_f32 v83, v83
  v_mfma_f32_32x32x16_bf16 v[40:55], v[110:113], v[32:35], v[40:55]
  v_cvt_pk_bf16_f32 v36, v80, v81
  v_cvt_pk_bf16_f32 v37, v82, v83
  v_exp_f32 v84, v84
  v_exp_f32 v85, v85
  v_exp_f32 v86, v86
  buffer_load_dword v136, v103, s[24:27], s82 offen
  v_exp_f32 v87, v87
  v_cvt_pk_bf16_f32 v38, v84, v85
  v_cvt_pk_bf16_f32 v39, v86, v87
  s_waitcnt lgkmcnt(0)
  v_mfma_f32_32x32x16_bf16 v[72:87], v[16:19], v[8:11], 0
  ds_read_b128 v[104:107], v2 offset:9472
  ds_read_b128 v[114:117], v6 offset:4736
  v_exp_f32 v56, v56
  v_exp_f32 v57, v57
  v_exp_f32 v58, v58
  buffer_load_dwordx4 v[138:141], v205, s[24:27], s81 offen
  v_exp_f32 v59, v59
  v_mfma_f32_32x32x16_bf16 v[40:55], v[28:31], v[36:39], v[40:55]
  ds_read_b32 v108, v3 offset:9472
  ds_read_b128 v[110:113], v4 offset:7104
  v_cvt_pk_bf16_f32 v32, v56, v57
  v_cvt_pk_bf16_f32 v33, v58, v59
  v_exp_f32 v60, v60
  v_exp_f32 v61, v61
  v_exp_f32 v62, v62
  v_xor_b32 v142, 32, v205
  buffer_load_dwordx4 v[142:145], v142, s[24:27], s81 offen
  v_exp_f32 v63, v63
  v_mfma_f32_32x32x8_bf16 v[72:87], v[20:21], v[12:13], v[72:87]
  v_cvt_pk_bf16_f32 v34, v60, v61
  v_cvt_pk_bf16_f32 v35, v62, v63
  v_exp_f32 v64, v64
  v_exp_f32 v65, v65
  v_exp_f32 v66, v66
  v_exp_f32 v67, v67
  v_mfma_f32_32x32x16_bf16 v[40:55], v[24:27], v[32:35], v[40:55]
  v_cvt_pk_bf16_f32 v36, v64, v65
  v_cvt_pk_bf16_f32 v37, v66, v67
  v_exp_f32 v68, v68
  v_exp_f32 v69, v69
  v_exp_f32 v70, v70
  v_xor_b32 v146, 32, v205
  buffer_load_dwordx4 v[146:149], v146, s[24:27], s82 offen
  v_exp_f32 v71, v71
  v_cvt_pk_bf16_f32 v38, v68, v69
  v_cvt_pk_bf16_f32 v39, v70, v71
  s_waitcnt lgkmcnt(0)
  v_mfma_f32_32x32x16_bf16 v[56:71], v[104:107], v[8:11], 0
  ds_read_b128 v[16:19], v2 offset:11840
  ds_read_b128 v[28:31], v6 offset:7104
  v_exp_f32 v72, v72
  v_exp_f32 v73, v73
  v_exp_f32 v74, v74
  buffer_load_dwordx4 v[150:153], v100, s[24:27], s83 offen
  v_exp_f32 v75, v75
  v_mfma_f32_32x32x16_bf16 v[40:55], v[114:117], v[36:39], v[40:55]
  ds_read_b32 v20, v3 offset:11840
  ds_read_b128 v[24:27], v4 offset:9472
  v_cvt_pk_bf16_f32 v32, v72, v73
  v_cvt_pk_bf16_f32 v33, v74, v75
  v_exp_f32 v76, v76
  v_exp_f32 v77, v77
  v_exp_f32 v78, v78
  buffer_load_dword v154, v102, s[24:27], s83 offen offset:1024
  v_exp_f32 v79, v79
  v_mfma_f32_32x32x8_bf16 v[56:71], v[108:109], v[12:13], v[56:71]
  v_cvt_pk_bf16_f32 v34, v76, v77
  v_cvt_pk_bf16_f32 v35, v78, v79
  v_exp_f32 v80, v80
  v_exp_f32 v81, v81
  v_exp_f32 v82, v82
  v_exp_f32 v83, v83
  v_mfma_f32_32x32x16_bf16 v[40:55], v[110:113], v[32:35], v[40:55]
  v_cvt_pk_bf16_f32 v36, v80, v81
  v_cvt_pk_bf16_f32 v37, v82, v83
  v_exp_f32 v84, v84
  v_exp_f32 v85, v85
  v_exp_f32 v86, v86
  buffer_load_dwordx4 v[156:159], v100, s[24:27], s84 offen
  v_exp_f32 v87, v87
  v_cvt_pk_bf16_f32 v38, v84, v85
  v_cvt_pk_bf16_f32 v39, v86, v87
  s_waitcnt lgkmcnt(0)
  v_mfma_f32_32x32x16_bf16 v[72:87], v[16:19], v[8:11], 0
  ds_read_b128 v[104:107], v2 offset:14208
  ds_read_b128 v[114:117], v6 offset:9472
  v_exp_f32 v56, v56
  v_exp_f32 v57, v57
  v_exp_f32 v58, v58
  buffer_load_dword v164, v103, s[24:27], s84 offen
  v_exp_f32 v59, v59
  v_mfma_f32_32x32x16_bf16 v[40:55], v[28:31], v[36:39], v[40:55]
  ds_read_b32 v108, v3 offset:14208
  ds_read_b128 v[110:113], v4 offset:11840
  v_cvt_pk_bf16_f32 v32, v56, v57
  v_cvt_pk_bf16_f32 v33, v58, v59
  v_exp_f32 v60, v60
  v_exp_f32 v61, v61
  v_exp_f32 v62, v62
  buffer_load_dwordx4 v[160:163], v100, s[24:27], s67 offen
  v_exp_f32 v63, v63
  v_mfma_f32_32x32x8_bf16 v[72:87], v[20:21], v[12:13], v[72:87]
  v_cvt_pk_bf16_f32 v34, v60, v61
  v_cvt_pk_bf16_f32 v35, v62, v63
  v_exp_f32 v64, v64
  v_exp_f32 v65, v65
  v_exp_f32 v66, v66
  v_exp_f32 v67, v67
  v_mfma_f32_32x32x16_bf16 v[40:55], v[24:27], v[32:35], v[40:55]
  v_cvt_pk_bf16_f32 v36, v64, v65
  v_cvt_pk_bf16_f32 v37, v66, v67
  v_exp_f32 v68, v68
  v_exp_f32 v69, v69
  v_exp_f32 v70, v70
  buffer_load_dword v166, v103, s[24:27], s67 offen
  v_exp_f32 v71, v71
  v_cvt_pk_bf16_f32 v38, v68, v69
  v_cvt_pk_bf16_f32 v39, v70, v71
  s_waitcnt lgkmcnt(0)
  v_mfma_f32_32x32x16_bf16 v[56:71], v[104:107], v[8:11], 0
  ds_read_b128 v[16:19], v2 offset:16576
  ds_read_b128 v[28:31], v6 offset:11840
  v_exp_f32 v72, v72
  v_exp_f32 v73, v73
  v_exp_f32 v74, v74
  buffer_load_dwordx4 v[168:171], v205, s[24:27], s84 offen
  v_exp_f32 v75, v75
  v_mfma_f32_32x32x16_bf16 v[40:55], v[114:117], v[36:39], v[40:55]
  ds_read_b32 v20, v3 offset:16576
  ds_read_b128 v[24:27], v4 offset:14208
  v_cvt_pk_bf16_f32 v32, v72, v73
  v_cvt_pk_bf16_f32 v33, v74, v75
  v_exp_f32 v76, v76
  v_exp_f32 v77, v77
  v_exp_f32 v78, v78
  v_xor_b32 v172, 32, v205
  buffer_load_dwordx4 v[172:175], v172, s[24:27], s84 offen
  v_exp_f32 v79, v79
  v_mfma_f32_32x32x8_bf16 v[56:71], v[108:109], v[12:13], v[56:71]
  v_cvt_pk_bf16_f32 v34, v76, v77
  v_cvt_pk_bf16_f32 v35, v78, v79
  v_exp_f32 v80, v80
  v_exp_f32 v81, v81
  v_exp_f32 v82, v82
  v_exp_f32 v83, v83
  v_mfma_f32_32x32x16_bf16 v[40:55], v[110:113], v[32:35], v[40:55]
  v_cvt_pk_bf16_f32 v36, v80, v81
  v_cvt_pk_bf16_f32 v37, v82, v83
  v_exp_f32 v84, v84
  v_exp_f32 v85, v85
  v_exp_f32 v86, v86
  v_xor_b32 v176, 32, v205
  buffer_load_dwordx4 v[176:179], v176, s[24:27], s67 offen
  v_exp_f32 v87, v87
  v_cvt_pk_bf16_f32 v38, v84, v85
  v_cvt_pk_bf16_f32 v39, v86, v87
  s_waitcnt lgkmcnt(0)
  v_mfma_f32_32x32x16_bf16 v[72:87], v[16:19], v[8:11], 0
  ds_read_b128 v[104:107], v2 offset:18944
  ds_read_b128 v[114:117], v6 offset:14208
  v_exp_f32 v56, v56
  v_exp_f32 v57, v57
  v_exp_f32 v58, v58
  v_exp_f32 v59, v59
  v_mfma_f32_32x32x16_bf16 v[40:55], v[28:31], v[36:39], v[40:55]
  ds_read_b32 v108, v3 offset:18944
  ds_read_b128 v[110:113], v4 offset:16576
  v_cvt_pk_bf16_f32 v32, v56, v57
  v_cvt_pk_bf16_f32 v33, v58, v59
  v_exp_f32 v60, v60
  v_exp_f32 v61, v61
  v_exp_f32 v62, v62
  v_exp_f32 v63, v63
  v_mfma_f32_32x32x8_bf16 v[72:87], v[20:21], v[12:13], v[72:87]
  v_cvt_pk_bf16_f32 v34, v60, v61
  v_cvt_pk_bf16_f32 v35, v62, v63
  v_exp_f32 v64, v64
  v_exp_f32 v65, v65
  v_exp_f32 v66, v66
  v_exp_f32 v67, v67
  v_mfma_f32_32x32x16_bf16 v[40:55], v[24:27], v[32:35], v[40:55]
  v_cvt_pk_bf16_f32 v36, v64, v65
  v_cvt_pk_bf16_f32 v37, v66, v67
  v_exp_f32 v68, v68
  v_exp_f32 v69, v69
  v_exp_f32 v70, v70
  v_exp_f32 v71, v71
  v_cvt_pk_bf16_f32 v38, v68, v69
  v_cvt_pk_bf16_f32 v39, v70, v71
  s_waitcnt lgkmcnt(0)
  v_mfma_f32_32x32x16_bf16 v[56:71], v[104:107], v[8:11], 0
  ds_read_b128 v[16:19], v2 offset:21312
  ds_read_b128 v[28:31], v6 offset:16576
  v_exp_f32 v72, v72
  v_exp_f32 v73, v73
  v_exp_f32 v74, v74
  v_exp_f32 v75, v75
  v_mfma_f32_32x32x16_bf16 v[40:55], v[114:117], v[36:39], v[40:55]
  ds_read_b32 v20, v3 offset:21312
  ds_read_b128 v[24:27], v4 offset:18944
  v_cvt_pk_bf16_f32 v32, v72, v73
  v_cvt_pk_bf16_f32 v33, v74, v75
  v_exp_f32 v76, v76
  v_exp_f32 v77, v77
  v_exp_f32 v78, v78
  v_exp_f32 v79, v79
  v_mfma_f32_32x32x8_bf16 v[56:71], v[108:109], v[12:13], v[56:71]
  v_cvt_pk_bf16_f32 v34, v76, v77
  v_cvt_pk_bf16_f32 v35, v78, v79
  v_exp_f32 v80, v80
  v_exp_f32 v81, v81
  v_exp_f32 v82, v82
  v_exp_f32 v83, v83
  v_mfma_f32_32x32x16_bf16 v[40:55], v[110:113], v[32:35], v[40:55]
  v_cvt_pk_bf16_f32 v36, v80, v81
  v_cvt_pk_bf16_f32 v37, v82, v83
  v_exp_f32 v84, v84
  v_exp_f32 v85, v85
  v_exp_f32 v86, v86
  v_exp_f32 v87, v87
  v_cvt_pk_bf16_f32 v38, v84, v85
  v_cvt_pk_bf16_f32 v39, v86, v87
  v_add_u32 v2, 18944, v2
  v_add_u32 v3, 18944, v3
  v_add_u32 v4, 18944, v4
  v_xor_b32 v6, 32, v4
  s_waitcnt vmcnt(9)
  v_cmp_gt_u32 vcc, 32, v1
  v_mov_b32 v125, 0
  v_mov_b32 v135, 0
  v_mov_b32 v137, 0
  v_cndmask_b32 v124, 0, v124, vcc
  v_mfma_f32_32x32x16_bf16 v[72:87], v[126:129], v[120:123], v[180:195]
  v_mfma_f32_32x32x16_bf16 v[208:223], v[130:133], v[120:123], v[188:203]
  s_nop 9
  v_mfma_f32_32x32x8_bf16 v[72:87], v[134:135], v[124:125], v[72:87]
  v_mfma_f32_32x32x8_bf16 v[208:223], v[136:137], v[124:125], v[208:223]
  s_nop 11
  v_max3_f32 v88, v72, v73, v74
  v_max_f32 v88, v88, v75
  v_max3_f32 v88, v88, v76, v77
  v_max3_f32 v88, v88, v78, v79
  v_max3_f32 v88, v88, v80, v81
  v_max3_f32 v88, v88, v82, v83
  v_max3_f32 v88, v88, v84, v85
  v_max3_f32 v88, v88, v86, v87
  v_max3_f32 v88, v88, v216, v217
  v_max3_f32 v88, v88, v218, v219
  v_max3_f32 v88, v88, v220, v221
  v_max3_f32 v88, v88, v222, v223
  v_mov_b32 v89, v88
  s_nop 1
  v_permlane32_swap_b32 v88, v89
  s_nop 1
  v_max_f32 v88, v88, v89
  v_pk_add_f32 v[72:73], v[72:73], v[88:89] op_sel_hi:[1,0] neg_lo:[0,1] neg_hi:[0,1]
  v_pk_add_f32 v[74:75], v[74:75], v[88:89] op_sel_hi:[1,0] neg_lo:[0,1] neg_hi:[0,1]
  v_pk_add_f32 v[76:77], v[76:77], v[88:89] op_sel_hi:[1,0] neg_lo:[0,1] neg_hi:[0,1]
  v_pk_add_f32 v[78:79], v[78:79], v[88:89] op_sel_hi:[1,0] neg_lo:[0,1] neg_hi:[0,1]
  v_pk_add_f32 v[80:81], v[80:81], v[88:89] op_sel_hi:[1,0] neg_lo:[0,1] neg_hi:[0,1]
  v_pk_add_f32 v[82:83], v[82:83], v[88:89] op_sel_hi:[1,0] neg_lo:[0,1] neg_hi:[0,1]
  v_pk_add_f32 v[84:85], v[84:85], v[88:89] op_sel_hi:[1,0] neg_lo:[0,1] neg_hi:[0,1]
  v_pk_add_f32 v[86:87], v[86:87], v[88:89] op_sel_hi:[1,0] neg_lo:[0,1] neg_hi:[0,1]
  v_pk_add_f32 v[216:217], v[216:217], v[88:89] op_sel_hi:[1,0] neg_lo:[0,1] neg_hi:[0,1]
  v_pk_add_f32 v[218:219], v[218:219], v[88:89] op_sel_hi:[1,0] neg_lo:[0,1] neg_hi:[0,1]
  v_pk_add_f32 v[220:221], v[220:221], v[88:89] op_sel_hi:[1,0] neg_lo:[0,1] neg_hi:[0,1]
  v_pk_add_f32 v[222:223], v[222:223], v[88:89] op_sel_hi:[1,0] neg_lo:[0,1] neg_hi:[0,1]
  v_exp_f32 v72, v72
  v_exp_f32 v73, v73
  v_exp_f32 v74, v74
  v_exp_f32 v75, v75
  v_exp_f32 v76, v76
  v_exp_f32 v77, v77
  v_exp_f32 v78, v78
  v_exp_f32 v79, v79
  v_exp_f32 v80, v80
  v_exp_f32 v81, v81
  v_exp_f32 v82, v82
  v_exp_f32 v83, v83
  v_exp_f32 v84, v84
  v_exp_f32 v85, v85
  v_exp_f32 v86, v86
  v_exp_f32 v87, v87
  v_exp_f32 v216, v216
  v_exp_f32 v217, v217
  v_exp_f32 v218, v218
  v_exp_f32 v219, v219
  v_exp_f32 v220, v220
  v_exp_f32 v221, v221
  v_exp_f32 v222, v222
  v_exp_f32 v223, v223
  s_nop 0
  v_cvt_pk_bf16_f32 v240, v72, v73
  v_cvt_pk_bf16_f32 v241, v74, v75
  v_cvt_pk_bf16_f32 v242, v76, v77
  v_cvt_pk_bf16_f32 v243, v78, v79
  v_cvt_pk_bf16_f32 v244, v80, v81
  v_cvt_pk_bf16_f32 v245, v82, v83
  v_cvt_pk_bf16_f32 v246, v84, v85
  v_cvt_pk_bf16_f32 v247, v86, v87
  v_cvt_pk_bf16_f32 v92, v216, v217
  v_cvt_pk_bf16_f32 v93, v218, v219
  v_cvt_pk_bf16_f32 v94, v220, v221
  v_cvt_pk_bf16_f32 v95, v222, v223
  s_nop 1
  v_mfma_f32_32x32x16_bf16 v[224:239], v[138:141], v[240:243], 0
  v_mfma_f32_32x32x16_bf16 v[224:239], v[142:145], v[244:247], v[224:239]
  v_mfma_f32_32x32x16_bf16 v[224:239], v[146:149], v[92:95], v[224:239]
  s_nop 11
  s_nop 7
  v_mov_b32 v88, v234
  v_mov_b32 v89, v234
  s_nop 1
  v_permlane32_swap_b32 v88, v89
  s_nop 1
  v_rcp_f32 v88, v88
  s_nop 0
  v_pk_mul_f32 v[224:225], v[224:225], v[88:89] op_sel_hi:[1,0]
  v_pk_mul_f32 v[226:227], v[226:227], v[88:89] op_sel_hi:[1,0]
  v_pk_mul_f32 v[228:229], v[228:229], v[88:89] op_sel_hi:[1,0]
  v_pk_mul_f32 v[230:231], v[230:231], v[88:89] op_sel_hi:[1,0]
  v_pk_mul_f32 v[232:233], v[232:233], v[88:89] op_sel_hi:[1,0]
  v_cvt_pk_bf16_f32 v120, v224, v225
  v_cvt_pk_bf16_f32 v121, v226, v227
  v_cvt_pk_bf16_f32 v122, v228, v229
  v_cvt_pk_bf16_f32 v123, v230, v231
  v_cvt_pk_bf16_f32 v124, v232, v233
  s_lshl_b32 s6, s28, 15
  s_lshl_b32 s30, s3, 9
  s_add_u32 s6, s6, s30
  s_add_u32 s6, s6, 19922944
  s_lshl_b32 s31, s28, 12
  s_lshl_b32 s30, s3, 7
  s_add_u32 s31, s31, s30
  s_add_u32 s31, s31, 22017856
  buffer_store_dwordx4 v[120:123], v206, s[36:39], s6 offen sc1
  v_cmp_gt_u32 vcc, 32, v1
  s_and_saveexec_b64 s[32:33], vcc
  buffer_store_dword v124, v103, s[36:39], s31 offen sc1
  s_mov_b64 exec, s[32:33]
  s_cmp_lg_u32 s29, 0
  s_cbranch_scc1 k2_attn_kernel_hasprev
  v_mov_b32 v196, v101
  v_mov_b32 v197, v101
  v_mov_b32 v198, v101
  v_mov_b32 v199, v101
  v_mov_b32 v200, v101
  v_mov_b32 v201, v101
  v_mov_b32 v202, v101
  v_mov_b32 v203, v101
k2_attn_kernel_hasprev:
  s_waitcnt vmcnt(2)
  v_cmp_gt_u32 vcc, 32, v1
  v_mov_b32 v155, 0
  v_mov_b32 v165, 0
  v_mov_b32 v167, 0
  v_cndmask_b32 v154, 0, v154, vcc
  v_mfma_f32_32x32x16_bf16 v[72:87], v[156:159], v[150:153], v[180:195]
  v_mfma_f32_32x32x16_bf16 v[208:223], v[160:163], v[150:153], v[188:203]
  s_nop 9
  v_mfma_f32_32x32x8_bf16 v[72:87], v[164:165], v[154:155], v[72:87]
  v_mfma_f32_32x32x8_bf16 v[208:223], v[166:167], v[154:155], v[208:223]
  s_nop 11
  v_max3_f32 v88, v72, v73, v74
  v_max_f32 v88, v88, v75
  v_max3_f32 v88, v88, v76, v77
  v_max3_f32 v88, v88, v78, v79
  v_max3_f32 v88, v88, v80, v81
  v_max3_f32 v88, v88, v82, v83
  v_max3_f32 v88, v88, v84, v85
  v_max3_f32 v88, v88, v86, v87
  v_max3_f32 v88, v88, v216, v217
  v_max3_f32 v88, v88, v218, v219
  v_max3_f32 v88, v88, v220, v221
  v_max3_f32 v88, v88, v222, v223
  v_mov_b32 v89, v88
  s_nop 1
  v_permlane32_swap_b32 v88, v89
  s_nop 1
  v_max_f32 v88, v88, v89
  v_pk_add_f32 v[72:73], v[72:73], v[88:89] op_sel_hi:[1,0] neg_lo:[0,1] neg_hi:[0,1]
  v_pk_add_f32 v[74:75], v[74:75], v[88:89] op_sel_hi:[1,0] neg_lo:[0,1] neg_hi:[0,1]
  v_pk_add_f32 v[76:77], v[76:77], v[88:89] op_sel_hi:[1,0] neg_lo:[0,1] neg_hi:[0,1]
  v_pk_add_f32 v[78:79], v[78:79], v[88:89] op_sel_hi:[1,0] neg_lo:[0,1] neg_hi:[0,1]
  v_pk_add_f32 v[80:81], v[80:81], v[88:89] op_sel_hi:[1,0] neg_lo:[0,1] neg_hi:[0,1]
  v_pk_add_f32 v[82:83], v[82:83], v[88:89] op_sel_hi:[1,0] neg_lo:[0,1] neg_hi:[0,1]
  v_pk_add_f32 v[84:85], v[84:85], v[88:89] op_sel_hi:[1,0] neg_lo:[0,1] neg_hi:[0,1]
  v_pk_add_f32 v[86:87], v[86:87], v[88:89] op_sel_hi:[1,0] neg_lo:[0,1] neg_hi:[0,1]
  v_pk_add_f32 v[216:217], v[216:217], v[88:89] op_sel_hi:[1,0] neg_lo:[0,1] neg_hi:[0,1]
  v_pk_add_f32 v[218:219], v[218:219], v[88:89] op_sel_hi:[1,0] neg_lo:[0,1] neg_hi:[0,1]
  v_pk_add_f32 v[220:221], v[220:221], v[88:89] op_sel_hi:[1,0] neg_lo:[0,1] neg_hi:[0,1]
  v_pk_add_f32 v[222:223], v[222:223], v[88:89] op_sel_hi:[1,0] neg_lo:[0,1] neg_hi:[0,1]
  v_exp_f32 v72, v72
  v_exp_f32 v73, v73
  v_exp_f32 v74, v74
  v_exp_f32 v75, v75
  v_exp_f32 v76, v76
  v_exp_f32 v77, v77
  v_exp_f32 v78, v78
  v_exp_f32 v79, v79
  v_exp_f32 v80, v80
  v_exp_f32 v81, v81
  v_exp_f32 v82, v82
  v_exp_f32 v83, v83
  v_exp_f32 v84, v84
  v_exp_f32 v85, v85
  v_exp_f32 v86, v86
  v_exp_f32 v87, v87
  v_exp_f32 v216, v216
  v_exp_f32 v217, v217
  v_exp_f32 v218, v218
  v_exp_f32 v219, v219
  v_exp_f32 v220, v220
  v_exp_f32 v221, v221
  v_exp_f32 v222, v222
  v_exp_f32 v223, v223
  s_nop 0
  v_cvt_pk_bf16_f32 v240, v72, v73
  v_cvt_pk_bf16_f32 v241, v74, v75
  v_cvt_pk_bf16_f32 v242, v76, v77
  v_cvt_pk_bf16_f32 v243, v78, v79
  v_cvt_pk_bf16_f32 v244, v80, v81
  v_cvt_pk_bf16_f32 v245, v82, v83
  v_cvt_pk_bf16_f32 v246, v84, v85
  v_cvt_pk_bf16_f32 v247, v86, v87
  v_cvt_pk_bf16_f32 v92, v216, v217
  v_cvt_pk_bf16_f32 v93, v218, v219
  v_cvt_pk_bf16_f32 v94, v220, v221
  v_cvt_pk_bf16_f32 v95, v222, v223
  s_nop 1
  v_mfma_f32_32x32x16_bf16 v[224:239], v[168:171], v[240:243], 0
  v_mfma_f32_32x32x16_bf16 v[224:239], v[172:175], v[244:247], v[224:239]
  v_mfma_f32_32x32x16_bf16 v[224:239], v[176:179], v[92:95], v[224:239]
  s_nop 11
  s_nop 7
  v_mov_b32 v88, v234
  v_mov_b32 v89, v234
  s_nop 1
  v_permlane32_swap_b32 v88, v89
  s_nop 1
  v_rcp_f32 v88, v88
  s_nop 0
  v_pk_mul_f32 v[224:225], v[224:225], v[88:89] op_sel_hi:[1,0]
  v_pk_mul_f32 v[226:227], v[226:227], v[88:89] op_sel_hi:[1,0]
  v_pk_mul_f32 v[228:229], v[228:229], v[88:89] op_sel_hi:[1,0]
  v_pk_mul_f32 v[230:231], v[230:231], v[88:89] op_sel_hi:[1,0]
  v_pk_mul_f32 v[232:233], v[232:233], v[88:89] op_sel_hi:[1,0]
  v_cvt_pk_bf16_f32 v150, v224, v225
  v_cvt_pk_bf16_f32 v151, v226, v227
  v_cvt_pk_bf16_f32 v152, v228, v229
  v_cvt_pk_bf16_f32 v153, v230, v231
  v_cvt_pk_bf16_f32 v154, v232, v233
  s_lshl_b32 s6, s29, 15
  s_lshl_b32 s30, s3, 9
  s_add_u32 s6, s6, s30
  s_add_u32 s6, s6, 19922944
  s_lshl_b32 s31, s29, 12
  s_lshl_b32 s30, s3, 7
  s_add_u32 s31, s31, s30
  s_add_u32 s31, s31, 22017856
  buffer_store_dwordx4 v[150:153], v206, s[36:39], s6 offen sc1
  v_cmp_gt_u32 vcc, 32, v1
  s_and_saveexec_b64 s[32:33], vcc
  buffer_store_dword v154, v103, s[36:39], s31 offen sc1
  s_mov_b64 exec, s[32:33]
  s_mov_b32 s66, 1
  s_mov_b32 s23, 0
  s_mov_b32 s65, 99
  s_branch k2_attn_kernel_loop
k2_attn_kernel_young:
  s_add_u32 s22, s22, 65536
  s_waitcnt lgkmcnt(0)
  v_mfma_f32_32x32x16_bf16 v[72:87], v[16:19], v[8:11], 0
  ds_read_b128 v[104:107], v2 offset:4736
  ds_read_b128 v[114:117], v6 offset:0
  v_exp_f32 v56, v56
  v_exp_f32 v57, v57
  v_exp_f32 v58, v58
  v_exp_f32 v59, v59
  v_mfma_f32_32x32x16_bf16 v[40:55], v[28:31], v[36:39], v[40:55]
  ds_read_b32 v108, v3 offset:4736
  ds_read_b128 v[110:113], v4 offset:2368
  v_cvt_pk_bf16_f32 v32, v56, v57
  v_cvt_pk_bf16_f32 v33, v58, v59
  v_exp_f32 v60, v60
  v_exp_f32 v61, v61
  v_exp_f32 v62, v62
  s_sub_u32 s30, s22, 4096
  s_mov_b32 m0, s30
  s_nop 0
  buffer_load_dwordx4 v100, s[8:11], s30 offen lds
  v_exp_f32 v63, v63
  v_mfma_f32_32x32x8_bf16 v[72:87], v[20:21], v[12:13], v[72:87]
  v_cvt_pk_bf16_f32 v34, v60, v61
  v_cvt_pk_bf16_f32 v35, v62, v63
  v_exp_f32 v64, v64
  v_exp_f32 v65, v65
  v_exp_f32 v66, v66
  v_exp_f32 v67, v67
  v_mfma_f32_32x32x16_bf16 v[40:55], v[24:27], v[32:35], v[40:55]
  v_cvt_pk_bf16_f32 v36, v64, v65
  v_cvt_pk_bf16_f32 v37, v66, v67
  v_exp_f32 v68, v68
  v_exp_f32 v69, v69
  v_exp_f32 v70, v70
  s_mov_b32 m0, s22
  s_nop 0
  buffer_load_dwordx4 v100, s[8:11], s22 offen lds
  s_add_u32 s22, s22, 8192
  v_exp_f32 v71, v71
  v_cvt_pk_bf16_f32 v38, v68, v69
  v_cvt_pk_bf16_f32 v39, v70, v71
  s_waitcnt lgkmcnt(0)
  v_mfma_f32_32x32x16_bf16 v[56:71], v[104:107], v[8:11], 0
  ds_read_b128 v[16:19], v2 offset:7104
  ds_read_b128 v[28:31], v6 offset:2368
  v_exp_f32 v72, v72
  v_exp_f32 v73, v73
  v_exp_f32 v74, v74
  v_exp_f32 v75, v75
  v_mfma_f32_32x32x16_bf16 v[40:55], v[114:117], v[36:39], v[40:55]
  ds_read_b32 v20, v3 offset:7104
  ds_read_b128 v[24:27], v4 offset:4736
  v_cvt_pk_bf16_f32 v32, v72, v73
  v_cvt_pk_bf16_f32 v33, v74, v75
  v_exp_f32 v76, v76
  v_exp_f32 v77, v77
  v_exp_f32 v78, v78
  s_sub_u32 s30, s22, 4096
  s_mov_b32 m0, s30
  s_nop 0
  buffer_load_dwordx4 v100, s[8:11], s30 offen lds
  v_exp_f32 v79, v79
  v_mfma_f32_32x32x8_bf16 v[56:71], v[108:109], v[12:13], v[56:71]
  v_cvt_pk_bf16_f32 v34, v76, v77
  v_cvt_pk_bf16_f32 v35, v78, v79
  v_exp_f32 v80, v80
  v_exp_f32 v81, v81
  v_exp_f32 v82, v82
  v_exp_f32 v83, v83
  v_mfma_f32_32x32x16_bf16 v[40:55], v[110:113], v[32:35], v[40:55]
  v_cvt_pk_bf16_f32 v36, v80, v81
  v_cvt_pk_bf16_f32 v37, v82, v83
  v_exp_f32 v84, v84
  v_exp_f32 v85, v85
  v_exp_f32 v86, v86
  s_mov_b32 m0, s22
  s_nop 0
  buffer_load_dwordx4 v100, s[8:11], s22 offen lds
  s_add_u32 s22, s22, 8192
  v_exp_f32 v87, v87
  v_cvt_pk_bf16_f32 v38, v84, v85
  v_cvt_pk_bf16_f32 v39, v86, v87
  s_waitcnt lgkmcnt(0)
  v_mfma_f32_32x32x16_bf16 v[72:87], v[16:19], v[8:11], 0
  ds_read_b128 v[104:107], v2 offset:9472
  ds_read_b128 v[114:117], v6 offset:4736
  v_exp_f32 v56, v56
  v_exp_f32 v57, v57
  v_exp_f32 v58, v58
  v_exp_f32 v59, v59
  v_mfma_f32_32x32x16_bf16 v[40:55], v[28:31], v[36:39], v[40:55]
  ds_read_b32 v108, v3 offset:9472
  ds_read_b128 v[110:113], v4 offset:7104
  v_cvt_pk_bf16_f32 v32, v56, v57
  v_cvt_pk_bf16_f32 v33, v58, v59
  v_exp_f32 v60, v60
  v_exp_f32 v61, v61
  v_exp_f32 v62, v62
  s_sub_u32 s30, s22, 4096
  s_mov_b32 m0, s30
  s_nop 0
  buffer_load_dwordx4 v100, s[8:11], s30 offen lds
  v_exp_f32 v63, v63
  v_mfma_f32_32x32x8_bf16 v[72:87], v[20:21], v[12:13], v[72:87]
  v_cvt_pk_bf16_f32 v34, v60, v61
  v_cvt_pk_bf16_f32 v35, v62, v63
  v_exp_f32 v64, v64
  v_exp_f32 v65, v65
  v_exp_f32 v66, v66
  v_exp_f32 v67, v67
  v_mfma_f32_32x32x16_bf16 v[40:55], v[24:27], v[32:35], v[40:55]
  v_cvt_pk_bf16_f32 v36, v64, v65
  v_cvt_pk_bf16_f32 v37, v66, v67
  v_exp_f32 v68, v68
  v_exp_f32 v69, v69
  v_exp_f32 v70, v70
  s_mov_b32 m0, s22
  s_nop 0
  buffer_load_dwordx4 v100, s[8:11], s22 offen lds
  s_add_u32 s22, s22, 8192
  v_exp_f32 v71, v71
  v_cvt_pk_bf16_f32 v38, v68, v69
  v_cvt_pk_bf16_f32 v39, v70, v71
  s_waitcnt lgkmcnt(0)
  v_mfma_f32_32x32x16_bf16 v[56:71], v[104:107], v[8:11], 0
  ds_read_b128 v[16:19], v2 offset:11840
  ds_read_b128 v[28:31], v6 offset:7104
  v_exp_f32 v72, v72
  v_exp_f32 v73, v73
  v_exp_f32 v74, v74
  v_exp_f32 v75, v75
  v_mfma_f32_32x32x16_bf16 v[40:55], v[114:117], v[36:39], v[40:55]
  ds_read_b32 v20, v3 offset:11840
  ds_read_b128 v[24:27], v4 offset:9472
  v_cvt_pk_bf16_f32 v32, v72, v73
  v_cvt_pk_bf16_f32 v33, v74, v75
  v_exp_f32 v76, v76
  v_exp_f32 v77, v77
  v_exp_f32 v78, v78
  s_sub_u32 s30, s22, 4096
  s_mov_b32 m0, s30
  s_nop 0
  buffer_load_dwordx4 v100, s[8:11], s30 offen lds
  v_exp_f32 v79, v79
  v_mfma_f32_32x32x8_bf16 v[56:71], v[108:109], v[12:13], v[56:71]
  v_cvt_pk_bf16_f32 v34, v76, v77
  v_cvt_pk_bf16_f32 v35, v78, v79
  v_exp_f32 v80, v80
  v_exp_f32 v81, v81
  v_exp_f32 v82, v82
  v_exp_f32 v83, v83
  v_mfma_f32_32x32x16_bf16 v[40:55], v[110:113], v[32:35], v[40:55]
  v_cvt_pk_bf16_f32 v36, v80, v81
  v_cvt_pk_bf16_f32 v37, v82, v83
  v_exp_f32 v84, v84
  v_exp_f32 v85, v85
  v_exp_f32 v86, v86
  s_mov_b32 m0, s22
  s_nop 0
  buffer_load_dwordx4 v100, s[8:11], s22 offen lds
  s_add_u32 s22, s22, 8192
  v_exp_f32 v87, v87
  v_cvt_pk_bf16_f32 v38, v84, v85
  v_cvt_pk_bf16_f32 v39, v86, v87
  s_waitcnt lgkmcnt(0)
  v_mfma_f32_32x32x16_bf16 v[72:87], v[16:19], v[8:11], 0
  ds_read_b128 v[104:107], v2 offset:14208
  ds_read_b128 v[114:117], v6 offset:9472
  v_exp_f32 v56, v56
  v_exp_f32 v57, v57
  v_exp_f32 v58, v58
  v_exp_f32 v59, v59
  v_mfma_f32_32x32x16_bf16 v[40:55], v[28:31], v[36:39], v[40:55]
  ds_read_b32 v108, v3 offset:14208
  ds_read_b128 v[110:113], v4 offset:11840
  v_cvt_pk_bf16_f32 v32, v56, v57
  v_cvt_pk_bf16_f32 v33, v58, v59
  v_exp_f32 v60, v60
  v_exp_f32 v61, v61
  v_exp_f32 v62, v62
  s_sub_u32 s30, s22, 4096
  s_mov_b32 m0, s30
  s_nop 0
  buffer_load_dwordx4 v100, s[8:11], s30 offen lds
  v_exp_f32 v63, v63
  v_mfma_f32_32x32x8_bf16 v[72:87], v[20:21], v[12:13], v[72:87]
  v_cvt_pk_bf16_f32 v34, v60, v61
  v_cvt_pk_bf16_f32 v35, v62, v63
  v_exp_f32 v64, v64
  v_exp_f32 v65, v65
  v_exp_f32 v66, v66
  v_exp_f32 v67, v67
  v_mfma_f32_32x32x16_bf16 v[40:55], v[24:27], v[32:35], v[40:55]
  v_cvt_pk_bf16_f32 v36, v64, v65
  v_cvt_pk_bf16_f32 v37, v66, v67
  v_exp_f32 v68, v68
  v_exp_f32 v69, v69
  v_exp_f32 v70, v70
  s_mov_b32 m0, s22
  s_nop 0
  buffer_load_dwordx4 v100, s[8:11], s22 offen lds
  s_add_u32 s22, s22, 8192
  v_exp_f32 v71, v71
  v_cvt_pk_bf16_f32 v38, v68, v69
  v_cvt_pk_bf16_f32 v39, v70, v71
  s_waitcnt lgkmcnt(0)
  v_mfma_f32_32x32x16_bf16 v[56:71], v[104:107], v[8:11], 0
  ds_read_b128 v[16:19], v2 offset:16576
  ds_read_b128 v[28:31], v6 offset:11840
  v_exp_f32 v72, v72
  v_exp_f32 v73, v73
  v_exp_f32 v74, v74
  v_exp_f32 v75, v75
  v_mfma_f32_32x32x16_bf16 v[40:55], v[114:117], v[36:39], v[40:55]
  ds_read_b32 v20, v3 offset:16576
  ds_read_b128 v[24:27], v4 offset:14208
  v_cvt_pk_bf16_f32 v32, v72, v73
  v_cvt_pk_bf16_f32 v33, v74, v75
  v_exp_f32 v76, v76
  v_exp_f32 v77, v77
  v_exp_f32 v78, v78
  s_sub_u32 s30, s22, 4096
  s_mov_b32 m0, s30
  s_nop 0
  buffer_load_dwordx4 v100, s[8:11], s30 offen lds
  v_exp_f32 v79, v79
  v_mfma_f32_32x32x8_bf16 v[56:71], v[108:109], v[12:13], v[56:71]
  v_cvt_pk_bf16_f32 v34, v76, v77
  v_cvt_pk_bf16_f32 v35, v78, v79
  v_exp_f32 v80, v80
  v_exp_f32 v81, v81
  v_exp_f32 v82, v82
  v_exp_f32 v83, v83
  v_mfma_f32_32x32x16_bf16 v[40:55], v[110:113], v[32:35], v[40:55]
  v_cvt_pk_bf16_f32 v36, v80, v81
  v_cvt_pk_bf16_f32 v37, v82, v83
  v_exp_f32 v84, v84
  v_exp_f32 v85, v85
  v_exp_f32 v86, v86
  s_mov_b32 m0, s22
  s_nop 0
  buffer_load_dwordx4 v100, s[8:11], s22 offen lds
  s_add_u32 s22, s22, 8192
  v_exp_f32 v87, v87
  v_cvt_pk_bf16_f32 v38, v84, v85
  v_cvt_pk_bf16_f32 v39, v86, v87
  s_waitcnt lgkmcnt(0)
  v_mfma_f32_32x32x16_bf16 v[72:87], v[16:19], v[8:11], 0
  ds_read_b128 v[104:107], v2 offset:18944
  ds_read_b128 v[114:117], v6 offset:14208
  v_exp_f32 v56, v56
  v_exp_f32 v57, v57
  v_exp_f32 v58, v58
  v_exp_f32 v59, v59
  v_mfma_f32_32x32x16_bf16 v[40:55], v[28:31], v[36:39], v[40:55]
  ds_read_b32 v108, v3 offset:18944
  ds_read_b128 v[110:113], v4 offset:16576
  v_cvt_pk_bf16_f32 v32, v56, v57
  v_cvt_pk_bf16_f32 v33, v58, v59
  v_exp_f32 v60, v60
  v_exp_f32 v61, v61
  v_exp_f32 v62, v62
  s_sub_u32 s30, s22, 4096
  s_mov_b32 m0, s30
  s_nop 0
  buffer_load_dwordx4 v100, s[8:11], s30 offen lds
  v_exp_f32 v63, v63
  v_mfma_f32_32x32x8_bf16 v[72:87], v[20:21], v[12:13], v[72:87]
  v_cvt_pk_bf16_f32 v34, v60, v61
  v_cvt_pk_bf16_f32 v35, v62, v63
  v_exp_f32 v64, v64
  v_exp_f32 v65, v65
  v_exp_f32 v66, v66
  v_exp_f32 v67, v67
  v_mfma_f32_32x32x16_bf16 v[40:55], v[24:27], v[32:35], v[40:55]
  v_cvt_pk_bf16_f32 v36, v64, v65
  v_cvt_pk_bf16_f32 v37, v66, v67
  v_exp_f32 v68, v68
  v_exp_f32 v69, v69
  v_exp_f32 v70, v70
  s_mov_b32 m0, s22
  s_nop 0
  buffer_load_dwordx4 v100, s[8:11], s22 offen lds
  s_add_u32 s22, s22, 8192
  v_exp_f32 v71, v71
  v_cvt_pk_bf16_f32 v38, v68, v69
  v_cvt_pk_bf16_f32 v39, v70, v71
  s_waitcnt lgkmcnt(0)
  v_mfma_f32_32x32x16_bf16 v[56:71], v[104:107], v[8:11], 0
  ds_read_b128 v[16:19], v2 offset:21312
  ds_read_b128 v[28:31], v6 offset:16576
  v_exp_f32 v72, v72
  v_exp_f32 v73, v73
  v_exp_f32 v74, v74
  v_exp_f32 v75, v75
  v_mfma_f32_32x32x16_bf16 v[40:55], v[114:117], v[36:39], v[40:55]
  ds_read_b32 v20, v3 offset:21312
  ds_read_b128 v[24:27], v4 offset:18944
  v_cvt_pk_bf16_f32 v32, v72, v73
  v_cvt_pk_bf16_f32 v33, v74, v75
  v_exp_f32 v76, v76
  v_exp_f32 v77, v77
  v_exp_f32 v78, v78
  s_sub_u32 s30, s22, 4096
  s_mov_b32 m0, s30
  s_nop 0
  buffer_load_dwordx4 v100, s[8:11], s30 offen lds
  s_add_u32 s22, s22, 8192
  v_exp_f32 v79, v79
  v_mfma_f32_32x32x8_bf16 v[56:71], v[108:109], v[12:13], v[56:71]
  v_cvt_pk_bf16_f32 v34, v76, v77
  v_cvt_pk_bf16_f32 v35, v78, v79
  v_exp_f32 v80, v80
  v_exp_f32 v81, v81
  v_exp_f32 v82, v82
  v_exp_f32 v83, v83
  v_mfma_f32_32x32x16_bf16 v[40:55], v[110:113], v[32:35], v[40:55]
  v_cvt_pk_bf16_f32 v36, v80, v81
  v_cvt_pk_bf16_f32 v37, v82, v83
  v_exp_f32 v84, v84
  v_exp_f32 v85, v85
  v_exp_f32 v86, v86
  v_exp_f32 v87, v87
  v_cvt_pk_bf16_f32 v38, v84, v85
  v_cvt_pk_bf16_f32 v39, v86, v87
  v_add_u32 v2, 18944, v2
  v_add_u32 v3, 18944, v3
  v_add_u32 v4, 18944, v4
  v_xor_b32 v6, 32, v4
  s_mov_b32 s66, 5
  s_mov_b32 s23, 0
  s_mov_b32 s65, 99
k2_attn_kernel_loop:
  s_waitcnt lgkmcnt(0)
  v_mfma_f32_32x32x16_bf16 v[72:87], v[16:19], v[8:11], 0
  ds_read_b128 v[104:107], v2 offset:4736
  ds_read_b128 v[114:117], v6 offset:0
  v_exp_f32 v56, v56
  v_exp_f32 v57, v57
  v_exp_f32 v58, v58
  v_exp_f32 v59, v59
  v_mfma_f32_32x32x16_bf16 v[40:55], v[28:31], v[36:39], v[40:55]
  ds_read_b32 v108, v3 offset:4736
  ds_read_b128 v[110:113], v4 offset:2368
  v_cvt_pk_bf16_f32 v32, v56, v57
  v_cvt_pk_bf16_f32 v33, v58, v59
  v_exp_f32 v60, v60
  v_exp_f32 v61, v61
  v_exp_f32 v62, v62
  v_exp_f32 v63, v63
  v_mfma_f32_32x32x8_bf16 v[72:87], v[20:21], v[12:13], v[72:87]
  v_cvt_pk_bf16_f32 v34, v60, v61
  v_cvt_pk_bf16_f32 v35, v62, v63
  v_exp_f32 v64, v64
  v_exp_f32 v65, v65
  v_exp_f32 v66, v66
  v_exp_f32 v67, v67
  v_mfma_f32_32x32x16_bf16 v[40:55], v[24:27], v[32:35], v[40:55]
  v_cvt_pk_bf16_f32 v36, v64, v65
  v_cvt_pk_bf16_f32 v37, v66, v67
  v_exp_f32 v68, v68
  v_exp_f32 v69, v69
  v_exp_f32 v70, v70
  v_exp_f32 v71, v71
  v_cvt_pk_bf16_f32 v38, v68, v69
  v_cvt_pk_bf16_f32 v39, v70, v71
  s_waitcnt lgkmcnt(0)
  v_mfma_f32_32x32x16_bf16 v[56:71], v[104:107], v[8:11], 0
  ds_read_b128 v[16:19], v2 offset:7104
  ds_read_b128 v[28:31], v6 offset:2368
  v_exp_f32 v72, v72
  v_exp_f32 v73, v73
  v_exp_f32 v74, v74
  v_exp_f32 v75, v75
  v_mfma_f32_32x32x16_bf16 v[40:55], v[114:117], v[36:39], v[40:55]
  ds_read_b32 v20, v3 offset:7104
  ds_read_b128 v[24:27], v4 offset:4736
  v_cvt_pk_bf16_f32 v32, v72, v73
  v_cvt_pk_bf16_f32 v33, v74, v75
  v_exp_f32 v76, v76
  v_exp_f32 v77, v77
  v_exp_f32 v78, v78
  v_exp_f32 v79, v79
  v_mfma_f32_32x32x8_bf16 v[56:71], v[108:109], v[12:13], v[56:71]
  v_cvt_pk_bf16_f32 v34, v76, v77
  v_cvt_pk_bf16_f32 v35, v78, v79
  v_exp_f32 v80, v80
  v_exp_f32 v81, v81
  v_exp_f32 v82, v82
  v_exp_f32 v83, v83
  v_mfma_f32_32x32x16_bf16 v[40:55], v[110:113], v[32:35], v[40:55]
  v_cvt_pk_bf16_f32 v36, v80, v81
  v_cvt_pk_bf16_f32 v37, v82, v83
  v_exp_f32 v84, v84
  v_exp_f32 v85, v85
  v_exp_f32 v86, v86
  v_exp_f32 v87, v87
  v_cvt_pk_bf16_f32 v38, v84, v85
  v_cvt_pk_bf16_f32 v39, v86, v87
  s_waitcnt lgkmcnt(0)
  v_mfma_f32_32x32x16_bf16 v[72:87], v[16:19], v[8:11], 0
  ds_read_b128 v[104:107], v2 offset:9472
  ds_read_b128 v[114:117], v6 offset:4736
  v_exp_f32 v56, v56
  v_exp_f32 v57, v57
  v_exp_f32 v58, v58
  v_exp_f32 v59, v59
  v_mfma_f32_32x32x16_bf16 v[40:55], v[28:31], v[36:39], v[40:55]
  ds_read_b32 v108, v3 offset:9472
  ds_read_b128 v[110:113], v4 offset:7104
  v_cvt_pk_bf16_f32 v32, v56, v57
  v_cvt_pk_bf16_f32 v33, v58, v59
  v_exp_f32 v60, v60
  v_exp_f32 v61, v61
  v_exp_f32 v62, v62
  v_exp_f32 v63, v63
  v_mfma_f32_32x32x8_bf16 v[72:87], v[20:21], v[12:13], v[72:87]
  v_cvt_pk_bf16_f32 v34, v60, v61
  v_cvt_pk_bf16_f32 v35, v62, v63
  v_exp_f32 v64, v64
  v_exp_f32 v65, v65
  v_exp_f32 v66, v66
  v_exp_f32 v67, v67
  v_mfma_f32_32x32x16_bf16 v[40:55], v[24:27], v[32:35], v[40:55]
  v_cvt_pk_bf16_f32 v36, v64, v65
  v_cvt_pk_bf16_f32 v37, v66, v67
  v_exp_f32 v68, v68
  v_exp_f32 v69, v69
  v_exp_f32 v70, v70
  v_exp_f32 v71, v71
  v_cvt_pk_bf16_f32 v38, v68, v69
  v_cvt_pk_bf16_f32 v39, v70, v71
  s_waitcnt lgkmcnt(0)
  v_mfma_f32_32x32x16_bf16 v[56:71], v[104:107], v[8:11], 0
  ds_read_b128 v[16:19], v2 offset:11840
  ds_read_b128 v[28:31], v6 offset:7104
  v_exp_f32 v72, v72
  v_exp_f32 v73, v73
  v_exp_f32 v74, v74
  v_exp_f32 v75, v75
  v_mfma_f32_32x32x16_bf16 v[40:55], v[114:117], v[36:39], v[40:55]
  ds_read_b32 v20, v3 offset:11840
  ds_read_b128 v[24:27], v4 offset:9472
  v_cvt_pk_bf16_f32 v32, v72, v73
  v_cvt_pk_bf16_f32 v33, v74, v75
  v_exp_f32 v76, v76
  v_exp_f32 v77, v77
  v_exp_f32 v78, v78
  v_exp_f32 v79, v79
  v_mfma_f32_32x32x8_bf16 v[56:71], v[108:109], v[12:13], v[56:71]
  v_cvt_pk_bf16_f32 v34, v76, v77
  v_cvt_pk_bf16_f32 v35, v78, v79
  v_exp_f32 v80, v80
  v_exp_f32 v81, v81
  v_exp_f32 v82, v82
  v_exp_f32 v83, v83
  v_mfma_f32_32x32x16_bf16 v[40:55], v[110:113], v[32:35], v[40:55]
  v_cvt_pk_bf16_f32 v36, v80, v81
  v_cvt_pk_bf16_f32 v37, v82, v83
  v_exp_f32 v84, v84
  v_exp_f32 v85, v85
  v_exp_f32 v86, v86
  v_exp_f32 v87, v87
  v_cvt_pk_bf16_f32 v38, v84, v85
  v_cvt_pk_bf16_f32 v39, v86, v87
  s_waitcnt lgkmcnt(0)
  v_mfma_f32_32x32x16_bf16 v[72:87], v[16:19], v[8:11], 0
  ds_read_b128 v[104:107], v2 offset:14208
  ds_read_b128 v[114:117], v6 offset:9472
  v_exp_f32 v56, v56
  v_exp_f32 v57, v57
  v_exp_f32 v58, v58
  v_exp_f32 v59, v59
  v_mfma_f32_32x32x16_bf16 v[40:55], v[28:31], v[36:39], v[40:55]
  ds_read_b32 v108, v3 offset:14208
  ds_read_b128 v[110:113], v4 offset:11840
  v_cvt_pk_bf16_f32 v32, v56, v57
  v_cvt_pk_bf16_f32 v33, v58, v59
  v_exp_f32 v60, v60
  v_exp_f32 v61, v61
  v_exp_f32 v62, v62
  v_exp_f32 v63, v63
  v_mfma_f32_32x32x8_bf16 v[72:87], v[20:21], v[12:13], v[72:87]
  v_cvt_pk_bf16_f32 v34, v60, v61
  v_cvt_pk_bf16_f32 v35, v62, v63
  v_exp_f32 v64, v64
  v_exp_f32 v65, v65
  v_exp_f32 v66, v66
  v_exp_f32 v67, v67
  v_mfma_f32_32x32x16_bf16 v[40:55], v[24:27], v[32:35], v[40:55]
  v_cvt_pk_bf16_f32 v36, v64, v65
  v_cvt_pk_bf16_f32 v37, v66, v67
  v_exp_f32 v68, v68
  v_exp_f32 v69, v69
  v_exp_f32 v70, v70
  v_exp_f32 v71, v71
  v_cvt_pk_bf16_f32 v38, v68, v69
  v_cvt_pk_bf16_f32 v39, v70, v71
  s_waitcnt lgkmcnt(0)
  v_mfma_f32_32x32x16_bf16 v[56:71], v[104:107], v[8:11], 0
  ds_read_b128 v[16:19], v2 offset:16576
  ds_read_b128 v[28:31], v6 offset:11840
  v_exp_f32 v72, v72
  v_exp_f32 v73, v73
  v_exp_f32 v74, v74
  v_exp_f32 v75, v75
  v_mfma_f32_32x32x16_bf16 v[40:55], v[114:117], v[36:39], v[40:55]
  ds_read_b32 v20, v3 offset:16576
  ds_read_b128 v[24:27], v4 offset:14208
  v_cvt_pk_bf16_f32 v32, v72, v73
  v_cvt_pk_bf16_f32 v33, v74, v75
  v_exp_f32 v76, v76
  v_exp_f32 v77, v77
  v_exp_f32 v78, v78
  v_exp_f32 v79, v79
  v_mfma_f32_32x32x8_bf16 v[56:71], v[108:109], v[12:13], v[56:71]
  v_cvt_pk_bf16_f32 v34, v76, v77
  v_cvt_pk_bf16_f32 v35, v78, v79
  v_exp_f32 v80, v80
  v_exp_f32 v81, v81
  v_exp_f32 v82, v82
  v_exp_f32 v83, v83
  v_mfma_f32_32x32x16_bf16 v[40:55], v[110:113], v[32:35], v[40:55]
  v_cvt_pk_bf16_f32 v36, v80, v81
  v_cvt_pk_bf16_f32 v37, v82, v83
  v_exp_f32 v84, v84
  v_exp_f32 v85, v85
  v_exp_f32 v86, v86
  v_exp_f32 v87, v87
  v_cvt_pk_bf16_f32 v38, v84, v85
  v_cvt_pk_bf16_f32 v39, v86, v87
  s_waitcnt lgkmcnt(0)
  v_mfma_f32_32x32x16_bf16 v[72:87], v[16:19], v[8:11], 0
  ds_read_b128 v[104:107], v2 offset:18944
  ds_read_b128 v[114:117], v6 offset:14208
  v_exp_f32 v56, v56
  v_exp_f32 v57, v57
  v_exp_f32 v58, v58
  v_exp_f32 v59, v59
  v_mfma_f32_32x32x16_bf16 v[40:55], v[28:31], v[36:39], v[40:55]
  ds_read_b32 v108, v3 offset:18944
  ds_read_b128 v[110:113], v4 offset:16576
  v_cvt_pk_bf16_f32 v32, v56, v57
  v_cvt_pk_bf16_f32 v33, v58, v59
  v_exp_f32 v60, v60
  v_exp_f32 v61, v61
  v_exp_f32 v62, v62
  v_exp_f32 v63, v63
  v_mfma_f32_32x32x8_bf16 v[72:87], v[20:21], v[12:13], v[72:87]
  v_cvt_pk_bf16_f32 v34, v60, v61
  v_cvt_pk_bf16_f32 v35, v62, v63
  v_exp_f32 v64, v64
  v_exp_f32 v65, v65
  v_exp_f32 v66, v66
  v_exp_f32 v67, v67
  v_mfma_f32_32x32x16_bf16 v[40:55], v[24:27], v[32:35], v[40:55]
  v_cvt_pk_bf16_f32 v36, v64, v65
  v_cvt_pk_bf16_f32 v37, v66, v67
  v_exp_f32 v68, v68
  v_exp_f32 v69, v69
  v_exp_f32 v70, v70
  v_exp_f32 v71, v71
  v_cvt_pk_bf16_f32 v38, v68, v69
  v_cvt_pk_bf16_f32 v39, v70, v71
  s_waitcnt lgkmcnt(0)
  v_mfma_f32_32x32x16_bf16 v[56:71], v[104:107], v[8:11], 0
  ds_read_b128 v[16:19], v2 offset:21312
  ds_read_b128 v[28:31], v6 offset:16576
  v_exp_f32 v72, v72
  v_exp_f32 v73, v73
  v_exp_f32 v74, v74
  v_exp_f32 v75, v75
  v_mfma_f32_32x32x16_bf16 v[40:55], v[114:117], v[36:39], v[40:55]
  ds_read_b32 v20, v3 offset:21312
  ds_read_b128 v[24:27], v4 offset:18944
  v_cvt_pk_bf16_f32 v32, v72, v73
  v_cvt_pk_bf16_f32 v33, v74, v75
  v_exp_f32 v76, v76
  v_exp_f32 v77, v77
  v_exp_f32 v78, v78
  v_exp_f32 v79, v79
  v_mfma_f32_32x32x8_bf16 v[56:71], v[108:109], v[12:13], v[56:71]
  v_cvt_pk_bf16_f32 v34, v76, v77
  v_cvt_pk_bf16_f32 v35, v78, v79
  v_exp_f32 v80, v80
  v_exp_f32 v81, v81
  v_exp_f32 v82, v82
  v_exp_f32 v83, v83
  v_mfma_f32_32x32x16_bf16 v[40:55], v[110:113], v[32:35], v[40:55]
  v_cvt_pk_bf16_f32 v36, v80, v81
  v_cvt_pk_bf16_f32 v37, v82, v83
  v_exp_f32 v84, v84
  v_exp_f32 v85, v85
  v_exp_f32 v86, v86
  v_exp_f32 v87, v87
  v_cvt_pk_bf16_f32 v38, v84, v85
  v_cvt_pk_bf16_f32 v39, v86, v87
  v_add_u32 v2, 18944, v2
  v_add_u32 v3, 18944, v3
  v_add_u32 v4, 18944, v4
  v_xor_b32 v6, 32, v4
  s_sub_u32 s23, s23, 1
  s_cbranch_scc0 k2_attn_kernel_loop
  s_cmp_eq_u32 s66, 0
  s_cbranch_scc1 k2_attn_kernel_last
  s_cmp_eq_u32 s66, 3
  s_cbranch_scc1 k2_attn_kernel_ph3
  s_waitcnt vmcnt(0)
  s_barrier
  s_cmp_eq_u32 s66, 1
  s_cbranch_scc1 k2_attn_kernel_osig
  s_mov_b32 s66, 0
  s_mov_b32 s23, 3
  s_branch k2_attn_kernel_loop
k2_attn_kernel_osig:
  s_cmp_eq_u32 s98, 3
  s_cbranch_scc0 k2_attn_kernel_nosig
  v_mov_b32 v89, 1
  s_lshl_b32 s30, s4, 8
  s_add_u32 s30, s30, 23134208
  s_mov_b64 exec, 1
  buffer_atomic_add v89, off, s[36:39], s30 sc1
  s_mov_b64 exec, -1
k2_attn_kernel_nosig:
  s_lshr_b32 s6, s2, 3
  s_lshl_b32 s6, s6, 2
  s_add_u32 s6, s6, s98
  s_mul_i32 s6, s6, 5248
  s_add_u32 s6, s6, 24117248
  v_lshlrev_b32 v5, 7, v1
  v_cmp_gt_u32 vcc, 41, v1
  s_and_saveexec_b64 s[32:33], vcc
  buffer_load_dword v204, v5, s[36:39], s6 offen
  s_mov_b64 exec, s[32:33]
  s_mov_b32 s66, 3
  s_mov_b32 s23, 2
  s_branch k2_attn_kernel_loop
k2_attn_kernel_ph3:
  s_mov_b32 s66, 0
  s_mov_b32 s23, 0
  s_cmp_eq_u32 s98, 3
  s_cbranch_scc1 k2_attn_kernel_loop
  s_and_b32 s30, s2, 7
  s_lshl_b32 s30, s30, 8
  s_add_u32 s30, s30, 23134208
  s_mov_b32 s6, 0
  s_mov_b32 s31, 60000
k2_attn_kernel_aspin:
  s_cmp_eq_u32 s6, 32
  s_cbranch_scc1 k2_attn_kernel_aspin_go
  s_sub_u32 s31, s31, 1
  s_cbranch_scc1 k2_attn_kernel_aspin_go
  buffer_load_dword v207, off, s[36:39], s30 sc1
  s_waitcnt vmcnt(0)
  v_readfirstlane_b32 s6, v207
  s_branch k2_attn_kernel_aspin
k2_attn_kernel_aspin_go:
  s_mov_b32 s66, 4
  s_and_b32 s6, s2, 7
  s_lshl_b32 s6, s6, 3
  s_lshr_b32 s30, s2, 5
  s_add_u32 s62, s6, s30
  s_lshr_b32 s30, s2, 3
  s_and_b32 s30, s30, 3
  s_mul_i32 s30, s30, 3
  s_add_u32 s63, s30, s98
  s_lshl_b32 s68, s62, 15
  s_add_u32 s68, s68, 19922944
  s_mul_i32 s69, s63, 55296
  s_add_u32 s69, s69, 24117248
  s_lshl_b32 s67, s62, 12
  s_add_u32 s67, s67, 22020096
  v_lshlrev_b32 v220, 4, v1
  v_lshlrev_b32 v221, 3, v1
  v_lshrrev_b32 v223, 4, v1
  v_lshlrev_b32 v223, 9, v223
  v_and_b32 v222, 15, v1
  v_lshl_add_u32 v223, v222, 2, v223
  v_mov_b32 v222, 1
  s_mov_b32 s80, s68
  s_add_u32 s81, s68, 16384
  s_mov_b32 s82, s69
  s_add_u32 s83, s69, 18432
  s_add_u32 s84, s69, 36864
  buffer_load_dwordx4 v[120:123], v220, s[36:39], s80 offen offset:0
  buffer_load_dwordx4 v[124:127], v220, s[36:39], s81 offen offset:0
  buffer_load_dwordx4 v[128:131], v220, s[36:39], s82 offen offset:0
  buffer_load_dwordx4 v[132:135], v220, s[36:39], s83 offen offset:0
  buffer_load_dwordx4 v[136:139], v220, s[36:39], s84 offen offset:0
  buffer_load_dwordx4 v[140:143], v220, s[36:39], s80 offen offset:1024
  buffer_load_dwordx4 v[144:147], v220, s[36:39], s81 offen offset:1024
  buffer_load_dwordx4 v[148:151], v220, s[36:39], s82 offen offset:1024
  buffer_load_dwordx4 v[152:155], v220, s[36:39], s83 offen offset:1024
  buffer_load_dwordx4 v[156:159], v220, s[36:39], s84 offen offset:1024
  buffer_load_dwordx4 v[160:163], v220, s[36:39], s80 offen offset:2048
  buffer_load_dwordx4 v[164:167], v220, s[36:39], s81 offen offset:2048
  buffer_load_dwordx4 v[168:171], v220, s[36:39], s82 offen offset:2048
  buffer_load_dwordx4 v[172:175], v220, s[36:39], s83 offen offset:2048
  buffer_load_dwordx4 v[176:179], v220, s[36:39], s84 offen offset:2048
  buffer_load_dwordx4 v[180:183], v220, s[36:39], s80 offen offset:3072
  buffer_load_dwordx4 v[184:187], v220, s[36:39], s81 offen offset:3072
  buffer_load_dwordx4 v[188:191], v220, s[36:39], s82 offen offset:3072
  buffer_load_dwordx4 v[192:195], v220, s[36:39], s83 offen offset:3072
  buffer_load_dwordx4 v[196:199], v220, s[36:39], s84 offen offset:3072
  s_add_u32 s80, s80, 4096
  s_add_u32 s81, s81, 4096
  s_add_u32 s82, s82, 4096
  s_add_u32 s83, s83, 4096
  s_add_u32 s84, s84, 4096
  buffer_load_dwordx4 v[200:203], v220, s[36:39], s80 offen offset:0
  buffer_load_dwordx4 v[204:207], v220, s[36:39], s81 offen offset:0
  buffer_load_dwordx4 v[208:211], v220, s[36:39], s82 offen offset:0
  buffer_load_dwordx4 v[212:215], v220, s[36:39], s83 offen offset:0
  buffer_load_dwordx4 v[216:219], v220, s[36:39], s84 offen offset:0
  s_waitcnt lgkmcnt(0)
  v_mfma_f32_32x32x16_bf16 v[72:87], v[16:19], v[8:11], 0
  ds_read_b128 v[104:107], v2 offset:4736
  ds_read_b128 v[114:117], v6 offset:0
  v_exp_f32 v56, v56
  v_exp_f32 v57, v57
  v_exp_f32 v58, v58
  v_exp_f32 v59, v59
  v_mfma_f32_32x32x16_bf16 v[40:55], v[28:31], v[36:39], v[40:55]
  ds_read_b32 v108, v3 offset:4736
  ds_read_b128 v[110:113], v4 offset:2368
  v_cvt_pk_bf16_f32 v32, v56, v57
  v_cvt_pk_bf16_f32 v33, v58, v59
  v_exp_f32 v60, v60
  v_exp_f32 v61, v61
  v_exp_f32 v62, v62
  v_exp_f32 v63, v63
  v_mfma_f32_32x32x8_bf16 v[72:87], v[20:21], v[12:13], v[72:87]
  v_cvt_pk_bf16_f32 v34, v60, v61
  v_cvt_pk_bf16_f32 v35, v62, v63
  v_exp_f32 v64, v64
  v_exp_f32 v65, v65
  v_exp_f32 v66, v66
  v_exp_f32 v67, v67
  v_mfma_f32_32x32x16_bf16 v[40:55], v[24:27], v[32:35], v[40:55]
  v_cvt_pk_bf16_f32 v36, v64, v65
  v_cvt_pk_bf16_f32 v37, v66, v67
  v_exp_f32 v68, v68
  v_exp_f32 v69, v69
  v_exp_f32 v70, v70
  v_exp_f32 v71, v71
  v_cvt_pk_bf16_f32 v38, v68, v69
  v_cvt_pk_bf16_f32 v39, v70, v71
  s_waitcnt lgkmcnt(0)
  v_mfma_f32_32x32x16_bf16 v[56:71], v[104:107], v[8:11], 0
  ds_read_b128 v[16:19], v2 offset:7104
  ds_read_b128 v[28:31], v6 offset:2368
  v_exp_f32 v72, v72
  v_exp_f32 v73, v73
  v_exp_f32 v74, v74
  v_exp_f32 v75, v75
  v_mfma_f32_32x32x16_bf16 v[40:55], v[114:117], v[36:39], v[40:55]
  ds_read_b32 v20, v3 offset:7104
  ds_read_b128 v[24:27], v4 offset:4736
  v_cvt_pk_bf16_f32 v32, v72, v73
  v_cvt_pk_bf16_f32 v33, v74, v75
  v_exp_f32 v76, v76
  v_exp_f32 v77, v77
  v_exp_f32 v78, v78
  v_exp_f32 v79, v79
  v_mfma_f32_32x32x8_bf16 v[56:71], v[108:109], v[12:13], v[56:71]
  v_cvt_pk_bf16_f32 v34, v76, v77
  v_cvt_pk_bf16_f32 v35, v78, v79
  v_exp_f32 v80, v80
  v_exp_f32 v81, v81
  v_exp_f32 v82, v82
  v_exp_f32 v83, v83
  v_mfma_f32_32x32x16_bf16 v[40:55], v[110:113], v[32:35], v[40:55]
  v_cvt_pk_bf16_f32 v36, v80, v81
  v_cvt_pk_bf16_f32 v37, v82, v83
  v_exp_f32 v84, v84
  v_exp_f32 v85, v85
  v_exp_f32 v86, v86
  v_exp_f32 v87, v87
  v_cvt_pk_bf16_f32 v38, v84, v85
  v_cvt_pk_bf16_f32 v39, v86, v87
  s_waitcnt lgkmcnt(0)
  v_mfma_f32_32x32x16_bf16 v[72:87], v[16:19], v[8:11], 0
  ds_read_b128 v[104:107], v2 offset:9472
  ds_read_b128 v[114:117], v6 offset:4736
  v_exp_f32 v56, v56
  v_exp_f32 v57, v57
  v_exp_f32 v58, v58
  v_exp_f32 v59, v59
  v_mfma_f32_32x32x16_bf16 v[40:55], v[28:31], v[36:39], v[40:55]
  ds_read_b32 v108, v3 offset:9472
  ds_read_b128 v[110:113], v4 offset:7104
  v_cvt_pk_bf16_f32 v32, v56, v57
  v_cvt_pk_bf16_f32 v33, v58, v59
  v_exp_f32 v60, v60
  v_exp_f32 v61, v61
  v_exp_f32 v62, v62
  v_exp_f32 v63, v63
  v_mfma_f32_32x32x8_bf16 v[72:87], v[20:21], v[12:13], v[72:87]
  v_cvt_pk_bf16_f32 v34, v60, v61
  v_cvt_pk_bf16_f32 v35, v62, v63
  v_exp_f32 v64, v64
  v_exp_f32 v65, v65
  v_exp_f32 v66, v66
  v_exp_f32 v67, v67
  v_mfma_f32_32x32x16_bf16 v[40:55], v[24:27], v[32:35], v[40:55]
  v_cvt_pk_bf16_f32 v36, v64, v65
  v_cvt_pk_bf16_f32 v37, v66, v67
  v_exp_f32 v68, v68
  v_exp_f32 v69, v69
  v_exp_f32 v70, v70
  v_exp_f32 v71, v71
  v_cvt_pk_bf16_f32 v38, v68, v69
  v_cvt_pk_bf16_f32 v39, v70, v71
  s_waitcnt lgkmcnt(0)
  v_mfma_f32_32x32x16_bf16 v[56:71], v[104:107], v[8:11], 0
  ds_read_b128 v[16:19], v2 offset:11840
  ds_read_b128 v[28:31], v6 offset:7104
  v_exp_f32 v72, v72
  v_exp_f32 v73, v73
  v_exp_f32 v74, v74
  v_exp_f32 v75, v75
  v_mfma_f32_32x32x16_bf16 v[40:55], v[114:117], v[36:39], v[40:55]
  ds_read_b32 v20, v3 offset:11840
  ds_read_b128 v[24:27], v4 offset:9472
  v_cvt_pk_bf16_f32 v32, v72, v73
  v_cvt_pk_bf16_f32 v33, v74, v75
  v_exp_f32 v76, v76
  v_exp_f32 v77, v77
  v_exp_f32 v78, v78
  v_exp_f32 v79, v79
  v_mfma_f32_32x32x8_bf16 v[56:71], v[108:109], v[12:13], v[56:71]
  v_cvt_pk_bf16_f32 v34, v76, v77
  v_cvt_pk_bf16_f32 v35, v78, v79
  v_exp_f32 v80, v80
  v_exp_f32 v81, v81
  v_exp_f32 v82, v82
  v_exp_f32 v83, v83
  v_mfma_f32_32x32x16_bf16 v[40:55], v[110:113], v[32:35], v[40:55]
  v_cvt_pk_bf16_f32 v36, v80, v81
  v_cvt_pk_bf16_f32 v37, v82, v83
  v_exp_f32 v84, v84
  v_exp_f32 v85, v85
  v_exp_f32 v86, v86
  v_exp_f32 v87, v87
  v_cvt_pk_bf16_f32 v38, v84, v85
  v_cvt_pk_bf16_f32 v39, v86, v87
  s_waitcnt lgkmcnt(0)
  v_mfma_f32_32x32x16_bf16 v[72:87], v[16:19], v[8:11], 0
  ds_read_b128 v[104:107], v2 offset:14208
  ds_read_b128 v[114:117], v6 offset:9472
  v_exp_f32 v56, v56
  v_exp_f32 v57, v57
  v_exp_f32 v58, v58
  v_exp_f32 v59, v59
  v_mfma_f32_32x32x16_bf16 v[40:55], v[28:31], v[36:39], v[40:55]
  ds_read_b32 v108, v3 offset:14208
  ds_read_b128 v[110:113], v4 offset:11840
  v_cvt_pk_bf16_f32 v32, v56, v57
  v_cvt_pk_bf16_f32 v33, v58, v59
  v_exp_f32 v60, v60
  v_exp_f32 v61, v61
  v_exp_f32 v62, v62
  v_exp_f32 v63, v63
  v_mfma_f32_32x32x8_bf16 v[72:87], v[20:21], v[12:13], v[72:87]
  v_cvt_pk_bf16_f32 v34, v60, v61
  v_cvt_pk_bf16_f32 v35, v62, v63
  v_exp_f32 v64, v64
  v_exp_f32 v65, v65
  v_exp_f32 v66, v66
  v_exp_f32 v67, v67
  v_mfma_f32_32x32x16_bf16 v[40:55], v[24:27], v[32:35], v[40:55]
  v_cvt_pk_bf16_f32 v36, v64, v65
  v_cvt_pk_bf16_f32 v37, v66, v67
  v_exp_f32 v68, v68
  v_exp_f32 v69, v69
  v_exp_f32 v70, v70
  v_exp_f32 v71, v71
  v_cvt_pk_bf16_f32 v38, v68, v69
  v_cvt_pk_bf16_f32 v39, v70, v71
  s_waitcnt lgkmcnt(0)
  v_mfma_f32_32x32x16_bf16 v[56:71], v[104:107], v[8:11], 0
  ds_read_b128 v[16:19], v2 offset:16576
  ds_read_b128 v[28:31], v6 offset:11840
  v_exp_f32 v72, v72
  v_exp_f32 v73, v73
  v_exp_f32 v74, v74
  s_waitcnt vmcnt(20)
  v_mfma_f32_16x16x32_bf16 v[232:235], v[128:131], v[120:123], 0
  v_exp_f32 v75, v75
  v_mfma_f32_32x32x16_bf16 v[40:55], v[114:117], v[36:39], v[40:55]
  ds_read_b32 v20, v3 offset:16576
  ds_read_b128 v[24:27], v4 offset:14208
  v_cvt_pk_bf16_f32 v32, v72, v73
  v_cvt_pk_bf16_f32 v33, v74, v75
  v_exp_f32 v76, v76
  v_exp_f32 v77, v77
  v_exp_f32 v78, v78
  v_mfma_f32_16x16x32_bf16 v[236:239], v[132:135], v[120:123], 0
  v_exp_f32 v79, v79
  v_mfma_f32_32x32x8_bf16 v[56:71], v[108:109], v[12:13], v[56:71]
  v_cvt_pk_bf16_f32 v34, v76, v77
  v_cvt_pk_bf16_f32 v35, v78, v79
  v_exp_f32 v80, v80
  v_exp_f32 v81, v81
  v_exp_f32 v82, v82
  v_mfma_f32_16x16x32_bf16 v[240:243], v[136:139], v[120:123], 0
  v_exp_f32 v83, v83
  v_mfma_f32_32x32x16_bf16 v[40:55], v[110:113], v[32:35], v[40:55]
  v_cvt_pk_bf16_f32 v36, v80, v81
  v_cvt_pk_bf16_f32 v37, v82, v83
  v_exp_f32 v84, v84
  v_exp_f32 v85, v85
  v_exp_f32 v86, v86
  v_mfma_f32_16x16x32_bf16 v[244:247], v[128:131], v[124:127], 0
  v_exp_f32 v87, v87
  v_cvt_pk_bf16_f32 v38, v84, v85
  v_cvt_pk_bf16_f32 v39, v86, v87
  s_waitcnt lgkmcnt(0)
  v_mfma_f32_32x32x16_bf16 v[72:87], v[16:19], v[8:11], 0
  ds_read_b128 v[104:107], v2 offset:18944
  ds_read_b128 v[114:117], v6 offset:14208
  v_exp_f32 v56, v56
  v_exp_f32 v57, v57
  v_exp_f32 v58, v58
  v_mfma_f32_16x16x32_bf16 v[248:251], v[132:135], v[124:127], 0
  v_exp_f32 v59, v59
  v_mfma_f32_32x32x16_bf16 v[40:55], v[28:31], v[36:39], v[40:55]
  ds_read_b32 v108, v3 offset:18944
  ds_read_b128 v[110:113], v4 offset:16576
  v_cvt_pk_bf16_f32 v32, v56, v57
  v_cvt_pk_bf16_f32 v33, v58, v59
  v_exp_f32 v60, v60
  v_exp_f32 v61, v61
  v_exp_f32 v62, v62
  v_mfma_f32_16x16x32_bf16 v[252:255], v[136:139], v[124:127], 0
  buffer_load_dwordx4 v[120:123], v220, s[36:39], s80 offen offset:1024
  v_exp_f32 v63, v63
  v_mfma_f32_32x32x8_bf16 v[72:87], v[20:21], v[12:13], v[72:87]
  v_cvt_pk_bf16_f32 v34, v60, v61
  v_cvt_pk_bf16_f32 v35, v62, v63
  v_exp_f32 v64, v64
  v_exp_f32 v65, v65
  v_exp_f32 v66, v66
  s_waitcnt vmcnt(16)
  v_mfma_f32_16x16x32_bf16 v[232:235], v[148:151], v[140:143], v[232:235]
  buffer_load_dwordx4 v[124:127], v220, s[36:39], s81 offen offset:1024
  v_exp_f32 v67, v67
  v_mfma_f32_32x32x16_bf16 v[40:55], v[24:27], v[32:35], v[40:55]
  v_cvt_pk_bf16_f32 v36, v64, v65
  v_cvt_pk_bf16_f32 v37, v66, v67
  v_exp_f32 v68, v68
  v_exp_f32 v69, v69
  v_exp_f32 v70, v70
  v_mfma_f32_16x16x32_bf16 v[236:239], v[152:155], v[140:143], v[236:239]
  buffer_load_dwordx4 v[128:131], v220, s[36:39], s82 offen offset:1024
  v_exp_f32 v71, v71
  v_cvt_pk_bf16_f32 v38, v68, v69
  v_cvt_pk_bf16_f32 v39, v70, v71
  s_waitcnt lgkmcnt(0)
  v_mfma_f32_32x32x16_bf16 v[56:71], v[104:107], v[8:11], 0
  ds_read_b128 v[16:19], v2 offset:21312
  ds_read_b128 v[28:31], v6 offset:16576
  v_exp_f32 v72, v72
  v_exp_f32 v73, v73
  v_exp_f32 v74, v74
  v_mfma_f32_16x16x32_bf16 v[240:243], v[156:159], v[140:143], v[240:243]
  buffer_load_dwordx4 v[132:135], v220, s[36:39], s83 offen offset:1024
  v_exp_f32 v75, v75
  v_mfma_f32_32x32x16_bf16 v[40:55], v[114:117], v[36:39], v[40:55]
  ds_read_b32 v20, v3 offset:21312
  ds_read_b128 v[24:27], v4 offset:18944
  v_cvt_pk_bf16_f32 v32, v72, v73
  v_cvt_pk_bf16_f32 v33, v74, v75
  v_exp_f32 v76, v76
  v_exp_f32 v77, v77
  v_exp_f32 v78, v78
  v_mfma_f32_16x16x32_bf16 v[244:247], v[148:151], v[144:147], v[244:247]
  buffer_load_dwordx4 v[136:139], v220, s[36:39], s84 offen offset:1024
  v_exp_f32 v79, v79
  v_mfma_f32_32x32x8_bf16 v[56:71], v[108:109], v[12:13], v[56:71]
  v_cvt_pk_bf16_f32 v34, v76, v77
  v_cvt_pk_bf16_f32 v35, v78, v79
  v_exp_f32 v80, v80
  v_exp_f32 v81, v81
  v_exp_f32 v82, v82
  v_mfma_f32_16x16x32_bf16 v[248:251], v[152:155], v[144:147], v[248:251]
  v_exp_f32 v83, v83
  v_mfma_f32_32x32x16_bf16 v[40:55], v[110:113], v[32:35], v[40:55]
  v_cvt_pk_bf16_f32 v36, v80, v81
  v_cvt_pk_bf16_f32 v37, v82, v83
  v_exp_f32 v84, v84
  v_exp_f32 v85, v85
  v_exp_f32 v86, v86
  v_mfma_f32_16x16x32_bf16 v[252:255], v[156:159], v[144:147], v[252:255]
  buffer_load_dwordx4 v[140:143], v220, s[36:39], s80 offen offset:2048
  v_exp_f32 v87, v87
  v_cvt_pk_bf16_f32 v38, v84, v85
  v_cvt_pk_bf16_f32 v39, v86, v87
  v_add_u32 v2, 18944, v2
  v_add_u32 v3, 18944, v3
  v_add_u32 v4, 18944, v4
  v_xor_b32 v6, 32, v4
  s_waitcnt lgkmcnt(0)
  v_mfma_f32_32x32x16_bf16 v[72:87], v[16:19], v[8:11], 0
  ds_read_b128 v[104:107], v2 offset:4736
  ds_read_b128 v[114:117], v6 offset:0
  v_exp_f32 v56, v56
  v_exp_f32 v57, v57
  v_exp_f32 v58, v58
  s_waitcnt vmcnt(16)
  v_mfma_f32_16x16x32_bf16 v[232:235], v[168:171], v[160:163], v[232:235]
  buffer_load_dwordx4 v[144:147], v220, s[36:39], s81 offen offset:2048
  v_exp_f32 v59, v59
  v_mfma_f32_32x32x16_bf16 v[40:55], v[28:31], v[36:39], v[40:55]
  ds_read_b32 v108, v3 offset:4736
  ds_read_b128 v[110:113], v4 offset:2368
  v_cvt_pk_bf16_f32 v32, v56, v57
  v_cvt_pk_bf16_f32 v33, v58, v59
  v_exp_f32 v60, v60
  v_exp_f32 v61, v61
  v_exp_f32 v62, v62
  v_mfma_f32_16x16x32_bf16 v[236:239], v[172:175], v[160:163], v[236:239]
  buffer_load_dwordx4 v[148:151], v220, s[36:39], s82 offen offset:2048
  v_exp_f32 v63, v63
  v_mfma_f32_32x32x8_bf16 v[72:87], v[20:21], v[12:13], v[72:87]
  v_cvt_pk_bf16_f32 v34, v60, v61
  v_cvt_pk_bf16_f32 v35, v62, v63
  v_exp_f32 v64, v64
  v_exp_f32 v65, v65
  v_exp_f32 v66, v66
  v_mfma_f32_16x16x32_bf16 v[240:243], v[176:179], v[160:163], v[240:243]
  buffer_load_dwordx4 v[152:155], v220, s[36:39], s83 offen offset:2048
  v_exp_f32 v67, v67
  v_mfma_f32_32x32x16_bf16 v[40:55], v[24:27], v[32:35], v[40:55]
  v_cvt_pk_bf16_f32 v36, v64, v65
  v_cvt_pk_bf16_f32 v37, v66, v67
  v_exp_f32 v68, v68
  v_exp_f32 v69, v69
  v_exp_f32 v70, v70
  v_mfma_f32_16x16x32_bf16 v[244:247], v[168:171], v[164:167], v[244:247]
  buffer_load_dwordx4 v[156:159], v220, s[36:39], s84 offen offset:2048
  v_exp_f32 v71, v71
  v_cvt_pk_bf16_f32 v38, v68, v69
  v_cvt_pk_bf16_f32 v39, v70, v71
  s_waitcnt lgkmcnt(0)
  v_mfma_f32_32x32x16_bf16 v[56:71], v[104:107], v[8:11], 0
  ds_read_b128 v[16:19], v2 offset:7104
  ds_read_b128 v[28:31], v6 offset:2368
  v_exp_f32 v72, v72
  v_exp_f32 v73, v73
  v_exp_f32 v74, v74
  v_mfma_f32_16x16x32_bf16 v[248:251], v[172:175], v[164:167], v[248:251]
  v_exp_f32 v75, v75
  v_mfma_f32_32x32x16_bf16 v[40:55], v[114:117], v[36:39], v[40:55]
  ds_read_b32 v20, v3 offset:7104
  ds_read_b128 v[24:27], v4 offset:4736
  v_cvt_pk_bf16_f32 v32, v72, v73
  v_cvt_pk_bf16_f32 v33, v74, v75
  v_exp_f32 v76, v76
  v_exp_f32 v77, v77
  v_exp_f32 v78, v78
  v_mfma_f32_16x16x32_bf16 v[252:255], v[176:179], v[164:167], v[252:255]
  buffer_load_dwordx4 v[160:163], v220, s[36:39], s80 offen offset:3072
  v_exp_f32 v79, v79
  v_mfma_f32_32x32x8_bf16 v[56:71], v[108:109], v[12:13], v[56:71]
  v_cvt_pk_bf16_f32 v34, v76, v77
  v_cvt_pk_bf16_f32 v35, v78, v79
  v_exp_f32 v80, v80
  v_exp_f32 v81, v81
  v_exp_f32 v82, v82
  s_waitcnt vmcnt(16)
  v_mfma_f32_16x16x32_bf16 v[232:235], v[188:191], v[180:183], v[232:235]
  buffer_load_dwordx4 v[164:167], v220, s[36:39], s81 offen offset:3072
  v_exp_f32 v83, v83
  v_mfma_f32_32x32x16_bf16 v[40:55], v[110:113], v[32:35], v[40:55]
  v_cvt_pk_bf16_f32 v36, v80, v81
  v_cvt_pk_bf16_f32 v37, v82, v83
  v_exp_f32 v84, v84
  v_exp_f32 v85, v85
  v_exp_f32 v86, v86
  v_mfma_f32_16x16x32_bf16 v[236:239], v[192:195], v[180:183], v[236:239]
  buffer_load_dwordx4 v[168:171], v220, s[36:39], s82 offen offset:3072
  v_exp_f32 v87, v87
  v_cvt_pk_bf16_f32 v38, v84, v85
  v_cvt_pk_bf16_f32 v39, v86, v87
  s_waitcnt lgkmcnt(0)
  v_mfma_f32_32x32x16_bf16 v[72:87], v[16:19], v[8:11], 0
  ds_read_b128 v[104:107], v2 offset:9472
  ds_read_b128 v[114:117], v6 offset:4736
  v_exp_f32 v56, v56
  v_exp_f32 v57, v57
  v_exp_f32 v58, v58
  v_mfma_f32_16x16x32_bf16 v[240:243], v[196:199], v[180:183], v[240:243]
  buffer_load_dwordx4 v[172:175], v220, s[36:39], s83 offen offset:3072
  v_exp_f32 v59, v59
  v_mfma_f32_32x32x16_bf16 v[40:55], v[28:31], v[36:39], v[40:55]
  ds_read_b32 v108, v3 offset:9472
  ds_read_b128 v[110:113], v4 offset:7104
  v_cvt_pk_bf16_f32 v32, v56, v57
  v_cvt_pk_bf16_f32 v33, v58, v59
  v_exp_f32 v60, v60
  v_exp_f32 v61, v61
  v_exp_f32 v62, v62
  v_mfma_f32_16x16x32_bf16 v[244:247], v[188:191], v[184:187], v[244:247]
  buffer_load_dwordx4 v[176:179], v220, s[36:39], s84 offen offset:3072
  v_exp_f32 v63, v63
  v_mfma_f32_32x32x8_bf16 v[72:87], v[20:21], v[12:13], v[72:87]
  v_cvt_pk_bf16_f32 v34, v60, v61
  v_cvt_pk_bf16_f32 v35, v62, v63
  v_exp_f32 v64, v64
  v_exp_f32 v65, v65
  v_exp_f32 v66, v66
  v_mfma_f32_16x16x32_bf16 v[248:251], v[192:195], v[184:187], v[248:251]
  v_exp_f32 v67, v67
  v_mfma_f32_32x32x16_bf16 v[40:55], v[24:27], v[32:35], v[40:55]
  v_cvt_pk_bf16_f32 v36, v64, v65
  v_cvt_pk_bf16_f32 v37, v66, v67
  v_exp_f32 v68, v68
  v_exp_f32 v69, v69
  v_exp_f32 v70, v70
  v_mfma_f32_16x16x32_bf16 v[252:255], v[196:199], v[184:187], v[252:255]
  s_add_u32 s80, s80, 4096
  s_add_u32 s81, s81, 4096
  s_add_u32 s82, s82, 4096
  s_add_u32 s83, s83, 4096
  s_add_u32 s84, s84, 4096
  buffer_load_dwordx4 v[180:183], v220, s[36:39], s80 offen offset:0
  v_exp_f32 v71, v71
  v_cvt_pk_bf16_f32 v38, v68, v69
  v_cvt_pk_bf16_f32 v39, v70, v71
  s_waitcnt lgkmcnt(0)
  v_mfma_f32_32x32x16_bf16 v[56:71], v[104:107], v[8:11], 0
  ds_read_b128 v[16:19], v2 offset:11840
  ds_read_b128 v[28:31], v6 offset:7104
  v_exp_f32 v72, v72
  v_exp_f32 v73, v73
  v_exp_f32 v74, v74
  s_waitcnt vmcnt(16)
  v_mfma_f32_16x16x32_bf16 v[232:235], v[208:211], v[200:203], v[232:235]
  buffer_load_dwordx4 v[184:187], v220, s[36:39], s81 offen offset:0
  v_exp_f32 v75, v75
  v_mfma_f32_32x32x16_bf16 v[40:55], v[114:117], v[36:39], v[40:55]
  ds_read_b32 v20, v3 offset:11840
  ds_read_b128 v[24:27], v4 offset:9472
  v_cvt_pk_bf16_f32 v32, v72, v73
  v_cvt_pk_bf16_f32 v33, v74, v75
  v_exp_f32 v76, v76
  v_exp_f32 v77, v77
  v_exp_f32 v78, v78
  v_mfma_f32_16x16x32_bf16 v[236:239], v[212:215], v[200:203], v[236:239]
  buffer_load_dwordx4 v[188:191], v220, s[36:39], s82 offen offset:0
  v_exp_f32 v79, v79
  v_mfma_f32_32x32x8_bf16 v[56:71], v[108:109], v[12:13], v[56:71]
  v_cvt_pk_bf16_f32 v34, v76, v77
  v_cvt_pk_bf16_f32 v35, v78, v79
  v_exp_f32 v80, v80
  v_exp_f32 v81, v81
  v_exp_f32 v82, v82
  v_mfma_f32_16x16x32_bf16 v[240:243], v[216:219], v[200:203], v[240:243]
  buffer_load_dwordx4 v[192:195], v220, s[36:39], s83 offen offset:0
  v_exp_f32 v83, v83
  v_mfma_f32_32x32x16_bf16 v[40:55], v[110:113], v[32:35], v[40:55]
  v_cvt_pk_bf16_f32 v36, v80, v81
  v_cvt_pk_bf16_f32 v37, v82, v83
  v_exp_f32 v84, v84
  v_exp_f32 v85, v85
  v_exp_f32 v86, v86
  v_mfma_f32_16x16x32_bf16 v[244:247], v[208:211], v[204:207], v[244:247]
  buffer_load_dwordx4 v[196:199], v220, s[36:39], s84 offen offset:0
  v_exp_f32 v87, v87
  v_cvt_pk_bf16_f32 v38, v84, v85
  v_cvt_pk_bf16_f32 v39, v86, v87
  s_waitcnt lgkmcnt(0)
  v_mfma_f32_32x32x16_bf16 v[72:87], v[16:19], v[8:11], 0
  ds_read_b128 v[104:107], v2 offset:14208
  ds_read_b128 v[114:117], v6 offset:9472
  v_exp_f32 v56, v56
  v_exp_f32 v57, v57
  v_exp_f32 v58, v58
  v_mfma_f32_16x16x32_bf16 v[248:251], v[212:215], v[204:207], v[248:251]
  v_exp_f32 v59, v59
  v_mfma_f32_32x32x16_bf16 v[40:55], v[28:31], v[36:39], v[40:55]
  ds_read_b32 v108, v3 offset:14208
  ds_read_b128 v[110:113], v4 offset:11840
  v_cvt_pk_bf16_f32 v32, v56, v57
  v_cvt_pk_bf16_f32 v33, v58, v59
  v_exp_f32 v60, v60
  v_exp_f32 v61, v61
  v_exp_f32 v62, v62
  v_mfma_f32_16x16x32_bf16 v[252:255], v[216:219], v[204:207], v[252:255]
  buffer_load_dwordx4 v[200:203], v220, s[36:39], s80 offen offset:1024
  v_exp_f32 v63, v63
  v_mfma_f32_32x32x8_bf16 v[72:87], v[20:21], v[12:13], v[72:87]
  v_cvt_pk_bf16_f32 v34, v60, v61
  v_cvt_pk_bf16_f32 v35, v62, v63
  v_exp_f32 v64, v64
  v_exp_f32 v65, v65
  v_exp_f32 v66, v66
  s_waitcnt vmcnt(16)
  v_mfma_f32_16x16x32_bf16 v[232:235], v[128:131], v[120:123], v[232:235]
  buffer_load_dwordx4 v[204:207], v220, s[36:39], s81 offen offset:1024
  v_exp_f32 v67, v67
  v_mfma_f32_32x32x16_bf16 v[40:55], v[24:27], v[32:35], v[40:55]
  v_cvt_pk_bf16_f32 v36, v64, v65
  v_cvt_pk_bf16_f32 v37, v66, v67
  v_exp_f32 v68, v68
  v_exp_f32 v69, v69
  v_exp_f32 v70, v70
  v_mfma_f32_16x16x32_bf16 v[236:239], v[132:135], v[120:123], v[236:239]
  buffer_load_dwordx4 v[208:211], v220, s[36:39], s82 offen offset:1024
  v_exp_f32 v71, v71
  v_cvt_pk_bf16_f32 v38, v68, v69
  v_cvt_pk_bf16_f32 v39, v70, v71
  s_waitcnt lgkmcnt(0)
  v_mfma_f32_32x32x16_bf16 v[56:71], v[104:107], v[8:11], 0
  ds_read_b128 v[16:19], v2 offset:16576
  ds_read_b128 v[28:31], v6 offset:11840
  v_exp_f32 v72, v72
  v_exp_f32 v73, v73
  v_exp_f32 v74, v74
  v_mfma_f32_16x16x32_bf16 v[240:243], v[136:139], v[120:123], v[240:243]
  buffer_load_dwordx4 v[212:215], v220, s[36:39], s83 offen offset:1024
  v_exp_f32 v75, v75
  v_mfma_f32_32x32x16_bf16 v[40:55], v[114:117], v[36:39], v[40:55]
  ds_read_b32 v20, v3 offset:16576
  ds_read_b128 v[24:27], v4 offset:14208
  v_cvt_pk_bf16_f32 v32, v72, v73
  v_cvt_pk_bf16_f32 v33, v74, v75
  v_exp_f32 v76, v76
  v_exp_f32 v77, v77
  v_exp_f32 v78, v78
  v_mfma_f32_16x16x32_bf16 v[244:247], v[128:131], v[124:127], v[244:247]
  buffer_load_dwordx4 v[216:219], v220, s[36:39], s84 offen offset:1024
  v_exp_f32 v79, v79
  v_mfma_f32_32x32x8_bf16 v[56:71], v[108:109], v[12:13], v[56:71]
  v_cvt_pk_bf16_f32 v34, v76, v77
  v_cvt_pk_bf16_f32 v35, v78, v79
  v_exp_f32 v80, v80
  v_exp_f32 v81, v81
  v_exp_f32 v82, v82
  v_mfma_f32_16x16x32_bf16 v[248:251], v[132:135], v[124:127], v[248:251]
  v_exp_f32 v83, v83
  v_mfma_f32_32x32x16_bf16 v[40:55], v[110:113], v[32:35], v[40:55]
  v_cvt_pk_bf16_f32 v36, v80, v81
  v_cvt_pk_bf16_f32 v37, v82, v83
  v_exp_f32 v84, v84
  v_exp_f32 v85, v85
  v_exp_f32 v86, v86
  v_mfma_f32_16x16x32_bf16 v[252:255], v[136:139], v[124:127], v[252:255]
  buffer_load_dwordx4 v[120:123], v220, s[36:39], s80 offen offset:2048
  v_exp_f32 v87, v87
  v_cvt_pk_bf16_f32 v38, v84, v85
  v_cvt_pk_bf16_f32 v39, v86, v87
  s_waitcnt lgkmcnt(0)
  v_mfma_f32_32x32x16_bf16 v[72:87], v[16:19], v[8:11], 0
  ds_read_b128 v[104:107], v2 offset:18944
  ds_read_b128 v[114:117], v6 offset:14208
  v_exp_f32 v56, v56
  v_exp_f32 v57, v57
  v_exp_f32 v58, v58
  s_waitcnt vmcnt(16)
  v_mfma_f32_16x16x32_bf16 v[232:235], v[148:151], v[140:143], v[232:235]
  buffer_load_dwordx4 v[124:127], v220, s[36:39], s81 offen offset:2048
  v_exp_f32 v59, v59
  v_mfma_f32_32x32x16_bf16 v[40:55], v[28:31], v[36:39], v[40:55]
  ds_read_b32 v108, v3 offset:18944
  ds_read_b128 v[110:113], v4 offset:16576
  v_cvt_pk_bf16_f32 v32, v56, v57
  v_cvt_pk_bf16_f32 v33, v58, v59
  v_exp_f32 v60, v60
  v_exp_f32 v61, v61
  v_exp_f32 v62, v62
  v_mfma_f32_16x16x32_bf16 v[236:239], v[152:155], v[140:143], v[236:239]
  buffer_load_dwordx4 v[128:131], v220, s[36:39], s82 offen offset:2048
  v_exp_f32 v63, v63
  v_mfma_f32_32x32x8_bf16 v[72:87], v[20:21], v[12:13], v[72:87]
  v_cvt_pk_bf16_f32 v34, v60, v61
  v_cvt_pk_bf16_f32 v35, v62, v63
  v_exp_f32 v64, v64
  v_exp_f32 v65, v65
  v_exp_f32 v66, v66
  v_mfma_f32_16x16x32_bf16 v[240:243], v[156:159], v[140:143], v[240:243]
  buffer_load_dwordx4 v[132:135], v220, s[36:39], s83 offen offset:2048
  v_exp_f32 v67, v67
  v_mfma_f32_32x32x16_bf16 v[40:55], v[24:27], v[32:35], v[40:55]
  v_cvt_pk_bf16_f32 v36, v64, v65
  v_cvt_pk_bf16_f32 v37, v66, v67
  v_exp_f32 v68, v68
  v_exp_f32 v69, v69
  v_exp_f32 v70, v70
  v_mfma_f32_16x16x32_bf16 v[244:247], v[148:151], v[144:147], v[244:247]
  buffer_load_dwordx4 v[136:139], v220, s[36:39], s84 offen offset:2048
  v_exp_f32 v71, v71
  v_cvt_pk_bf16_f32 v38, v68, v69
  v_cvt_pk_bf16_f32 v39, v70, v71
  s_waitcnt lgkmcnt(0)
  v_mfma_f32_32x32x16_bf16 v[56:71], v[104:107], v[8:11], 0
  ds_read_b128 v[16:19], v2 offset:21312
  ds_read_b128 v[28:31], v6 offset:16576
  v_exp_f32 v72, v72
  v_exp_f32 v73, v73
  v_exp_f32 v74, v74
  v_mfma_f32_16x16x32_bf16 v[248:251], v[152:155], v[144:147], v[248:251]
  v_exp_f32 v75, v75
  v_mfma_f32_32x32x16_bf16 v[40:55], v[114:117], v[36:39], v[40:55]
  ds_read_b32 v20, v3 offset:21312
  ds_read_b128 v[24:27], v4 offset:18944
  v_cvt_pk_bf16_f32 v32, v72, v73
  v_cvt_pk_bf16_f32 v33, v74, v75
  v_exp_f32 v76, v76
  v_exp_f32 v77, v77
  v_exp_f32 v78, v78
  v_mfma_f32_16x16x32_bf16 v[252:255], v[156:159], v[144:147], v[252:255]
  buffer_load_dwordx4 v[140:143], v220, s[36:39], s80 offen offset:3072
  v_exp_f32 v79, v79
  v_mfma_f32_32x32x8_bf16 v[56:71], v[108:109], v[12:13], v[56:71]
  v_cvt_pk_bf16_f32 v34, v76, v77
  v_cvt_pk_bf16_f32 v35, v78, v79
  v_exp_f32 v80, v80
  v_exp_f32 v81, v81
  v_exp_f32 v82, v82
  s_waitcnt vmcnt(16)
  v_mfma_f32_16x16x32_bf16 v[232:235], v[168:171], v[160:163], v[232:235]
  buffer_load_dwordx4 v[144:147], v220, s[36:39], s81 offen offset:3072
  v_exp_f32 v83, v83
  v_mfma_f32_32x32x16_bf16 v[40:55], v[110:113], v[32:35], v[40:55]
  v_cvt_pk_bf16_f32 v36, v80, v81
  v_cvt_pk_bf16_f32 v37, v82, v83
  v_exp_f32 v84, v84
  v_exp_f32 v85, v85
  v_exp_f32 v86, v86
  v_mfma_f32_16x16x32_bf16 v[236:239], v[172:175], v[160:163], v[236:239]
  buffer_load_dwordx4 v[148:151], v220, s[36:39], s82 offen offset:3072
  v_exp_f32 v87, v87
  v_cvt_pk_bf16_f32 v38, v84, v85
  v_cvt_pk_bf16_f32 v39, v86, v87
  v_add_u32 v2, 18944, v2
  v_add_u32 v3, 18944, v3
  v_add_u32 v4, 18944, v4
  v_xor_b32 v6, 32, v4
  s_branch k2_attn_kernel_fpv
k2_attn_kernel_last:
  s_waitcnt lgkmcnt(0)
  v_mfma_f32_32x32x16_bf16 v[72:87], v[16:19], v[8:11], 0
  ds_read_b128 v[104:107], v2 offset:4736
  ds_read_b128 v[114:117], v6 offset:0
  v_exp_f32 v56, v56
  v_exp_f32 v57, v57
  v_exp_f32 v58, v58
  v_exp_f32 v59, v59
  v_mfma_f32_32x32x16_bf16 v[40:55], v[28:31], v[36:39], v[40:55]
  ds_read_b32 v108, v3 offset:4736
  ds_read_b128 v[110:113], v4 offset:2368
  v_cvt_pk_bf16_f32 v32, v56, v57
  v_cvt_pk_bf16_f32 v33, v58, v59
  v_exp_f32 v60, v60
  v_exp_f32 v61, v61
  v_exp_f32 v62, v62
  v_exp_f32 v63, v63
  v_mfma_f32_32x32x8_bf16 v[72:87], v[20:21], v[12:13], v[72:87]
  v_cvt_pk_bf16_f32 v34, v60, v61
  v_cvt_pk_bf16_f32 v35, v62, v63
  v_exp_f32 v64, v64
  v_exp_f32 v65, v65
  v_exp_f32 v66, v66
  v_exp_f32 v67, v67
  v_mfma_f32_32x32x16_bf16 v[40:55], v[24:27], v[32:35], v[40:55]
  v_cvt_pk_bf16_f32 v36, v64, v65
  v_cvt_pk_bf16_f32 v37, v66, v67
  v_exp_f32 v68, v68
  v_exp_f32 v69, v69
  v_exp_f32 v70, v70
  v_exp_f32 v71, v71
  v_cvt_pk_bf16_f32 v38, v68, v69
  v_cvt_pk_bf16_f32 v39, v70, v71
  s_waitcnt lgkmcnt(0)
  v_mfma_f32_32x32x16_bf16 v[56:71], v[104:107], v[8:11], 0
  ds_read_b128 v[16:19], v2 offset:7104
  ds_read_b128 v[28:31], v6 offset:2368
  v_exp_f32 v72, v72
  v_exp_f32 v73, v73
  v_exp_f32 v74, v74
  v_exp_f32 v75, v75
  v_mfma_f32_32x32x16_bf16 v[40:55], v[114:117], v[36:39], v[40:55]
  ds_read_b32 v20, v3 offset:7104
  ds_read_b128 v[24:27], v4 offset:4736
  v_cvt_pk_bf16_f32 v32, v72, v73
  v_cvt_pk_bf16_f32 v33, v74, v75
  v_exp_f32 v76, v76
  v_exp_f32 v77, v77
  v_exp_f32 v78, v78
  v_exp_f32 v79, v79
  v_mfma_f32_32x32x8_bf16 v[56:71], v[108:109], v[12:13], v[56:71]
  v_cvt_pk_bf16_f32 v34, v76, v77
  v_cvt_pk_bf16_f32 v35, v78, v79
  v_exp_f32 v80, v80
  v_exp_f32 v81, v81
  v_exp_f32 v82, v82
  v_exp_f32 v83, v83
  v_mfma_f32_32x32x16_bf16 v[40:55], v[110:113], v[32:35], v[40:55]
  v_cvt_pk_bf16_f32 v36, v80, v81
  v_cvt_pk_bf16_f32 v37, v82, v83
  v_exp_f32 v84, v84
  v_exp_f32 v85, v85
  v_exp_f32 v86, v86
  v_exp_f32 v87, v87
  v_cvt_pk_bf16_f32 v38, v84, v85
  v_cvt_pk_bf16_f32 v39, v86, v87
  s_waitcnt lgkmcnt(0)
  v_mfma_f32_32x32x16_bf16 v[72:87], v[16:19], v[8:11], 0
  ds_read_b128 v[104:107], v2 offset:9472
  ds_read_b128 v[114:117], v6 offset:4736
  v_exp_f32 v56, v56
  v_exp_f32 v57, v57
  v_exp_f32 v58, v58
  v_exp_f32 v59, v59
  v_mfma_f32_32x32x16_bf16 v[40:55], v[28:31], v[36:39], v[40:55]
  ds_read_b32 v108, v3 offset:9472
  ds_read_b128 v[110:113], v4 offset:7104
  v_cvt_pk_bf16_f32 v32, v56, v57
  v_cvt_pk_bf16_f32 v33, v58, v59
  v_exp_f32 v60, v60
  v_exp_f32 v61, v61
  v_exp_f32 v62, v62
  v_exp_f32 v63, v63
  v_mfma_f32_32x32x8_bf16 v[72:87], v[20:21], v[12:13], v[72:87]
  v_cvt_pk_bf16_f32 v34, v60, v61
  v_cvt_pk_bf16_f32 v35, v62, v63
  v_exp_f32 v64, v64
  v_exp_f32 v65, v65
  v_exp_f32 v66, v66
  v_exp_f32 v67, v67
  v_mfma_f32_32x32x16_bf16 v[40:55], v[24:27], v[32:35], v[40:55]
  v_cvt_pk_bf16_f32 v36, v64, v65
  v_cvt_pk_bf16_f32 v37, v66, v67
  v_exp_f32 v68, v68
  v_exp_f32 v69, v69
  v_exp_f32 v70, v70
  v_exp_f32 v71, v71
  v_cvt_pk_bf16_f32 v38, v68, v69
  v_cvt_pk_bf16_f32 v39, v70, v71
  s_waitcnt lgkmcnt(0)
  v_mfma_f32_32x32x16_bf16 v[56:71], v[104:107], v[8:11], 0
  ds_read_b128 v[16:19], v2 offset:11840
  ds_read_b128 v[28:31], v6 offset:7104
  v_exp_f32 v72, v72
  v_exp_f32 v73, v73
  v_exp_f32 v74, v74
  v_exp_f32 v75, v75
  v_mfma_f32_32x32x16_bf16 v[40:55], v[114:117], v[36:39], v[40:55]
  ds_read_b32 v20, v3 offset:11840
  ds_read_b128 v[24:27], v4 offset:9472
  v_cvt_pk_bf16_f32 v32, v72, v73
  v_cvt_pk_bf16_f32 v33, v74, v75
  v_exp_f32 v76, v76
  v_exp_f32 v77, v77
  v_exp_f32 v78, v78
  v_exp_f32 v79, v79
  v_mfma_f32_32x32x8_bf16 v[56:71], v[108:109], v[12:13], v[56:71]
  v_cvt_pk_bf16_f32 v34, v76, v77
  v_cvt_pk_bf16_f32 v35, v78, v79
  v_exp_f32 v80, v80
  v_exp_f32 v81, v81
  v_exp_f32 v82, v82
  v_exp_f32 v83, v83
  v_mfma_f32_32x32x16_bf16 v[40:55], v[110:113], v[32:35], v[40:55]
  v_cvt_pk_bf16_f32 v36, v80, v81
  v_cvt_pk_bf16_f32 v37, v82, v83
  v_exp_f32 v84, v84
  v_exp_f32 v85, v85
  v_exp_f32 v86, v86
  v_exp_f32 v87, v87
  v_cvt_pk_bf16_f32 v38, v84, v85
  v_cvt_pk_bf16_f32 v39, v86, v87
  s_waitcnt lgkmcnt(0)
  v_mfma_f32_32x32x16_bf16 v[72:87], v[16:19], v[8:11], 0
  ds_read_b128 v[104:107], v2 offset:14208
  ds_read_b128 v[114:117], v6 offset:9472
  v_exp_f32 v56, v56
  v_exp_f32 v57, v57
  v_exp_f32 v58, v58
  v_exp_f32 v59, v59
  v_mfma_f32_32x32x16_bf16 v[40:55], v[28:31], v[36:39], v[40:55]
  ds_read_b32 v108, v3 offset:14208
  ds_read_b128 v[110:113], v4 offset:11840
  v_cvt_pk_bf16_f32 v32, v56, v57
  v_cvt_pk_bf16_f32 v33, v58, v59
  v_exp_f32 v60, v60
  v_exp_f32 v61, v61
  v_exp_f32 v62, v62
  v_exp_f32 v63, v63
  v_mfma_f32_32x32x8_bf16 v[72:87], v[20:21], v[12:13], v[72:87]
  v_cvt_pk_bf16_f32 v34, v60, v61
  v_cvt_pk_bf16_f32 v35, v62, v63
  v_exp_f32 v64, v64
  v_exp_f32 v65, v65
  v_exp_f32 v66, v66
  v_exp_f32 v67, v67
  v_mfma_f32_32x32x16_bf16 v[40:55], v[24:27], v[32:35], v[40:55]
  v_cvt_pk_bf16_f32 v36, v64, v65
  v_cvt_pk_bf16_f32 v37, v66, v67
  v_exp_f32 v68, v68
  v_exp_f32 v69, v69
  v_exp_f32 v70, v70
  v_exp_f32 v71, v71
  v_cvt_pk_bf16_f32 v38, v68, v69
  v_cvt_pk_bf16_f32 v39, v70, v71
  s_waitcnt lgkmcnt(0)
  v_mfma_f32_32x32x16_bf16 v[56:71], v[104:107], v[8:11], 0
  ds_read_b128 v[16:19], v2 offset:16576
  ds_read_b128 v[28:31], v6 offset:11840
  v_exp_f32 v72, v72
  v_exp_f32 v73, v73
  v_exp_f32 v74, v74
  v_exp_f32 v75, v75
  v_mfma_f32_32x32x16_bf16 v[40:55], v[114:117], v[36:39], v[40:55]
  ds_read_b32 v20, v3 offset:16576
  ds_read_b128 v[24:27], v4 offset:14208
  v_cvt_pk_bf16_f32 v32, v72, v73
  v_cvt_pk_bf16_f32 v33, v74, v75
  v_exp_f32 v76, v76
  v_exp_f32 v77, v77
  v_exp_f32 v78, v78
  v_exp_f32 v79, v79
  v_mfma_f32_32x32x8_bf16 v[56:71], v[108:109], v[12:13], v[56:71]
  v_cvt_pk_bf16_f32 v34, v76, v77
  v_cvt_pk_bf16_f32 v35, v78, v79
  v_exp_f32 v80, v80
  v_exp_f32 v81, v81
  v_exp_f32 v82, v82
  v_exp_f32 v83, v83
  v_mfma_f32_32x32x16_bf16 v[40:55], v[110:113], v[32:35], v[40:55]
  v_cvt_pk_bf16_f32 v36, v80, v81
  v_cvt_pk_bf16_f32 v37, v82, v83
  v_exp_f32 v84, v84
  v_exp_f32 v85, v85
  v_exp_f32 v86, v86
  v_exp_f32 v87, v87
  v_cvt_pk_bf16_f32 v38, v84, v85
  v_cvt_pk_bf16_f32 v39, v86, v87
  s_waitcnt lgkmcnt(0)
  v_mfma_f32_32x32x16_bf16 v[72:87], v[16:19], v[8:11], 0
  ds_read_b128 v[104:107], v2 offset:18944
  ds_read_b128 v[114:117], v6 offset:14208
  v_exp_f32 v56, v56
  v_exp_f32 v57, v57
  v_exp_f32 v58, v58
  v_exp_f32 v59, v59
  v_mfma_f32_32x32x16_bf16 v[40:55], v[28:31], v[36:39], v[40:55]
  ds_read_b32 v108, v3 offset:18944
  ds_read_b128 v[110:113], v4 offset:16576
  v_cvt_pk_bf16_f32 v32, v56, v57
  v_cvt_pk_bf16_f32 v33, v58, v59
  v_exp_f32 v60, v60
  v_exp_f32 v61, v61
  v_exp_f32 v62, v62
  v_exp_f32 v63, v63
  v_mfma_f32_32x32x8_bf16 v[72:87], v[20:21], v[12:13], v[72:87]
  v_cvt_pk_bf16_f32 v34, v60, v61
  v_cvt_pk_bf16_f32 v35, v62, v63
  v_exp_f32 v64, v64
  v_exp_f32 v65, v65
  v_exp_f32 v66, v66
  v_exp_f32 v67, v67
  v_mfma_f32_32x32x16_bf16 v[40:55], v[24:27], v[32:35], v[40:55]
  v_cvt_pk_bf16_f32 v36, v64, v65
  v_cvt_pk_bf16_f32 v37, v66, v67
  v_exp_f32 v68, v68
  v_exp_f32 v69, v69
  v_exp_f32 v70, v70
  v_exp_f32 v71, v71
  v_cvt_pk_bf16_f32 v38, v68, v69
  v_cvt_pk_bf16_f32 v39, v70, v71
  s_waitcnt lgkmcnt(0)
  v_mfma_f32_32x32x16_bf16 v[56:71], v[104:107], v[8:11], 0
  ds_read_b128 v[16:19], v2 offset:21312
  ds_read_b128 v[28:31], v6 offset:16576
  v_exp_f32 v72, v72
  v_exp_f32 v73, v73
  v_exp_f32 v74, v74
  v_exp_f32 v75, v75
  v_mfma_f32_32x32x16_bf16 v[40:55], v[114:117], v[36:39], v[40:55]
  ds_read_b32 v20, v3 offset:21312
  ds_read_b128 v[24:27], v4 offset:18944
  v_cvt_pk_bf16_f32 v32, v72, v73
  v_cvt_pk_bf16_f32 v33, v74, v75
  v_exp_f32 v76, v76
  v_exp_f32 v77, v77
  v_exp_f32 v78, v78
  v_exp_f32 v79, v79
  v_mfma_f32_32x32x8_bf16 v[56:71], v[108:109], v[12:13], v[56:71]
  v_cvt_pk_bf16_f32 v34, v76, v77
  v_cvt_pk_bf16_f32 v35, v78, v79
  v_exp_f32 v80, v80
  v_exp_f32 v81, v81
  v_exp_f32 v82, v82
  v_exp_f32 v83, v83
  v_mfma_f32_32x32x16_bf16 v[40:55], v[110:113], v[32:35], v[40:55]
  v_cvt_pk_bf16_f32 v36, v80, v81
  v_cvt_pk_bf16_f32 v37, v82, v83
  v_exp_f32 v84, v84
  v_exp_f32 v85, v85
  v_exp_f32 v86, v86
  v_exp_f32 v87, v87
  v_cvt_pk_bf16_f32 v38, v84, v85
  v_cvt_pk_bf16_f32 v39, v86, v87
  v_add_u32 v2, 18944, v2
  v_add_u32 v3, 18944, v3
  v_add_u32 v4, 18944, v4
  v_xor_b32 v6, 32, v4
k2_attn_kernel_fpv:
  s_waitcnt lgkmcnt(0)
  v_mfma_f32_32x32x16_bf16 v[40:55], v[28:31], v[36:39], v[40:55]
  s_nop 11
k2_attn_kernel_check:
  v_mov_b32 v88, v50
  v_mov_b32 v89, v50
  v_mul_f32 v90, 0, v40
  v_fma_f32 v90, v41, 0, v90
  v_permlane32_swap_b32 v88, v89
  v_fma_f32 v90, v42, 0, v90
  v_fma_f32 v90, v43, 0, v90
  v_fma_f32 v90, v44, 0, v90
  v_fma_f32 v90, v45, 0, v90
  v_fma_f32 v90, v46, 0, v90
  v_fma_f32 v90, v47, 0, v90
  v_fma_f32 v90, v48, 0, v90
  v_fma_f32 v90, v49, 0, v90
  v_add_f32 v90, v90, v88
  v_mov_b32 v91, 0x5f800000
  v_cmp_nlt_f32 vcc, v90, v91
  s_nop 4
  s_cbranch_vccnz k2_attn_kernel_slow
k2_attn_kernel_fin:
  v_rcp_f32 v88, v88
  v_bfe_u32 v5, v1, 4, 1
  v_lshlrev_b32 v5, 14, v5
  v_lshrrev_b32 v7, 5, v1
  v_lshl_add_u32 v5, v7, 8, v5
  v_and_b32 v7, 15, v1
  v_lshl_add_u32 v5, v7, 4, v5
  v_pk_mul_f32 v[40:41], v[40:41], v[88:89] op_sel_hi:[1,0]
  v_pk_mul_f32 v[42:43], v[42:43], v[88:89] op_sel_hi:[1,0]
  v_pk_mul_f32 v[44:45], v[44:45], v[88:89] op_sel_hi:[1,0]
  v_pk_mul_f32 v[46:47], v[46:47], v[88:89] op_sel_hi:[1,0]
  v_pk_mul_f32 v[48:49], v[48:49], v[88:89] op_sel_hi:[1,0]
  v_cvt_pk_bf16_f32 v32, v40, v41
  v_cvt_pk_bf16_f32 v33, v42, v43
  v_cvt_pk_bf16_f32 v34, v44, v45
  v_cvt_pk_bf16_f32 v35, v46, v47
  v_cvt_pk_bf16_f32 v36, v48, v49
  v_min_u32 v32, -2, v32
  v_min_u32 v33, -2, v33
  v_min_u32 v34, -2, v34
  v_min_u32 v35, -2, v35
  v_min_u32 v36, -2, v36
  s_lshl_b32 s6, s7, 15
  s_lshl_b32 s30, s3, 9
  s_add_u32 s6, s6, s30
  s_add_u32 s6, s6, 16777216
  s_lshl_b32 s31, s7, 12
  s_lshl_b32 s30, s3, 7
  s_add_u32 s31, s31, s30
  s_add_u32 s31, s31, 18872128
  buffer_store_dwordx4 v[32:35], v5, s[36:39], s6 offen sc1
  v_cmp_gt_u32 vcc, 32, v1
  s_and_saveexec_b64 s[32:33], vcc
  buffer_store_dword v36, v103, s[36:39], s31 offen sc1
  s_mov_b64 exec, s[32:33]
  s_cmp_eq_u32 s66, 4
  s_cbranch_scc0 k2_attn_kernel_tail
  v_mfma_f32_16x16x32_bf16 v[240:243], v[176:179], v[160:163], v[240:243]
  buffer_load_dwordx4 v[152:155], v220, s[36:39], s83 offen offset:3072
  v_mfma_f32_16x16x32_bf16 v[244:247], v[168:171], v[164:167], v[244:247]
  buffer_load_dwordx4 v[156:159], v220, s[36:39], s84 offen offset:3072
  v_mfma_f32_16x16x32_bf16 v[248:251], v[172:175], v[164:167], v[248:251]
  v_mfma_f32_16x16x32_bf16 v[252:255], v[176:179], v[164:167], v[252:255]
  s_add_u32 s80, s80, 4096
  s_add_u32 s81, s81, 4096
  s_add_u32 s82, s82, 4096
  s_add_u32 s83, s83, 4096
  s_add_u32 s84, s84, 4096
  buffer_load_dwordx4 v[160:163], v220, s[36:39], s80 offen offset:0
  s_waitcnt vmcnt(16)
  v_mfma_f32_16x16x32_bf16 v[232:235], v[188:191], v[180:183], v[232:235]
  buffer_load_dwordx4 v[164:167], v220, s[36:39], s81 offen offset:0
  v_mfma_f32_16x16x32_bf16 v[236:239], v[192:195], v[180:183], v[236:239]
  buffer_load_dwordx4 v[168:171], v220, s[36:39], s82 offen offset:0
  v_mfma_f32_16x16x32_bf16 v[240:243], v[196:199], v[180:183], v[240:243]
  buffer_load_dwordx4 v[172:175], v220, s[36:39], s83 offen offset:0
  v_mfma_f32_16x16x32_bf16 v[244:247], v[188:191], v[184:187], v[244:247]
  buffer_load_dwordx4 v[176:179], v220, s[36:39], s84 offen offset:0
  v_mfma_f32_16x16x32_bf16 v[248:251], v[192:195], v[184:187], v[248:251]
  v_mfma_f32_16x16x32_bf16 v[252:255], v[196:199], v[184:187], v[252:255]
  buffer_load_dwordx4 v[180:183], v220, s[36:39], s80 offen offset:1024
  s_waitcnt vmcnt(16)
  v_mfma_f32_16x16x32_bf16 v[232:235], v[208:211], v[200:203], v[232:235]
  buffer_load_dwordx4 v[184:187], v220, s[36:39], s81 offen offset:1024
  v_mfma_f32_16x16x32_bf16 v[236:239], v[212:215], v[200:203], v[236:239]
  buffer_load_dwordx4 v[188:191], v220, s[36:39], s82 offen offset:1024
  v_mfma_f32_16x16x32_bf16 v[240:243], v[216:219], v[200:203], v[240:243]
  buffer_load_dwordx4 v[192:195], v220, s[36:39], s83 offen offset:1024
  v_mfma_f32_16x16x32_bf16 v[244:247], v[208:211], v[204:207], v[244:247]
  buffer_load_dwordx4 v[196:199], v220, s[36:39], s84 offen offset:1024
  v_mfma_f32_16x16x32_bf16 v[248:251], v[212:215], v[204:207], v[248:251]
  v_mfma_f32_16x16x32_bf16 v[252:255], v[216:219], v[204:207], v[252:255]
  buffer_load_dwordx4 v[200:203], v220, s[36:39], s80 offen offset:2048
  s_waitcnt vmcnt(16)
  v_mfma_f32_16x16x32_bf16 v[232:235], v[128:131], v[120:123], v[232:235]
  buffer_load_dwordx4 v[204:207], v220, s[36:39], s81 offen offset:2048
  v_mfma_f32_16x16x32_bf16 v[236:239], v[132:135], v[120:123], v[236:239]
  buffer_load_dwordx4 v[208:211], v220, s[36:39], s82 offen offset:2048
  v_mfma_f32_16x16x32_bf16 v[240:243], v[136:139], v[120:123], v[240:243]
  buffer_load_dwordx4 v[212:215], v220, s[36:39], s83 offen offset:2048
  v_mfma_f32_16x16x32_bf16 v[244:247], v[128:131], v[124:127], v[244:247]
  buffer_load_dwordx4 v[216:219], v220, s[36:39], s84 offen offset:2048
  v_mfma_f32_16x16x32_bf16 v[248:251], v[132:135], v[124:127], v[248:251]
  v_mfma_f32_16x16x32_bf16 v[252:255], v[136:139], v[124:127], v[252:255]
  buffer_load_dwordx4 v[120:123], v220, s[36:39], s80 offen offset:3072
  s_waitcnt vmcnt(16)
  v_mfma_f32_16x16x32_bf16 v[232:235], v[148:151], v[140:143], v[232:235]
  buffer_load_dwordx4 v[124:127], v220, s[36:39], s81 offen offset:3072
  v_mfma_f32_16x16x32_bf16 v[236:239], v[152:155], v[140:143], v[236:239]
  buffer_load_dwordx4 v[128:131], v220, s[36:39], s82 offen offset:3072
  v_mfma_f32_16x16x32_bf16 v[240:243], v[156:159], v[140:143], v[240:243]
  buffer_load_dwordx4 v[132:135], v220, s[36:39], s83 offen offset:3072
  v_mfma_f32_16x16x32_bf16 v[244:247], v[148:151], v[144:147], v[244:247]
  buffer_load_dwordx4 v[136:139], v220, s[36:39], s84 offen offset:3072
  v_mfma_f32_16x16x32_bf16 v[248:251], v[152:155], v[144:147], v[248:251]
  v_mfma_f32_16x16x32_bf16 v[252:255], v[156:159], v[144:147], v[252:255]
  s_add_u32 s80, s80, 4096
  s_add_u32 s81, s81, 4096
  s_add_u32 s82, s82, 4096
  s_add_u32 s83, s83, 4096
  s_add_u32 s84, s84, 4096
  buffer_load_dword v140, v223, s[36:39], s67 offen offset:0
  buffer_load_dword v141, v223, s[36:39], s67 offen offset:128
  s_waitcnt vmcnt(17)
  v_mfma_f32_16x16x32_bf16 v[232:235], v[168:171], v[160:163], v[232:235]
  buffer_load_dword v142, v223, s[36:39], s67 offen offset:256
  buffer_load_dword v143, v223, s[36:39], s67 offen offset:384
  v_mfma_f32_16x16x32_bf16 v[236:239], v[172:175], v[160:163], v[236:239]
  buffer_load_dword v144, v223, s[36:39], s67 offen offset:64
  buffer_load_dword v145, v223, s[36:39], s67 offen offset:192
  v_mfma_f32_16x16x32_bf16 v[240:243], v[176:179], v[160:163], v[240:243]
  buffer_load_dword v146, v223, s[36:39], s67 offen offset:320
  buffer_load_dword v147, v223, s[36:39], s67 offen offset:448
  v_mfma_f32_16x16x32_bf16 v[244:247], v[168:171], v[164:167], v[244:247]
  buffer_load_dwordx4 v[148:151], v220, s[36:39], s82 offen offset:0
  buffer_load_dwordx4 v[152:155], v220, s[36:39], s83 offen offset:0
  v_mfma_f32_16x16x32_bf16 v[248:251], v[172:175], v[164:167], v[248:251]
  buffer_load_dwordx4 v[156:159], v220, s[36:39], s84 offen offset:0
  v_mfma_f32_16x16x32_bf16 v[252:255], v[176:179], v[164:167], v[252:255]
  buffer_load_dword v160, v223, s[36:39], s67 offen offset:2048
  buffer_load_dword v161, v223, s[36:39], s67 offen offset:2176
  s_waitcnt vmcnt(23)
  v_mfma_f32_16x16x32_bf16 v[232:235], v[188:191], v[180:183], v[232:235]
  buffer_load_dword v162, v223, s[36:39], s67 offen offset:2304
  buffer_load_dword v163, v223, s[36:39], s67 offen offset:2432
  v_mfma_f32_16x16x32_bf16 v[236:239], v[192:195], v[180:183], v[236:239]
  buffer_load_dword v164, v223, s[36:39], s67 offen offset:2112
  buffer_load_dword v165, v223, s[36:39], s67 offen offset:2240
  v_mfma_f32_16x16x32_bf16 v[240:243], v[196:199], v[180:183], v[240:243]
  buffer_load_dword v166, v223, s[36:39], s67 offen offset:2368
  buffer_load_dword v167, v223, s[36:39], s67 offen offset:2496
  v_mfma_f32_16x16x32_bf16 v[244:247], v[188:191], v[184:187], v[244:247]
  buffer_load_dwordx4 v[168:171], v220, s[36:39], s82 offen offset:1024
  buffer_load_dwordx4 v[172:175], v220, s[36:39], s83 offen offset:1024
  v_mfma_f32_16x16x32_bf16 v[248:251], v[192:195], v[184:187], v[248:251]
  buffer_load_dwordx4 v[176:179], v220, s[36:39], s84 offen offset:1024
  v_mfma_f32_16x16x32_bf16 v[252:255], v[196:199], v[184:187], v[252:255]
  s_waitcnt vmcnt(27)
  v_mfma_f32_16x16x32_bf16 v[232:235], v[208:211], v[200:203], v[232:235]
  v_mfma_f32_16x16x32_bf16 v[236:239], v[212:215], v[200:203], v[236:239]
  v_mfma_f32_16x16x32_bf16 v[240:243], v[216:219], v[200:203], v[240:243]
  v_mfma_f32_16x16x32_bf16 v[244:247], v[208:211], v[204:207], v[244:247]
  v_mfma_f32_16x16x32_bf16 v[248:251], v[212:215], v[204:207], v[248:251]
  v_mfma_f32_16x16x32_bf16 v[252:255], v[216:219], v[204:207], v[252:255]
  s_waitcnt vmcnt(22)
  v_mfma_f32_16x16x32_bf16 v[232:235], v[128:131], v[120:123], v[232:235]
  v_mfma_f32_16x16x32_bf16 v[236:239], v[132:135], v[120:123], v[236:239]
  v_mfma_f32_16x16x32_bf16 v[240:243], v[136:139], v[120:123], v[240:243]
  v_mfma_f32_16x16x32_bf16 v[244:247], v[128:131], v[124:127], v[244:247]
  v_mfma_f32_16x16x32_bf16 v[248:251], v[132:135], v[124:127], v[248:251]
  v_mfma_f32_16x16x32_bf16 v[252:255], v[136:139], v[124:127], v[252:255]
  s_waitcnt vmcnt(11)
  v_mfma_f32_16x16x32_bf16 v[232:235], v[148:151], v[140:143], v[232:235]
  v_mfma_f32_16x16x32_bf16 v[236:239], v[152:155], v[140:143], v[236:239]
  v_mfma_f32_16x16x32_bf16 v[240:243], v[156:159], v[140:143], v[240:243]
  v_mfma_f32_16x16x32_bf16 v[244:247], v[148:151], v[144:147], v[244:247]
  v_mfma_f32_16x16x32_bf16 v[248:251], v[152:155], v[144:147], v[248:251]
  v_mfma_f32_16x16x32_bf16 v[252:255], v[156:159], v[144:147], v[252:255]
  s_waitcnt vmcnt(0)
  v_mfma_f32_16x16x32_bf16 v[232:235], v[168:171], v[160:163], v[232:235]
  v_mfma_f32_16x16x32_bf16 v[236:239], v[172:175], v[160:163], v[236:239]
  v_mfma_f32_16x16x32_bf16 v[240:243], v[176:179], v[160:163], v[240:243]
  v_mfma_f32_16x16x32_bf16 v[244:247], v[168:171], v[164:167], v[244:247]
  v_mfma_f32_16x16x32_bf16 v[248:251], v[172:175], v[164:167], v[248:251]
  v_mfma_f32_16x16x32_bf16 v[252:255], v[176:179], v[164:167], v[252:255]
  s_nop 7
  s_mul_i32 s6, s98, 1536
  s_add_u32 s6, s6, 151552
  v_add_u32 v221, s6, v221
  s_nop 3
  v_cvt_pk_bf16_f32 v120, v232, v233
  v_cvt_pk_bf16_f32 v121, v234, v235
  ds_write_b64 v221, v[120:121] offset:0
  v_cvt_pk_bf16_f32 v122, v236, v237
  v_cvt_pk_bf16_f32 v123, v238, v239
  ds_write_b64 v221, v[122:123] offset:512
  v_cvt_pk_bf16_f32 v124, v240, v241
  v_cvt_pk_bf16_f32 v125, v242, v243
  ds_write_b64 v221, v[124:125] offset:1024
  v_cvt_pk_bf16_f32 v126, v244, v245
  v_cvt_pk_bf16_f32 v127, v246, v247
  ds_write_b64 v221, v[126:127] offset:4608
  v_cvt_pk_bf16_f32 v128, v248, v249
  v_cvt_pk_bf16_f32 v129, v250, v251
  ds_write_b64 v221, v[128:129] offset:5120
  v_cvt_pk_bf16_f32 v130, v252, v253
  v_cvt_pk_bf16_f32 v131, v254, v255
  ds_write_b64 v221, v[130:131] offset:5632
k2_attn_kernel_tail:
  s_and_b32 s74, s2, 7
  s_lshl_b32 s74, s74, 3
  s_lshr_b32 s6, s2, 5
  s_add_u32 s74, s74, s6
  s_lshr_b32 s75, s2, 3
  s_and_b32 s75, s75, 3
  v_lshlrev_b32 v8, 4, v1
  v_and_b32 v56, 15, v1
  v_lshrrev_b32 v57, 4, v1
  v_lshlrev_b32 v14, 9, v57
  v_lshl_add_u32 v14, v56, 2, v14
  v_lshlrev_b32 v15, 3, v1
  v_add_u32 v15, 151552, v15
  s_lshl_b32 s6, s74, 5
  v_add_u32 v56, s6, v56
  v_mul_u32_u24 v13, 1152, v56
  v_lshl_add_u32 v13, v57, 3, v13
  v_lshlrev_b32 v56, 2, v56
  s_cmp_ge_u32 s5, 4
  s_cbranch_scc1 k2_attn_kernel_tnow
  s_mov_b32 s30, 23068672
  buffer_load_dword v9, v56, s[36:39], s30 offen
  buffer_load_dword v10, v56, s[36:39], s30 offen offset:64
  s_lshl_b32 s72, s5, 1
  s_min_u32 s72, s72, 8
  s_mul_i32 s6, s75, 9
  s_add_u32 s6, s6, s72
  s_mul_i32 s31, s75, 288
  s_and_b32 s30, s75, 1
  s_lshl_b32 s30, s30, 5
  s_add_u32 s31, s31, s30
  s_lshl_b32 s30, s5, 6
  s_add_u32 s31, s31, s30
  v_lshrrev_b32 v63, 4, v1
  v_lshl_add_u32 v13, v63, 3, v13
  v_add_u32 v13, s31, v13
  s_mul_i32 s30, s6, 18432
  s_add_u32 s30, s30, 26214400
  buffer_load_dwordx4 v[64:67], v8, s[36:39], s30 offen offset:0
  buffer_load_dwordx4 v[68:71], v8, s[36:39], s30 offen offset:1024
  buffer_load_dwordx4 v[72:75], v8, s[36:39], s30 offen offset:2048
  buffer_load_dwordx4 v[76:79], v8, s[36:39], s30 offen offset:3072
  s_add_u32 s30, s30, 4096
  buffer_load_dwordx4 v[80:83], v8, s[36:39], s30 offen offset:0
  buffer_load_dwordx4 v[84:87], v8, s[36:39], s30 offen offset:1024
  buffer_load_dwordx4 v[88:91], v8, s[36:39], s30 offen offset:2048
  buffer_load_dwordx4 v[92:95], v8, s[36:39], s30 offen offset:3072
  s_add_u32 s30, s30, 4096
  buffer_load_dwordx4 v[96:99], v8, s[36:39], s30 offen offset:0
  buffer_load_dwordx4 v[100:103], v8, s[36:39], s30 offen offset:1024
  buffer_load_dwordx4 v[104:107], v8, s[36:39], s30 offen offset:2048
  buffer_load_dwordx4 v[108:111], v8, s[36:39], s30 offen offset:3072
  s_add_u32 s30, s30, 4096
  buffer_load_dwordx4 v[112:115], v8, s[36:39], s30 offen offset:0
  buffer_load_dwordx4 v[116:119], v8, s[36:39], s30 offen offset:1024
  buffer_load_dwordx4 v[120:123], v8, s[36:39], s30 offen offset:2048
  buffer_load_dwordx4 v[124:127], v8, s[36:39], s30 offen offset:3072
  s_add_u32 s30, s30, 4096
  buffer_load_dwordx4 v[128:131], v8, s[36:39], s30 offen offset:0
  buffer_load_dwordx4 v[132:135], v8, s[36:39], s30 offen offset:1024
  s_add_u32 s30, s30, 2048
  buffer_load_dwordx4 v[136:139], v8, s[36:39], s30 offen offset:0
  buffer_load_dwordx4 v[140:143], v8, s[36:39], s30 offen offset:1024
  buffer_load_dwordx4 v[144:147], v8, s[36:39], s30 offen offset:2048
  buffer_load_dwordx4 v[148:151], v8, s[36:39], s30 offen offset:3072
  s_add_u32 s30, s30, 4096
  buffer_load_dwordx4 v[152:155], v8, s[36:39], s30 offen offset:0
  buffer_load_dwordx4 v[156:159], v8, s[36:39], s30 offen offset:1024
  buffer_load_dwordx4 v[160:163], v8, s[36:39], s30 offen offset:2048
  buffer_load_dwordx4 v[164:167], v8, s[36:39], s30 offen offset:3072
  s_add_u32 s30, s30, 4096
  buffer_load_dwordx4 v[168:171], v8, s[36:39], s30 offen offset:0
  buffer_load_dwordx4 v[172:175], v8, s[36:39], s30 offen offset:1024
  buffer_load_dwordx4 v[176:179], v8, s[36:39], s30 offen offset:2048
  buffer_load_dwordx4 v[180:183], v8, s[36:39], s30 offen offset:3072
  s_add_u32 s30, s30, 4096
  buffer_load_dwordx4 v[184:187], v8, s[36:39], s30 offen offset:0
  buffer_load_dwordx4 v[188:191], v8, s[36:39], s30 offen offset:1024
  buffer_load_dwordx4 v[192:195], v8, s[36:39], s30 offen offset:2048
  buffer_load_dwordx4 v[196:199], v8, s[36:39], s30 offen offset:3072
  s_add_u32 s30, s30, 4096
  buffer_load_dwordx4 v[200:203], v8, s[36:39], s30 offen offset:0
  buffer_load_dwordx4 v[204:207], v8, s[36:39], s30 offen offset:1024
k2_attn_kernel_tnow:
  s_cmp_ge_u32 s5, 4
  s_cbranch_scc1 k2_attn_kernel_tyoung
  v_and_b32 v56, 31, v1
  v_lshlrev_b32 v56, 4, v56
  v_lshrrev_b32 v59, 5, v1
  v_lshl_add_u32 v56, v59, 11, v56
  s_lshl_b32 s6, s5, 12
  v_add_u32 v57, s6, v56
  s_lshl_b32 s30, s74, 15
  s_add_u32 s30, s30, s6
  s_add_u32 s30, s30, 16777216
  s_add_u32 s31, s30, 16384
  s_lshl_b32 s6, s5, 10
  v_add_u32 v58, s6, v8
  s_lshl_b32 s72, s74, 12
  s_add_u32 s72, s72, s6
  s_add_u32 s72, s72, 18874368
  v_add_u32 v15, s6, v15
  s_waitcnt lgkmcnt(0)
  s_barrier
  buffer_load_dwordx4 v[16:19], v56, s[36:39], s30 offen offset:0 sc1
  buffer_load_dwordx4 v[20:23], v56, s[36:39], s30 offen offset:512 sc1
  buffer_load_dwordx4 v[24:27], v56, s[36:39], s30 offen offset:1024 sc1
  buffer_load_dwordx4 v[28:31], v56, s[36:39], s30 offen offset:1536 sc1
  buffer_load_dwordx4 v[32:35], v56, s[36:39], s31 offen offset:0 sc1
  buffer_load_dwordx4 v[36:39], v56, s[36:39], s31 offen offset:512 sc1
  buffer_load_dwordx4 v[40:43], v56, s[36:39], s31 offen offset:1024 sc1
  buffer_load_dwordx4 v[44:47], v56, s[36:39], s31 offen offset:1536 sc1
  buffer_load_dwordx4 v[48:51], v8, s[36:39], s72 offen sc1
  ds_read_b64 v[224:225], v15 offset:0
  ds_read_b64 v[226:227], v15 offset:4608
  ds_read_b64 v[228:229], v15 offset:512
  ds_read_b64 v[230:231], v15 offset:5120
  s_waitcnt vmcnt(9) lgkmcnt(0)
  v_lshlrev_b32 v208, 16, v224
  v_and_b32 v209, 0xffff0000, v224
  v_lshlrev_b32 v210, 16, v225
  v_and_b32 v211, 0xffff0000, v225
  v_mul_f32 v208, v9, v208
  v_mul_f32 v209, v9, v209
  v_mul_f32 v210, v9, v210
  v_mul_f32 v211, v9, v211
  v_lshlrev_b32 v212, 16, v226
  v_and_b32 v213, 0xffff0000, v226
  v_lshlrev_b32 v214, 16, v227
  v_and_b32 v215, 0xffff0000, v227
  v_mul_f32 v212, v10, v212
  v_mul_f32 v213, v10, v213
  v_mul_f32 v214, v10, v214
  v_mul_f32 v215, v10, v215
  v_lshlrev_b32 v216, 16, v228
  v_and_b32 v217, 0xffff0000, v228
  v_lshlrev_b32 v218, 16, v229
  v_and_b32 v219, 0xffff0000, v229
  v_mul_f32 v216, v9, v216
  v_mul_f32 v217, v9, v217
  v_mul_f32 v218, v9, v218
  v_mul_f32 v219, v9, v219
  v_lshlrev_b32 v220, 16, v230
  v_and_b32 v221, 0xffff0000, v230
  v_lshlrev_b32 v222, 16, v231
  v_and_b32 v223, 0xffff0000, v231
  v_mul_f32 v220, v10, v220
  v_mul_f32 v221, v10, v221
  v_mul_f32 v222, v10, v222
  v_mul_f32 v223, v10, v223
  v_sub_f32 v11, 1.0, v9
  v_sub_f32 v12, 1.0, v10
  s_mov_b32 s73, 60000
k2_attn_kernel_txw:
  s_waitcnt vmcnt(0)
  v_max3_u32 v59, v16, v17, v18
  v_max3_u32 v60, v34, v35, v36
  v_max3_u32 v59, v59, v19, v20
  v_max3_u32 v60, v60, v37, v38
  v_max3_u32 v59, v59, v21, v22
  v_max3_u32 v60, v60, v39, v40
  v_max3_u32 v59, v59, v23, v24
  v_max3_u32 v60, v60, v41, v42
  v_max3_u32 v59, v59, v25, v26
  v_max3_u32 v60, v60, v43, v44
  v_max3_u32 v59, v59, v27, v28
  v_max3_u32 v60, v60, v45, v46
  v_max3_u32 v59, v59, v29, v30
  v_max3_u32 v60, v60, v47, v48
  v_max3_u32 v59, v59, v31, v32
  v_max3_u32 v60, v60, v49, v50
  v_max3_u32 v59, v59, v33, v51
  v_max_u32 v59, v59, v60
  v_cmp_eq_u32 vcc, -1, v59
  s_and_b64 exec, exec, vcc
  s_cbranch_scc0 k2_attn_kernel_txok
  s_sub_u32 s73, s73, 1
  s_cbranch_scc1 k2_attn_kernel_txok
  buffer_load_dwordx4 v[16:19], v56, s[36:39], s30 offen offset:0 sc1
  buffer_load_dwordx4 v[20:23], v56, s[36:39], s30 offen offset:512 sc1
  buffer_load_dwordx4 v[24:27], v56, s[36:39], s30 offen offset:1024 sc1
  buffer_load_dwordx4 v[28:31], v56, s[36:39], s30 offen offset:1536 sc1
  buffer_load_dwordx4 v[32:35], v56, s[36:39], s31 offen offset:0 sc1
  buffer_load_dwordx4 v[36:39], v56, s[36:39], s31 offen offset:512 sc1
  buffer_load_dwordx4 v[40:43], v56, s[36:39], s31 offen offset:1024 sc1
  buffer_load_dwordx4 v[44:47], v56, s[36:39], s31 offen offset:1536 sc1
  buffer_load_dwordx4 v[48:51], v8, s[36:39], s72 offen sc1
  s_branch k2_attn_kernel_txw
k2_attn_kernel_txok:
  s_mov_b64 exec, -1
  ds_write_b128 v57, v[16:19] offset:0
  ds_write_b128 v57, v[20:23] offset:512
  ds_write_b128 v57, v[24:27] offset:1024
  ds_write_b128 v57, v[28:31] offset:1536
  ds_write_b128 v57, v[32:35] offset:16384
  ds_write_b128 v57, v[36:39] offset:16896
  ds_write_b128 v57, v[40:43] offset:17408
  ds_write_b128 v57, v[44:47] offset:17920
  ds_write_b128 v58, v[48:51] offset:32768
  s_mov_b32 s72, 0
  s_mov_b32 s73, 18432
  s_waitcnt lgkmcnt(0)
  s_barrier
  ds_read_b128 v[16:19], v8 offset:0
  ds_read_b128 v[20:23], v8 offset:16384
  ds_read_b128 v[24:27], v8 offset:1024
  ds_read_b128 v[28:31], v8 offset:17408
  ds_read_b128 v[32:35], v8 offset:2048
  ds_read_b128 v[36:39], v8 offset:18432
  s_waitcnt lgkmcnt(4)
  v_mfma_f32_16x16x32_bf16 v[40:43], v[64:67], v[16:19], 0
  v_mfma_f32_16x16x32_bf16 v[44:47], v[64:67], v[20:23], 0
  v_mfma_f32_16x16x32_bf16 v[48:51], v[136:139], v[16:19], 0
  v_mfma_f32_16x16x32_bf16 v[52:55], v[136:139], v[20:23], 0
  ds_read_b128 v[16:19], v8 offset:3072
  ds_read_b128 v[20:23], v8 offset:19456
  s_waitcnt lgkmcnt(4)
  v_mfma_f32_16x16x32_bf16 v[40:43], v[68:71], v[24:27], v[40:43]
  v_mfma_f32_16x16x32_bf16 v[44:47], v[68:71], v[28:31], v[44:47]
  v_mfma_f32_16x16x32_bf16 v[48:51], v[140:143], v[24:27], v[48:51]
  v_mfma_f32_16x16x32_bf16 v[52:55], v[140:143], v[28:31], v[52:55]
  ds_read_b128 v[24:27], v8 offset:4096
  ds_read_b128 v[28:31], v8 offset:20480
  s_waitcnt lgkmcnt(4)
  v_mfma_f32_16x16x32_bf16 v[40:43], v[72:75], v[32:35], v[40:43]
  v_mfma_f32_16x16x32_bf16 v[44:47], v[72:75], v[36:39], v[44:47]
  v_mfma_f32_16x16x32_bf16 v[48:51], v[144:147], v[32:35], v[48:51]
  v_mfma_f32_16x16x32_bf16 v[52:55], v[144:147], v[36:39], v[52:55]
  ds_read_b128 v[32:35], v8 offset:5120
  ds_read_b128 v[36:39], v8 offset:21504
  s_waitcnt lgkmcnt(4)
  v_mfma_f32_16x16x32_bf16 v[40:43], v[76:79], v[16:19], v[40:43]
  v_mfma_f32_16x16x32_bf16 v[44:47], v[76:79], v[20:23], v[44:47]
  v_mfma_f32_16x16x32_bf16 v[48:51], v[148:151], v[16:19], v[48:51]
  v_mfma_f32_16x16x32_bf16 v[52:55], v[148:151], v[20:23], v[52:55]
  ds_read_b128 v[16:19], v8 offset:6144
  ds_read_b128 v[20:23], v8 offset:22528
  s_waitcnt lgkmcnt(4)
  v_mfma_f32_16x16x32_bf16 v[40:43], v[80:83], v[24:27], v[40:43]
  v_mfma_f32_16x16x32_bf16 v[44:47], v[80:83], v[28:31], v[44:47]
  v_mfma_f32_16x16x32_bf16 v[48:51], v[152:155], v[24:27], v[48:51]
  v_mfma_f32_16x16x32_bf16 v[52:55], v[152:155], v[28:31], v[52:55]
  ds_read_b128 v[24:27], v8 offset:7168
  ds_read_b128 v[28:31], v8 offset:23552
  s_waitcnt lgkmcnt(4)
  v_mfma_f32_16x16x32_bf16 v[40:43], v[84:87], v[32:35], v[40:43]
  v_mfma_f32_16x16x32_bf16 v[44:47], v[84:87], v[36:39], v[44:47]
  v_mfma_f32_16x16x32_bf16 v[48:51], v[156:159], v[32:35], v[48:51]
  v_mfma_f32_16x16x32_bf16 v[52:55], v[156:159], v[36:39], v[52:55]
  ds_read_b128 v[32:35], v8 offset:8192
  ds_read_b128 v[36:39], v8 offset:24576
  s_waitcnt lgkmcnt(4)
  v_mfma_f32_16x16x32_bf16 v[40:43], v[88:91], v[16:19], v[40:43]
  v_mfma_f32_16x16x32_bf16 v[44:47], v[88:91], v[20:23], v[44:47]
  v_mfma_f32_16x16x32_bf16 v[48:51], v[160:163], v[16:19], v[48:51]
  v_mfma_f32_16x16x32_bf16 v[52:55], v[160:163], v[20:23], v[52:55]
  ds_read_b128 v[16:19], v8 offset:9216
  ds_read_b128 v[20:23], v8 offset:25600
  s_waitcnt lgkmcnt(4)
  v_mfma_f32_16x16x32_bf16 v[40:43], v[92:95], v[24:27], v[40:43]
  v_mfma_f32_16x16x32_bf16 v[44:47], v[92:95], v[28:31], v[44:47]
  v_mfma_f32_16x16x32_bf16 v[48:51], v[164:167], v[24:27], v[48:51]
  v_mfma_f32_16x16x32_bf16 v[52:55], v[164:167], v[28:31], v[52:55]
  ds_read_b128 v[24:27], v8 offset:10240
  ds_read_b128 v[28:31], v8 offset:26624
  s_waitcnt lgkmcnt(4)
  v_mfma_f32_16x16x32_bf16 v[40:43], v[96:99], v[32:35], v[40:43]
  v_mfma_f32_16x16x32_bf16 v[44:47], v[96:99], v[36:39], v[44:47]
  v_mfma_f32_16x16x32_bf16 v[48:51], v[168:171], v[32:35], v[48:51]
  v_mfma_f32_16x16x32_bf16 v[52:55], v[168:171], v[36:39], v[52:55]
  ds_read_b128 v[32:35], v8 offset:11264
  ds_read_b128 v[36:39], v8 offset:27648
  s_waitcnt lgkmcnt(4)
  v_mfma_f32_16x16x32_bf16 v[40:43], v[100:103], v[16:19], v[40:43]
  v_mfma_f32_16x16x32_bf16 v[44:47], v[100:103], v[20:23], v[44:47]
  v_mfma_f32_16x16x32_bf16 v[48:51], v[172:175], v[16:19], v[48:51]
  v_mfma_f32_16x16x32_bf16 v[52:55], v[172:175], v[20:23], v[52:55]
  ds_read_b128 v[16:19], v8 offset:12288
  ds_read_b128 v[20:23], v8 offset:28672
  s_waitcnt lgkmcnt(4)
  v_mfma_f32_16x16x32_bf16 v[40:43], v[104:107], v[24:27], v[40:43]
  v_mfma_f32_16x16x32_bf16 v[44:47], v[104:107], v[28:31], v[44:47]
  v_mfma_f32_16x16x32_bf16 v[48:51], v[176:179], v[24:27], v[48:51]
  v_mfma_f32_16x16x32_bf16 v[52:55], v[176:179], v[28:31], v[52:55]
  ds_read_b128 v[24:27], v8 offset:13312
  ds_read_b128 v[28:31], v8 offset:29696
  s_waitcnt lgkmcnt(4)
  v_mfma_f32_16x16x32_bf16 v[40:43], v[108:111], v[32:35], v[40:43]
  v_mfma_f32_16x16x32_bf16 v[44:47], v[108:111], v[36:39], v[44:47]
  v_mfma_f32_16x16x32_bf16 v[48:51], v[180:183], v[32:35], v[48:51]
  v_mfma_f32_16x16x32_bf16 v[52:55], v[180:183], v[36:39], v[52:55]
  ds_read_b128 v[32:35], v8 offset:14336
  ds_read_b128 v[36:39], v8 offset:30720
  s_waitcnt lgkmcnt(4)
  v_mfma_f32_16x16x32_bf16 v[40:43], v[112:115], v[16:19], v[40:43]
  v_mfma_f32_16x16x32_bf16 v[44:47], v[112:115], v[20:23], v[44:47]
  v_mfma_f32_16x16x32_bf16 v[48:51], v[184:187], v[16:19], v[48:51]
  v_mfma_f32_16x16x32_bf16 v[52:55], v[184:187], v[20:23], v[52:55]
  ds_read_b128 v[16:19], v8 offset:15360
  ds_read_b128 v[20:23], v8 offset:31744
  s_waitcnt lgkmcnt(4)
  v_mfma_f32_16x16x32_bf16 v[40:43], v[116:119], v[24:27], v[40:43]
  v_mfma_f32_16x16x32_bf16 v[44:47], v[116:119], v[28:31], v[44:47]
  v_mfma_f32_16x16x32_bf16 v[48:51], v[188:191], v[24:27], v[48:51]
  v_mfma_f32_16x16x32_bf16 v[52:55], v[188:191], v[28:31], v[52:55]
  ds_read_b32 v24, v14 offset:32768
  ds_read_b32 v25, v14 offset:32896
  ds_read_b32 v26, v14 offset:33024
  ds_read_b32 v27, v14 offset:33152
  ds_read_b32 v28, v14 offset:32832
  ds_read_b32 v29, v14 offset:32960
  ds_read_b32 v30, v14 offset:33088
  ds_read_b32 v31, v14 offset:33216
  s_waitcnt lgkmcnt(10)
  v_mfma_f32_16x16x32_bf16 v[40:43], v[120:123], v[32:35], v[40:43]
  v_mfma_f32_16x16x32_bf16 v[44:47], v[120:123], v[36:39], v[44:47]
  v_mfma_f32_16x16x32_bf16 v[48:51], v[192:195], v[32:35], v[48:51]
  v_mfma_f32_16x16x32_bf16 v[52:55], v[192:195], v[36:39], v[52:55]
  ds_read_b32 v32, v14 offset:34816
  ds_read_b32 v33, v14 offset:34944
  ds_read_b32 v34, v14 offset:35072
  ds_read_b32 v35, v14 offset:35200
  ds_read_b32 v36, v14 offset:34880
  ds_read_b32 v37, v14 offset:35008
  ds_read_b32 v38, v14 offset:35136
  ds_read_b32 v39, v14 offset:35264
  s_waitcnt lgkmcnt(15)
  v_mfma_f32_16x16x32_bf16 v[40:43], v[124:127], v[16:19], v[40:43]
  v_mfma_f32_16x16x32_bf16 v[44:47], v[124:127], v[20:23], v[44:47]
  v_mfma_f32_16x16x32_bf16 v[48:51], v[196:199], v[16:19], v[48:51]
  v_mfma_f32_16x16x32_bf16 v[52:55], v[196:199], v[20:23], v[52:55]
  s_waitcnt lgkmcnt(8)
  v_mfma_f32_16x16x32_bf16 v[40:43], v[128:131], v[24:27], v[40:43]
  v_mfma_f32_16x16x32_bf16 v[44:47], v[128:131], v[28:31], v[44:47]
  v_mfma_f32_16x16x32_bf16 v[48:51], v[200:203], v[24:27], v[48:51]
  v_mfma_f32_16x16x32_bf16 v[52:55], v[200:203], v[28:31], v[52:55]
  s_waitcnt lgkmcnt(0)
  v_mfma_f32_16x16x32_bf16 v[40:43], v[132:135], v[32:35], v[40:43]
  v_mfma_f32_16x16x32_bf16 v[44:47], v[132:135], v[36:39], v[44:47]
  v_mfma_f32_16x16x32_bf16 v[48:51], v[204:207], v[32:35], v[48:51]
  v_mfma_f32_16x16x32_bf16 v[52:55], v[204:207], v[36:39], v[52:55]
  s_nop 7
  v_fma_f32 v40, v11, v40, v208
  v_fma_f32 v41, v11, v41, v209
  v_fma_f32 v42, v11, v42, v210
  v_fma_f32 v43, v11, v43, v211
  v_cvt_pk_bf16_f32 v224, v40, v41
  v_cvt_pk_bf16_f32 v225, v42, v43
  v_fma_f32 v48, v11, v48, v216
  v_fma_f32 v49, v11, v49, v217
  v_fma_f32 v50, v11, v50, v218
  v_fma_f32 v51, v11, v51, v219
  v_cvt_pk_bf16_f32 v226, v48, v49
  v_cvt_pk_bf16_f32 v227, v50, v51
  buffer_store_dwordx4 v[224:227], v13, s[16:19], s72 offen
  v_fma_f32 v44, v12, v44, v212
  v_fma_f32 v45, v12, v45, v213
  v_fma_f32 v46, v12, v46, v214
  v_fma_f32 v47, v12, v47, v215
  v_cvt_pk_bf16_f32 v228, v44, v45
  v_cvt_pk_bf16_f32 v229, v46, v47
  v_fma_f32 v52, v12, v52, v220
  v_fma_f32 v53, v12, v53, v221
  v_fma_f32 v54, v12, v54, v222
  v_fma_f32 v55, v12, v55, v223
  v_cvt_pk_bf16_f32 v230, v52, v53
  v_cvt_pk_bf16_f32 v231, v54, v55
  buffer_store_dwordx4 v[228:231], v13, s[16:19], s73 offen
  s_branch k2_attn_kernel_done
k2_attn_kernel_tyoung:
  s_cmp_ge_u32 s5, 6
  s_cbranch_scc0 k2_attn_kernel_tidle
  s_sub_u32 s6, s5, 6
  s_mul_i32 s30, s6, 4608
  s_add_u32 s30, s30, 4096
  v_add_u32 v15, s30, v15
  s_lshl_b32 s30, s6, 14
  v_add_u32 v60, s30, v8
  s_lshl_b32 s30, s6, 6
  v_add_u32 v61, s30, v14
  s_mov_b32 s73, s6
  s_cmp_eq_u32 s5, 7
  s_cbranch_scc0 k2_attn_kernel_t6
  s_mov_b32 s30, 23068672
  buffer_load_dword v9, v56, s[36:39], s30 offen
  buffer_load_dword v10, v56, s[36:39], s30 offen offset:64
  s_lshl_b32 s72, s5, 1
  s_min_u32 s72, s72, 8
  s_mul_i32 s6, s75, 9
  s_add_u32 s6, s6, s72
  s_mul_i32 s31, s75, 288
  s_and_b32 s30, s75, 1
  s_cmp_eq_u32 s30, 0
  s_cselect_b32 s30, 256, 0
  s_add_u32 s31, s31, s30
  v_add_u32 v13, s31, v13
  s_mul_i32 s30, s6, 18432
  s_add_u32 s30, s30, 26214400
  buffer_load_dwordx4 v[64:67], v8, s[36:39], s30 offen offset:0
  buffer_load_dwordx4 v[68:71], v8, s[36:39], s30 offen offset:1024
  buffer_load_dwordx4 v[72:75], v8, s[36:39], s30 offen offset:2048
  buffer_load_dwordx4 v[76:79], v8, s[36:39], s30 offen offset:3072
  s_add_u32 s30, s30, 4096
  buffer_load_dwordx4 v[80:83], v8, s[36:39], s30 offen offset:0
  buffer_load_dwordx4 v[84:87], v8, s[36:39], s30 offen offset:1024
  buffer_load_dwordx4 v[88:91], v8, s[36:39], s30 offen offset:2048
  buffer_load_dwordx4 v[92:95], v8, s[36:39], s30 offen offset:3072
  s_add_u32 s30, s30, 4096
  buffer_load_dwordx4 v[96:99], v8, s[36:39], s30 offen offset:0
  buffer_load_dwordx4 v[100:103], v8, s[36:39], s30 offen offset:1024
  buffer_load_dwordx4 v[104:107], v8, s[36:39], s30 offen offset:2048
  buffer_load_dwordx4 v[108:111], v8, s[36:39], s30 offen offset:3072
  s_add_u32 s30, s30, 4096
  buffer_load_dwordx4 v[112:115], v8, s[36:39], s30 offen offset:0
  buffer_load_dwordx4 v[116:119], v8, s[36:39], s30 offen offset:1024
  buffer_load_dwordx4 v[120:123], v8, s[36:39], s30 offen offset:2048
  buffer_load_dwordx4 v[124:127], v8, s[36:39], s30 offen offset:3072
  s_add_u32 s30, s30, 4096
  buffer_load_dwordx4 v[128:131], v8, s[36:39], s30 offen offset:0
  buffer_load_dwordx4 v[132:135], v8, s[36:39], s30 offen offset:1024
  s_barrier
  s_waitcnt vmcnt(18)
  v_mov_b32 v9, v10
  ds_read_b64 v[224:225], v15
  s_waitcnt vmcnt(18) lgkmcnt(0)
  v_lshlrev_b32 v208, 16, v224
  v_and_b32 v209, 0xffff0000, v224
  v_lshlrev_b32 v210, 16, v225
  v_and_b32 v211, 0xffff0000, v225
  v_mul_f32 v208, v9, v208
  v_mul_f32 v209, v9, v209
  v_mul_f32 v210, v9, v210
  v_mul_f32 v211, v9, v211
  v_sub_f32 v11, 1.0, v9
  v_sub_f32 v12, 1.0, v10
  s_mov_b32 s72, 18432
  s_waitcnt vmcnt(0)
  s_barrier
  s_branch k2_attn_kernel_t67
k2_attn_kernel_t6:
  s_barrier
  s_barrier
  s_mov_b32 s30, 23068672
  buffer_load_dword v9, v56, s[36:39], s30 offen
  buffer_load_dword v10, v56, s[36:39], s30 offen offset:64
  s_lshl_b32 s72, s5, 1
  s_min_u32 s72, s72, 8
  s_mul_i32 s6, s75, 9
  s_add_u32 s6, s6, s72
  s_mul_i32 s31, s75, 288
  s_and_b32 s30, s75, 1
  s_cmp_eq_u32 s30, 0
  s_cselect_b32 s30, 256, 0
  s_add_u32 s31, s31, s30
  v_add_u32 v13, s31, v13
  s_mul_i32 s30, s6, 18432
  s_add_u32 s30, s30, 26214400
  buffer_load_dwordx4 v[64:67], v8, s[36:39], s30 offen offset:0
  buffer_load_dwordx4 v[68:71], v8, s[36:39], s30 offen offset:1024
  buffer_load_dwordx4 v[72:75], v8, s[36:39], s30 offen offset:2048
  buffer_load_dwordx4 v[76:79], v8, s[36:39], s30 offen offset:3072
  s_add_u32 s30, s30, 4096
  buffer_load_dwordx4 v[80:83], v8, s[36:39], s30 offen offset:0
  buffer_load_dwordx4 v[84:87], v8, s[36:39], s30 offen offset:1024
  buffer_load_dwordx4 v[88:91], v8, s[36:39], s30 offen offset:2048
  buffer_load_dwordx4 v[92:95], v8, s[36:39], s30 offen offset:3072
  s_add_u32 s30, s30, 4096
  buffer_load_dwordx4 v[96:99], v8, s[36:39], s30 offen offset:0
  buffer_load_dwordx4 v[100:103], v8, s[36:39], s30 offen offset:1024
  buffer_load_dwordx4 v[104:107], v8, s[36:39], s30 offen offset:2048
  buffer_load_dwordx4 v[108:111], v8, s[36:39], s30 offen offset:3072
  s_add_u32 s30, s30, 4096
  buffer_load_dwordx4 v[112:115], v8, s[36:39], s30 offen offset:0
  buffer_load_dwordx4 v[116:119], v8, s[36:39], s30 offen offset:1024
  buffer_load_dwordx4 v[120:123], v8, s[36:39], s30 offen offset:2048
  buffer_load_dwordx4 v[124:127], v8, s[36:39], s30 offen offset:3072
  s_add_u32 s30, s30, 4096
  buffer_load_dwordx4 v[128:131], v8, s[36:39], s30 offen offset:0
  buffer_load_dwordx4 v[132:135], v8, s[36:39], s30 offen offset:1024
  ds_read_b64 v[224:225], v15
  s_waitcnt vmcnt(18) lgkmcnt(0)
  v_lshlrev_b32 v208, 16, v224
  v_and_b32 v209, 0xffff0000, v224
  v_lshlrev_b32 v210, 16, v225
  v_and_b32 v211, 0xffff0000, v225
  v_mul_f32 v208, v9, v208
  v_mul_f32 v209, v9, v209
  v_mul_f32 v210, v9, v210
  v_mul_f32 v211, v9, v211
  v_sub_f32 v11, 1.0, v9
  v_sub_f32 v12, 1.0, v10
  s_mov_b32 s72, 0
  s_waitcnt vmcnt(0)
k2_attn_kernel_t67:
  ds_read_b128 v[16:19], v60 offset:0
  ds_read_b128 v[24:27], v60 offset:1024
  ds_read_b128 v[32:35], v60 offset:2048
  s_waitcnt lgkmcnt(2)
  v_mfma_f32_16x16x32_bf16 v[40:43], v[64:67], v[16:19], 0
  ds_read_b128 v[16:19], v60 offset:3072
  s_waitcnt lgkmcnt(2)
  v_mfma_f32_16x16x32_bf16 v[40:43], v[68:71], v[24:27], v[40:43]
  ds_read_b128 v[24:27], v60 offset:4096
  s_waitcnt lgkmcnt(2)
  v_mfma_f32_16x16x32_bf16 v[40:43], v[72:75], v[32:35], v[40:43]
  ds_read_b128 v[32:35], v60 offset:5120
  s_waitcnt lgkmcnt(2)
  v_mfma_f32_16x16x32_bf16 v[40:43], v[76:79], v[16:19], v[40:43]
  ds_read_b128 v[16:19], v60 offset:6144
  s_waitcnt lgkmcnt(2)
  v_mfma_f32_16x16x32_bf16 v[40:43], v[80:83], v[24:27], v[40:43]
  ds_read_b128 v[24:27], v60 offset:7168
  s_waitcnt lgkmcnt(2)
  v_mfma_f32_16x16x32_bf16 v[40:43], v[84:87], v[32:35], v[40:43]
  ds_read_b128 v[32:35], v60 offset:8192
  s_waitcnt lgkmcnt(2)
  v_mfma_f32_16x16x32_bf16 v[40:43], v[88:91], v[16:19], v[40:43]
  ds_read_b128 v[16:19], v60 offset:9216
  s_waitcnt lgkmcnt(2)
  v_mfma_f32_16x16x32_bf16 v[40:43], v[92:95], v[24:27], v[40:43]
  ds_read_b128 v[24:27], v60 offset:10240
  s_waitcnt lgkmcnt(2)
  v_mfma_f32_16x16x32_bf16 v[40:43], v[96:99], v[32:35], v[40:43]
  ds_read_b128 v[32:35], v60 offset:11264
  s_waitcnt lgkmcnt(2)
  v_mfma_f32_16x16x32_bf16 v[40:43], v[100:103], v[16:19], v[40:43]
  ds_read_b128 v[16:19], v60 offset:12288
  s_waitcnt lgkmcnt(2)
  v_mfma_f32_16x16x32_bf16 v[40:43], v[104:107], v[24:27], v[40:43]
  ds_read_b128 v[24:27], v60 offset:13312
  s_waitcnt lgkmcnt(2)
  v_mfma_f32_16x16x32_bf16 v[40:43], v[108:111], v[32:35], v[40:43]
  ds_read_b128 v[32:35], v60 offset:14336
  s_waitcnt lgkmcnt(2)
  v_mfma_f32_16x16x32_bf16 v[40:43], v[112:115], v[16:19], v[40:43]
  ds_read_b128 v[16:19], v60 offset:15360
  s_waitcnt lgkmcnt(2)
  v_mfma_f32_16x16x32_bf16 v[40:43], v[116:119], v[24:27], v[40:43]
  ds_read_b32 v24, v61 offset:32768
  ds_read_b32 v25, v61 offset:32896
  ds_read_b32 v26, v61 offset:33024
  ds_read_b32 v27, v61 offset:33152
  s_waitcnt lgkmcnt(5)
  v_mfma_f32_16x16x32_bf16 v[40:43], v[120:123], v[32:35], v[40:43]
  ds_read_b32 v32, v61 offset:34816
  ds_read_b32 v33, v61 offset:34944
  ds_read_b32 v34, v61 offset:35072
  ds_read_b32 v35, v61 offset:35200
  s_waitcnt lgkmcnt(8)
  v_mfma_f32_16x16x32_bf16 v[40:43], v[124:127], v[16:19], v[40:43]
  s_waitcnt lgkmcnt(4)
  v_mfma_f32_16x16x32_bf16 v[40:43], v[128:131], v[24:27], v[40:43]
  s_waitcnt lgkmcnt(0)
  v_mfma_f32_16x16x32_bf16 v[40:43], v[132:135], v[32:35], v[40:43]
  s_nop 7
  v_fma_f32 v40, v11, v40, v208
  v_fma_f32 v41, v11, v41, v209
  v_fma_f32 v42, v11, v42, v210
  v_fma_f32 v43, v11, v43, v211
  v_cvt_pk_bf16_f32 v224, v40, v41
  v_cvt_pk_bf16_f32 v225, v42, v43
  buffer_store_dwordx2 v[224:225], v13, s[16:19], s72 offen offset:0
  s_branch k2_attn_kernel_done
k2_attn_kernel_tidle:
  s_barrier
  s_barrier
k2_attn_kernel_done:
k2_attn_kernel_end:
  s_endpgm
k2_attn_kernel_slow:
  v_subrev_u32 v2, 151552, v2
  v_subrev_u32 v3, 151552, v3
  v_subrev_u32 v4, 151552, v4
  v_xor_b32 v6, 32, v4
  v_mov_b32 v88, 0xff800000
  s_mov_b32 s23, 64
k2_attn_kernel_slow_max:
  ds_read_b128 v[16:19], v2
  ds_read_b32 v20, v3
  s_waitcnt lgkmcnt(0)
  v_mfma_f32_32x32x16_bf16 v[56:71], v[16:19], v[8:11], 0
  s_nop 9
  v_mfma_f32_32x32x8_bf16 v[56:71], v[20:21], v[14:15], v[56:71]
  s_nop 11
  v_max3_f32 v88, v88, v56, v57
  v_max3_f32 v88, v88, v58, v59
  v_max3_f32 v88, v88, v60, v61
  v_max3_f32 v88, v88, v62, v63
  v_max3_f32 v88, v88, v64, v65
  v_max3_f32 v88, v88, v66, v67
  v_max3_f32 v88, v88, v68, v69
  v_max3_f32 v88, v88, v70, v71
  v_add_u32 v2, 2368, v2
  v_add_u32 v3, 2368, v3
  s_sub_u32 s23, s23, 1
  s_cmp_lg_u32 s23, 0
  s_cbranch_scc1 k2_attn_kernel_slow_max
  v_subrev_u32 v2, 151552, v2
  v_subrev_u32 v3, 151552, v3
  v_mov_b32 v89, v88
  s_nop 1
  v_permlane32_swap_b32 v88, v89
  s_nop 1
  v_max_f32 v88, v88, v89
  v_sub_f32 v90, 0, v88
  v_and_b32 v91, 0xffff0000, v90
  v_sub_f32 v90, v90, v91
  v_and_b32 v92, 0xffff0000, v90
  v_sub_f32 v90, v90, v92
  v_lshrrev_b32 v91, 16, v91
  v_or_b32 v91, v91, v92
  v_lshrrev_b32 v90, 16, v90
  v_cmp_gt_u32 vcc, 32, v1
  s_nop 1
  v_cndmask_b32 v13, v90, v91, vcc
  v_mov_b32 v40, 0
  v_mov_b32 v41, 0
  v_mov_b32 v42, 0
  v_mov_b32 v43, 0
  v_mov_b32 v44, 0
  v_mov_b32 v45, 0
  v_mov_b32 v46, 0
  v_mov_b32 v47, 0
  v_mov_b32 v48, 0
  v_mov_b32 v49, 0
  v_mov_b32 v50, 0
  v_mov_b32 v51, 0
  v_mov_b32 v52, 0
  v_mov_b32 v53, 0
  v_mov_b32 v54, 0
  v_mov_b32 v55, 0
  s_mov_b32 s23, 64
k2_attn_kernel_slow_main:
  ds_read_b128 v[16:19], v2
  ds_read_b32 v20, v3
  ds_read_b128 v[24:27], v4
  ds_read_b128 v[28:31], v6 offset:0
  s_waitcnt lgkmcnt(0)
  v_mfma_f32_32x32x16_bf16 v[56:71], v[16:19], v[8:11], 0
  s_nop 9
  v_mfma_f32_32x32x8_bf16 v[56:71], v[20:21], v[12:13], v[56:71]
  s_nop 11
  v_exp_f32 v56, v56
  v_exp_f32 v57, v57
  v_exp_f32 v58, v58
  v_exp_f32 v59, v59
  v_exp_f32 v60, v60
  v_exp_f32 v61, v61
  v_exp_f32 v62, v62
  v_exp_f32 v63, v63
  v_exp_f32 v64, v64
  v_exp_f32 v65, v65
  v_exp_f32 v66, v66
  v_exp_f32 v67, v67
  v_exp_f32 v68, v68
  v_exp_f32 v69, v69
  v_exp_f32 v70, v70
  v_exp_f32 v71, v71
  s_nop 0
  v_cvt_pk_bf16_f32 v32, v56, v57
  v_cvt_pk_bf16_f32 v33, v58, v59
  v_cvt_pk_bf16_f32 v34, v60, v61
  v_cvt_pk_bf16_f32 v35, v62, v63
  v_cvt_pk_bf16_f32 v36, v64, v65
  v_cvt_pk_bf16_f32 v37, v66, v67
  v_cvt_pk_bf16_f32 v38, v68, v69
  v_cvt_pk_bf16_f32 v39, v70, v71
  s_nop 1
  v_mfma_f32_32x32x16_bf16 v[40:55], v[24:27], v[32:35], v[40:55]
  v_mfma_f32_32x32x16_bf16 v[40:55], v[28:31], v[36:39], v[40:55]
  v_add_u32 v2, 2368, v2
  v_add_u32 v3, 2368, v3
  v_add_u32 v4, 2368, v4
  v_xor_b32 v6, 32, v4
  s_sub_u32 s23, s23, 1
  s_cmp_lg_u32 s23, 0
  s_cbranch_scc1 k2_attn_kernel_slow_main
  s_nop 11
  v_mov_b32 v88, v50
  v_mov_b32 v89, v50
  s_nop 1
  v_permlane32_swap_b32 v88, v89
  s_nop 1
  s_branch k2_attn_kernel_fin
.section .rodata,"a"
.p2align 6
.amdhsa_kernel k2_attn_kernel
  .amdhsa_next_free_vgpr 256
  .amdhsa_next_free_sgpr 102
  .amdhsa_accum_offset 256
  .amdhsa_group_segment_fixed_size 0
  .amdhsa_kernarg_size 80
  .amdhsa_user_sgpr_count 2
  .amdhsa_user_sgpr_kernarg_segment_ptr 1
  .amdhsa_system_sgpr_workgroup_id_x 1
  .amdhsa_float_denorm_mode_32 3
.end_amdhsa_kernel
.text
```
